```python
import torch

def _softmax(x, axis=-1):
    return torch.softmax(x, dim=axis)

def _gelu(x):
    return torch.nn.functional.gelu(x, approximate='tanh')

def _silu(x):
    return torch.nn.functional.silu(x)

def _sigmoid(x):
    return torch.sigmoid(x)

def _layernorm(x, axis=-1, eps=1e-05):
    m = x.mean(dim=axis, keepdim=True)
    v = x.var(dim=axis, keepdim=True, unbiased=False)
    return (x - m) / torch.sqrt(v + eps)

def _scatter_add(tgt, idx, src, axis=0):
    return tgt.clone().index_add_(axis, idx, src)

def _segment_sum(src, seg, n):
    out = torch.zeros((n,) + src.shape[1:], dtype=src.dtype)
    return out.index_add_(0, seg, src)

def _pad(x, pw):
    flat = tuple((v for pair in reversed(pw) for v in pair))
    return torch.nn.functional.pad(x, flat)
kernel_name = 'adaLN_cond__sliding_block_cached__mixer_s_mlp__prompt'

def setup_inputs():

    _w = lambda a: (lambda t: t.to(torch.bfloat16) if t.is_floating_point() else t)(torch.as_tensor(a))

    def _A_setup():
        B, Sq, D = (1, 2048, 640)
        Hq, Hkv, Sk, Dh = (32, 32, 2048, 128)
        assert Hq % Hkv == 0, (Hq, Hkv)
        return {'x': _w((lambda *s: torch.randn(*s, dtype=torch.bfloat16) * 0.1)(B, Sq, D)), 'k_cache': _w((lambda *s: torch.randn(*s, dtype=torch.bfloat16) * 0.8)(B, Hkv, Sk, Dh)), 'v_cache': _w((lambda *s: torch.randn(*s, dtype=torch.bfloat16) * 0.8)(B, Hkv, Sk, Dh)), 'wq': _w((lambda *s: torch.randn(*s, dtype=torch.bfloat16) * 0.8)(D, Hq * Dh) * D ** (-0.5)), 'wo': _w((lambda *s: torch.randn(*s, dtype=torch.bfloat16) * 0.8)(Hq * Dh, D) * (Hq * Dh) ** (-0.5))}
    _A_in = _A_setup()

    def _B_setup():
        B, S, D, F = (1, 2048, 640, 1728)
        return {'x': _w((lambda *s: torch.randn(*s, dtype=torch.bfloat16) * 0.1)(B, S, D)), 'w1': _w((lambda *s: torch.randn(*s, dtype=torch.bfloat16) * 3.2)(D, D) * D ** (-0.5)), 'w2': _w((lambda *s: torch.randn(*s, dtype=torch.bfloat16) * 3.2)(D, D) * D ** (-0.5)), 'w3': _w((lambda *s: torch.randn(*s, dtype=torch.bfloat16) * 3.2)(D, F) * D ** (-0.5)), 'w4': _w((lambda *s: torch.randn(*s, dtype=torch.bfloat16) * 3.2)(F, D) * F ** (-0.5))}
    _B_in = _B_setup()
    return {'A_x': _A_in['x'], 'A_k_cache': _A_in['k_cache'], 'A_v_cache': _A_in['v_cache'], 'A_wq': _A_in['wq'], 'A_wo': _A_in['wo'], 'B_x': _B_in['x'], 'B_w1': _B_in['w1'], 'B_w2': _B_in['w2'], 'B_w3': _B_in['w3'], 'B_w4': _B_in['w4'], 'c': _w((lambda *s: torch.randn(*s, dtype=torch.bfloat16) * 0.2)(1, 640) * 8.0), 'w_mod': _w((lambda *s: torch.randn(*s, dtype=torch.bfloat16) * 0.2)(640, 6 * 640) * 640 ** (-0.5) * 8.0)}

def reference(A_x, A_k_cache, A_v_cache, A_wq, A_wo, B_x, B_w1, B_w2, B_w3, B_w4, c, w_mod):

    def _A_ref(x, k_cache, v_cache, wq, wo):
        B, Sq, D = x.shape
        Hq, Dh = (32, 128)
        Hkv, Sk = (k_cache.shape[1], k_cache.shape[2])
        W = min(4096, max(256, Sk // 4))
        rep = Hq // Hkv
        q = (lambda x, *d: x.permute(*d))((x @ wq).reshape(B, Sq, Hq, Dh), 0, 2, 1, 3)
        k = (lambda x, n, axis: torch.repeat_interleave(x, n, dim=axis))(k_cache[:, :, Sk - W:, :], rep, axis=1)
        v = (lambda x, n, axis: torch.repeat_interleave(x, n, dim=axis))(v_cache[:, :, Sk - W:, :], rep, axis=1)
        scores = torch.einsum('bhqd,bhkd->bhqk', q, k) * Dh ** (-0.5)
        p = _softmax(scores, axis=-1)
        o = torch.einsum('bhqk,bhkd->bhqd', p, v)
        return (lambda x, *d: x.permute(*d))(o, 0, 2, 1, 3).reshape(B, Sq, Hq * Dh) @ wo

    def _B_ref(x, w1, w2, w3, w4):
        B, S, D = x.shape
        h = _gelu(_layernorm(x, axis=-1) @ w1)
        c = D // 4
        g0 = _pad(h[:, :, 0 * c:1 * c], ((0, 0), (1, 0), (0, 0)))[:, :S, :]
        g1 = _pad(h[:, :, 1 * c:2 * c], ((0, 0), (0, 1), (0, 0)))[:, 1:, :]
        g2 = _pad(h[:, :, 2 * c:3 * c], ((0, 0), (2, 0), (0, 0)))[:, :S, :]
        g3 = _pad(h[:, :, 3 * c:], ((0, 0), (0, 2), (0, 0)))[:, 2:, :]
        hs = torch.concatenate([g0, g1, g2, g3], axis=-1) @ w2
        x1 = x + hs
        h2 = _gelu(_layernorm(x1, axis=-1) @ w3) @ w4
        return x1 + h2
    x = A_x
    mod = (_silu(c) @ w_mod).reshape(c.shape[0], 6, 1, -1)
    sa, ca, ga, sb, cb, gb = (mod[:, 0].clone(), mod[:, 1].clone(), mod[:, 2].clone(), mod[:, 3].clone(), mod[:, 4].clone(), mod[:, 5].clone())
    h = _layernorm(x, axis=-1) * (1 + ca) + sa
    x = x + ga * _A_ref(h, A_k_cache, A_v_cache, A_wq, A_wo)
    h = _layernorm(x, axis=-1) * (1 + cb) + sb
    x = x + gb * _B_ref(h, B_w1, B_w2, B_w3, B_w4)
    return x
```

```asm
; @launch grid=(256,1,1) block=(512,1,1) lds=163840
.amdgcn_target "amdgcn-amd-amdhsa--gfx950"
.text
.globl adaLN_cond__sliding_block_cached__mixer_s_mlp__prompt_kernel
.p2align 8
.type adaLN_cond__sliding_block_cached__mixer_s_mlp__prompt_kernel,@function
adaLN_cond__sliding_block_cached__mixer_s_mlp__prompt_kernel:
    s_cmp_ge_u32 s2, 256
    s_cbranch_scc1 L_exit_main
    s_load_dwordx8 s[36:43], s[0:1], 0
    s_load_dwordx4 s[44:47], s[0:1], 80
    s_load_dwordx2 s[4:5], s[0:1], 112
    s_load_dwordx2 s[20:21], s[0:1], 104
    v_lshrrev_b32 v1, 6, v0
    v_and_b32 v0, 63, v0
    v_readfirstlane_b32 s3, v1
    s_cmp_lt_u32 s2, 80
    s_cbranch_scc0 L_mt_1
    s_mul_i32 s31, s2, 205
    s_lshr_b32 s31, s31, 12
    s_mul_i32 s30, s31, 20
    s_sub_u32 s30, s2, s30
    s_branch L_mt_2
L_mt_1:
    s_sub_u32 s30, s2, 80
    s_mul_i32 s31, s30, 103
    s_lshr_b32 s31, s31, 12
    s_mul_i32 s25, s31, 40
    s_sub_u32 s30, s30, s25
    s_add_u32 s30, s30, 20
L_mt_2:
    s_lshl_b32 s25, s3, 6
    v_add_u32 v1, s25, v0
    v_lshrrev_b32 v2, 3, v1
    v_and_b32 v3, 7, v1
    s_mul_i32 s25, s31, 160
    v_add_u32 v8, s25, v2
    v_mul_u32_u24 v9, 7680, v8
    v_lshl_add_u32 v9, v3, 4, v9
    s_lshl_b32 s25, s30, 7
    v_add_u32 v9, s25, v9
    v_lshlrev_b32 v8, 1, v8
    v_mov_b32 v10, 0x7fff0000
    v_cmp_gt_u32 vcc, 32, v2
    s_nop 1
    v_cndmask_b32 v11, v10, v9, vcc
    v_cndmask_b32 v12, v10, v8, vcc
    s_mov_b32 s34, s2
    s_lshl_b32 s27, s3, 6
    v_add_u32 v88, s27, v0
    v_lshrrev_b32 v89, 3, v88
    v_and_b32 v90, 7, v0
    s_lshl_b32 s27, s34, 3
    v_add_u32 v91, s27, v90
    v_mul_u32_u24 v91, 1280, v91
    v_lshl_add_u32 v91, v89, 4, v91
    s_waitcnt lgkmcnt(0)
    s_mov_b32 s48, s46
    s_and_b32 s49, s47, 0xffff
    s_mov_b32 s50, 4915200
    s_mov_b32 s51, 0x20000
    s_mov_b32 s52, s44
    s_and_b32 s53, s45, 0xffff
    s_mov_b32 s54, 1280
    s_mov_b32 s55, 0x20000
    s_mov_b32 s64, s36
    s_and_b32 s65, s37, 0xffff
    s_mov_b32 s66, 2621440
    s_mov_b32 s67, 0x20000
    s_and_b32 s5, s5, 0xffff
    s_mov_b32 s6, 79691776
    s_mov_b32 s7, 0x20000
    s_and_b32 s21, s21, 0xffff
    s_mov_b32 s22, 256
    s_mov_b32 s23, 0x20000
    s_mov_b32 s56, s38
    s_mov_b32 s57, s39
    s_mov_b32 s62, s40
    s_mov_b32 s63, s41
    s_mov_b32 s68, s42
    s_mov_b32 s69, s43
    s_cmp_ge_u32 s2, 240
    s_cbranch_scc1 L_nomod_3
    s_mov_b32 s25, 491520
    s_mov_b32 s26, 983040
    buffer_load_dwordx4 v[32:35], v9, s[48:51], 0 offen
    buffer_load_dwordx4 v[36:39], v9, s[48:51], s25 offen
    buffer_load_dwordx4 v[40:43], v11, s[48:51], s26 offen
    buffer_load_ushort v16, v8, s[52:55], 0 offen
    buffer_load_ushort v17, v8, s[52:55], 0 offen offset:128
    buffer_load_ushort v18, v12, s[52:55], 0 offen offset:256
L_nomod_3:
    buffer_load_dwordx4 v[92:95], v91, s[64:67], 0 offen
    s_cmp_ge_u32 s3, 2
    s_cbranch_scc1 L_two_4
    buffer_load_dwordx4 v[96:99], v91, s[64:67], 0 offen offset:1024
    s_nop 1
L_two_4:
    s_or_b32 s25, s2, s3
    s_cmp_lg_u32 s25, 0
    s_cbranch_scc1 L_np_5
    s_memrealtime s[26:27]
    s_waitcnt lgkmcnt(0)
    s_and_b32 s25, s26, 0xfffffff0
    s_or_b32 s25, s25, 16
    v_mov_b32 v250, s25
    v_lshlrev_b32 v251, 6, v0
    s_mov_b64 exec, 15
    buffer_store_dword v250, v251, s[20:23], 0 offen sc1
    s_mov_b64 exec, -1
L_np_5:
    s_cmp_lg_u32 s2, 1
    s_cbranch_scc1 L_pt_6
    s_cmp_ge_u32 s3, 7
    s_cbranch_scc1 L_pt_6
    s_lshl_b32 s25, s3, 13
    s_add_u32 s25, s25, 0x8000
    v_lshlrev_b32 v251, 7, v0
    buffer_load_dword v250, v251, s[4:7], s25 offen
L_pt_6:
    s_cmp_lg_u32 s3, 7
    s_cbranch_scc1 L_cpf_7
    s_getpc_b64 s[92:93]
L_pc_8:
    s_sub_u32 s92, s92, L_pc_8-adaLN_cond__sliding_block_cached__mixer_s_mlp__prompt_kernel
    s_subb_u32 s93, s93, 0
    s_and_b32 s93, s93, 0xffff
    s_mov_b32 s94, L_exit_main-adaLN_cond__sliding_block_cached__mixer_s_mlp__prompt_kernel+4
    s_mov_b32 s95, 0x20000
    s_lshr_b32 s25, s2, 3
    s_lshl_b32 s25, s25, 11
    v_lshlrev_b32 v240, 4, v0
    buffer_load_dwordx4 v[244:247], v240, s[92:95], s25 offen
    buffer_load_dwordx4 v[244:247], v240, s[92:95], s25 offen offset:1024
L_cpf_7:
    s_cmp_lg_u32 s3, 0
    s_cbranch_scc1 L_w0_9
    s_and_b32 s25, s2, 3
    s_lshl_b32 s25, s25, 6
    v_mov_b32 v251, s25
    buffer_load_dword v248, v251, s[20:23], 0 offen sc1
L_w0_9:
    s_and_b32 s45, s2, 3
    s_lshl_b32 s45, s45, 3
    s_bfe_u32 s46, s2, 0x30003
    s_add_u32 s40, s45, s46
    s_bfe_u32 s45, s2, 0x10002
    s_lshl_b32 s45, s45, 2
    s_lshr_b32 s46, s2, 6
    s_add_u32 s41, s45, s46
    s_mul_i32 s45, s40, 524288
    s_add_u32 s45, s45, 393216
    s_mov_b32 s12, s56
    s_mov_b32 s13, s57
    s_mov_b32 s14, s62
    s_mov_b32 s15, s63
    s_mov_b32 s8, s68
    s_mov_b32 s9, s69
    s_add_u32 s16, s14, s45
    s_addc_u32 s17, s15, 0
    s_and_b32 s17, s17, 0xffff
    s_mov_b32 s18, 131072
    s_mov_b32 s19, 0x20000
    s_add_u32 s12, s12, s45
    s_addc_u32 s13, s13, 0
    s_and_b32 s13, s13, 0xffff
    s_mov_b32 s14, 131072
    s_mov_b32 s15, 0x20000
    s_and_b32 s9, s9, 0xffff
    s_mov_b32 s10, 5242880
    s_mov_b32 s11, 0x20000
    v_lshrrev_b32 v8, 4, v0
    s_lshl_b32 s45, s3, 3
    v_add_u32 v9, s45, v8
    v_and_b32 v10, 15, v0
    v_lshlrev_b32 v11, 8, v9
    v_and_b32 v12, 15, v9
    v_xor_b32 v13, v10, v12
    v_lshlrev_b32 v13, 4, v13
    v_add_u32 v5, v11, v13
    v_xor_b32 v12, 4, v12
    v_xor_b32 v13, v10, v12
    v_lshlrev_b32 v13, 4, v13
    v_add_u32 v6, v11, v13
    v_lshlrev_b32 v12, 2, v8
    v_xor_b32 v13, v10, v12
    v_lshlrev_b32 v13, 4, v13
    v_add_u32 v7, v11, v13
    v_lshlrev_b32 v11, 13, v9
    v_add_u32 v11, v11, v13
    s_lshl_b32 s45, s40, 8
    v_add_u32 v4, s45, v11
    s_lshl_b32 s43, s3, 11
    s_add_u32 s44, s43, 65536
    s_mov_b32 s47, 0
    s_add_u32 m0, s43, 49152
    s_nop 0
    buffer_load_dwordx4 v4, s[8:11], s47 offen lds
    s_mov_b32 s47, 32768
    s_add_u32 m0, s43, 50176
    s_nop 0
    buffer_load_dwordx4 v4, s[8:11], s47 offen lds
    s_mov_b32 s47, 524288
    s_add_u32 m0, s43, 114688
    s_nop 0
    buffer_load_dwordx4 v4, s[8:11], s47 offen lds
    s_mov_b32 s47, 557056
    s_add_u32 m0, s43, 115712
    s_nop 0
    buffer_load_dwordx4 v4, s[8:11], s47 offen lds
    s_cmp_ge_u32 s2, 240
    s_cbranch_scc1 L_nomod2_10
    s_waitcnt vmcnt(5)
    s_cmp_lt_u32 s2, 80
    s_cbranch_scc0 L_mt_11
    s_mul_i32 s31, s2, 205
    s_lshr_b32 s31, s31, 12
    s_mul_i32 s30, s31, 20
    s_sub_u32 s30, s2, s30
    s_branch L_mt_12
L_mt_11:
    s_sub_u32 s30, s2, 80
    s_mul_i32 s31, s30, 103
    s_lshr_b32 s31, s31, 12
    s_mul_i32 s25, s31, 40
    s_sub_u32 s30, s30, s25
    s_add_u32 s30, s30, 20
L_mt_12:
    s_mov_b32 s25, 0xbfb8aa3b
    v_lshlrev_b32 v16, 16, v16
    v_mul_f32 v20, s25, v16
    v_lshlrev_b32 v17, 16, v17
    v_mul_f32 v21, s25, v17
    v_lshlrev_b32 v18, 16, v18
    v_mul_f32 v22, s25, v18
    v_exp_f32 v20, v20
    v_exp_f32 v21, v21
    v_exp_f32 v22, v22
    v_add_f32 v20, 1.0, v20
    v_add_f32 v21, 1.0, v21
    v_add_f32 v22, 1.0, v22
    v_rcp_f32 v20, v20
    v_rcp_f32 v21, v21
    v_rcp_f32 v22, v22
    v_mul_f32 v20, v16, v20
    v_mul_f32 v21, v17, v21
    v_mul_f32 v22, v18, v22
    v_cvt_pk_bf16_f32 v20, v20, v20
    v_lshlrev_b32 v16, 16, v20
    v_cvt_pk_bf16_f32 v21, v21, v21
    v_lshlrev_b32 v17, 16, v21
    v_cvt_pk_bf16_f32 v22, v22, v22
    v_lshlrev_b32 v18, 16, v22
    v_lshlrev_b32 v26, 16, v32
    v_and_b32 v27, 0xffff0000, v32
    v_mul_f32 v80, v16, v26
    v_mul_f32 v81, v16, v27
    v_lshlrev_b32 v26, 16, v33
    v_and_b32 v27, 0xffff0000, v33
    v_mul_f32 v82, v16, v26
    v_mul_f32 v83, v16, v27
    v_lshlrev_b32 v26, 16, v34
    v_and_b32 v27, 0xffff0000, v34
    v_mul_f32 v84, v16, v26
    v_mul_f32 v85, v16, v27
    v_lshlrev_b32 v26, 16, v35
    v_and_b32 v27, 0xffff0000, v35
    v_mul_f32 v86, v16, v26
    v_mul_f32 v87, v16, v27
    v_lshlrev_b32 v26, 16, v36
    v_and_b32 v27, 0xffff0000, v36
    v_fmac_f32 v80, v17, v26
    v_fmac_f32 v81, v17, v27
    v_lshlrev_b32 v26, 16, v37
    v_and_b32 v27, 0xffff0000, v37
    v_fmac_f32 v82, v17, v26
    v_fmac_f32 v83, v17, v27
    v_lshlrev_b32 v26, 16, v38
    v_and_b32 v27, 0xffff0000, v38
    v_fmac_f32 v84, v17, v26
    v_fmac_f32 v85, v17, v27
    v_lshlrev_b32 v26, 16, v39
    v_and_b32 v27, 0xffff0000, v39
    v_fmac_f32 v86, v17, v26
    v_fmac_f32 v87, v17, v27
    v_lshlrev_b32 v26, 16, v40
    v_and_b32 v27, 0xffff0000, v40
    v_fmac_f32 v80, v18, v26
    v_fmac_f32 v81, v18, v27
    v_lshlrev_b32 v26, 16, v41
    v_and_b32 v27, 0xffff0000, v41
    v_fmac_f32 v82, v18, v26
    v_fmac_f32 v83, v18, v27
    v_lshlrev_b32 v26, 16, v42
    v_and_b32 v27, 0xffff0000, v42
    v_fmac_f32 v84, v18, v26
    v_fmac_f32 v85, v18, v27
    v_lshlrev_b32 v26, 16, v43
    v_and_b32 v27, 0xffff0000, v43
    v_fmac_f32 v86, v18, v26
    v_fmac_f32 v87, v18, v27
    v_add_f32_dpp v80, v80, v80 row_ror:8 row_mask:0xf bank_mask:0xf
    v_add_f32_dpp v81, v81, v81 row_ror:8 row_mask:0xf bank_mask:0xf
    v_add_f32_dpp v82, v82, v82 row_ror:8 row_mask:0xf bank_mask:0xf
    v_add_f32_dpp v83, v83, v83 row_ror:8 row_mask:0xf bank_mask:0xf
    v_add_f32_dpp v84, v84, v84 row_ror:8 row_mask:0xf bank_mask:0xf
    v_add_f32_dpp v85, v85, v85 row_ror:8 row_mask:0xf bank_mask:0xf
    v_add_f32_dpp v86, v86, v86 row_ror:8 row_mask:0xf bank_mask:0xf
    v_add_f32_dpp v87, v87, v87 row_ror:8 row_mask:0xf bank_mask:0xf
    v_mov_b32 v32, v80
    v_mov_b32 v33, v81
    v_mov_b32 v34, v82
    v_mov_b32 v35, v83
    v_mov_b32 v36, v84
    v_mov_b32 v37, v85
    v_mov_b32 v38, v86
    v_mov_b32 v39, v87
    v_permlane16_swap_b32 v80, v32
    v_permlane16_swap_b32 v81, v33
    v_permlane16_swap_b32 v82, v34
    v_permlane16_swap_b32 v83, v35
    v_permlane16_swap_b32 v84, v36
    v_permlane16_swap_b32 v85, v37
    v_permlane16_swap_b32 v86, v38
    v_permlane16_swap_b32 v87, v39
    v_add_f32 v80, v80, v32
    v_add_f32 v81, v81, v33
    v_add_f32 v82, v82, v34
    v_add_f32 v83, v83, v35
    v_add_f32 v84, v84, v36
    v_add_f32 v85, v85, v37
    v_add_f32 v86, v86, v38
    v_add_f32 v87, v87, v39
    v_mov_b32 v32, v80
    v_mov_b32 v33, v81
    v_mov_b32 v34, v82
    v_mov_b32 v35, v83
    v_mov_b32 v36, v84
    v_mov_b32 v37, v85
    v_mov_b32 v38, v86
    v_mov_b32 v39, v87
    v_permlane32_swap_b32 v80, v32
    v_permlane32_swap_b32 v81, v33
    v_permlane32_swap_b32 v82, v34
    v_permlane32_swap_b32 v83, v35
    v_permlane32_swap_b32 v84, v36
    v_permlane32_swap_b32 v85, v37
    v_permlane32_swap_b32 v86, v38
    v_permlane32_swap_b32 v87, v39
    v_add_f32 v80, v80, v32
    v_add_f32 v81, v81, v33
    v_add_f32 v82, v82, v34
    v_add_f32 v83, v83, v35
    v_add_f32 v84, v84, v36
    v_add_f32 v85, v85, v37
    v_add_f32 v86, v86, v38
    v_add_f32 v87, v87, v39
    s_lshl_b32 s25, s3, 8
    s_add_u32 s25, s25, 149504
    v_lshlrev_b32 v2, 5, v0
    v_add_u32 v2, s25, v2
    s_mov_b64 exec, 0xff
    ds_write_b128 v2, v[80:83]
    ds_write_b128 v2, v[84:87] offset:16
    s_mov_b64 exec, -1
    s_waitcnt lgkmcnt(0)
    s_barrier
    s_cmp_lg_u32 s3, 0
    s_cbranch_scc1 L_mc_13
    v_lshlrev_b32 v2, 2, v0
    v_add_u32 v3, 149504, v2
    ds_read_b32 v80, v3 offset:0
    ds_read_b32 v81, v3 offset:256
    ds_read_b32 v82, v3 offset:512
    ds_read_b32 v83, v3 offset:768
    ds_read_b32 v84, v3 offset:1024
    ds_read_b32 v85, v3 offset:1280
    ds_read_b32 v86, v3 offset:1536
    ds_read_b32 v87, v3 offset:1792
    s_waitcnt lgkmcnt(0)
    v_add_f32 v80, v80, v81
    v_add_f32 v82, v82, v83
    v_add_f32 v84, v84, v85
    v_add_f32 v86, v86, v87
    v_add_f32 v80, v80, v82
    v_add_f32 v84, v84, v86
    v_add_f32 v80, v80, v84
    s_mul_i32 s25, s31, 15360
    s_lshl_b32 s26, s30, 8
    s_add_u32 s25, s25, s26
    s_add_u32 s25, s25, 262144
    buffer_store_dword v80, v2, s[4:7], s25 offen sc1
L_mc_13:
L_nomod2_10:
    s_cmp_lg_u32 s3, 0
    s_cbranch_scc1 L_ng_14
    s_waitcnt vmcnt(0)
    v_readfirstlane_b32 s24, v248
    s_nop 0
    s_cmp_eq_u32 s24, 0
    s_cbranch_scc1 L_nf_17
    s_memrealtime s[26:27]
    s_waitcnt lgkmcnt(0)
    s_sub_u32 s26, s26, s24
    s_add_u32 s26, s26, 64
    s_cmp_lt_u32 s26, 4096
    s_cbranch_scc1 L_ngd_16
L_nf_17:
    s_load_dwordx2 s[20:21], s[0:1], 104
    s_waitcnt lgkmcnt(0)
    s_and_b32 s21, s21, 0xffff
    s_mov_b32 s22, 256
    s_mov_b32 s23, 0x20000
    s_and_b32 s25, s2, 3
    s_lshl_b32 s25, s25, 6
    v_mov_b32 v251, s25
    s_mov_b32 s58, 0
L_ngp_15:
    buffer_load_dword v250, v251, s[20:23], 0 offen sc1
    s_waitcnt vmcnt(0)
    v_readfirstlane_b32 s24, v250
    s_nop 0
    s_cmp_eq_u32 s24, 0
    s_cbranch_scc1 L_nf_18
    s_memrealtime s[26:27]
    s_waitcnt lgkmcnt(0)
    s_sub_u32 s26, s26, s24
    s_add_u32 s26, s26, 64
    s_cmp_lt_u32 s26, 4096
    s_cbranch_scc1 L_ngd_16
L_nf_18:
    s_sleep 2
    s_add_u32 s58, s58, 1
    s_cmp_lt_u32 s58, 400
    s_cbranch_scc1 L_ngp_15
    s_cmp_lg_u32 s24, 0
    s_cbranch_scc1 L_ngd_16
    s_cmp_lt_u32 s58, 32768
    s_cbranch_scc1 L_ngp_15
L_ngd_16:
    s_getreg_b32 s28, hwreg(HW_REG_XCC_ID, 0, 4)
    s_and_b32 s59, s2, 7
    s_lshl_b32 s59, s59, 7
    s_lshr_b32 s25, s2, 3
    s_lshl_b32 s25, s25, 2
    s_add_u32 s59, s59, s25
    s_add_u32 s59, s59, 34816
    s_or_b32 s25, s24, s28
    v_mov_b32 v250, s25
    v_mov_b32 v251, 0
    s_mov_b64 exec, 1
    buffer_atomic_swap v250, v251, s[4:7], s59 offen
    s_mov_b64 exec, -1
L_ng_14:
    s_cmp_lg_u32 s3, 0
    s_cbranch_scc1 L_w0_20
    s_cmp_ge_u32 s2, 240
    s_cbranch_scc1 L_nm3_21
    s_lshl_b32 s59, s2, 2
    s_add_u32 s59, s59, 65536
    v_mov_b32 v250, s24
    v_mul_u32_u24 v251, 1024, v0
    s_mov_b64 exec, 255
    buffer_atomic_swap v250, v251, s[4:7], s59 offen
    s_mov_b64 exec, -1
L_nm3_21:
    v_mov_b32 v250, s24
    v_mov_b32 v251, 156928
    ds_write_b32 v251, v250
    s_waitcnt lgkmcnt(0)
L_w0_20:
    s_waitcnt vmcnt(4)
    v_lshlrev_b32 v100, 16, v92
    v_and_b32 v101, 0xffff0000, v92
    v_lshlrev_b32 v102, 16, v93
    v_and_b32 v103, 0xffff0000, v93
    v_lshlrev_b32 v104, 16, v94
    v_and_b32 v105, 0xffff0000, v94
    v_lshlrev_b32 v106, 16, v95
    v_and_b32 v107, 0xffff0000, v95
    s_cmp_ge_u32 s3, 2
    s_cbranch_scc1 L_two_22
    v_lshlrev_b32 v108, 16, v96
    v_and_b32 v109, 0xffff0000, v96
    v_lshlrev_b32 v110, 16, v97
    v_and_b32 v111, 0xffff0000, v97
    v_lshlrev_b32 v112, 16, v98
    v_and_b32 v113, 0xffff0000, v98
    v_lshlrev_b32 v114, 16, v99
    v_and_b32 v115, 0xffff0000, v99
    s_nop 1
L_two_22:
    v_add_f32 v116, v100, v101
    v_mul_f32 v117, v100, v100
    v_fmac_f32 v117, v101, v101
    v_add_f32 v116, v116, v102
    v_fmac_f32 v117, v102, v102
    v_add_f32 v116, v116, v103
    v_fmac_f32 v117, v103, v103
    v_add_f32 v116, v116, v104
    v_fmac_f32 v117, v104, v104
    v_add_f32 v116, v116, v105
    v_fmac_f32 v117, v105, v105
    v_add_f32 v116, v116, v106
    v_fmac_f32 v117, v106, v106
    v_add_f32 v116, v116, v107
    v_fmac_f32 v117, v107, v107
    s_cmp_ge_u32 s3, 2
    s_cbranch_scc1 L_two_23
    v_add_f32 v116, v116, v108
    v_fmac_f32 v117, v108, v108
    v_add_f32 v116, v116, v109
    v_fmac_f32 v117, v109, v109
    v_add_f32 v116, v116, v110
    v_fmac_f32 v117, v110, v110
    v_add_f32 v116, v116, v111
    v_fmac_f32 v117, v111, v111
    v_add_f32 v116, v116, v112
    v_fmac_f32 v117, v112, v112
    v_add_f32 v116, v116, v113
    v_fmac_f32 v117, v113, v113
    v_add_f32 v116, v116, v114
    v_fmac_f32 v117, v114, v114
    v_add_f32 v116, v116, v115
    v_fmac_f32 v117, v115, v115
    s_nop 1
L_two_23:
    v_add_f32_dpp v116, v116, v116 row_ror:8 row_mask:0xf bank_mask:0xf
    v_add_f32_dpp v117, v117, v117 row_ror:8 row_mask:0xf bank_mask:0xf
    v_mov_b32 v118, v116
    s_nop 1
    v_permlane16_swap_b32 v116, v118
    v_add_f32 v116, v116, v118
    v_mov_b32 v118, v116
    s_nop 1
    v_permlane32_swap_b32 v116, v118
    v_add_f32 v116, v116, v118
    v_mov_b32 v119, v117
    s_nop 1
    v_permlane16_swap_b32 v117, v119
    v_add_f32 v117, v117, v119
    v_mov_b32 v119, v117
    s_nop 1
    v_permlane32_swap_b32 v117, v119
    v_add_f32 v117, v117, v119
    v_lshlrev_b32 v118, 6, v0
    s_lshl_b32 s30, s3, 3
    s_add_u32 s30, s30, 147456
    v_add_u32 v118, s30, v118
    s_mov_b64 exec, 0xff
    ds_write_b64 v118, v[116:117]
    s_mov_b64 exec, -1
    s_waitcnt lgkmcnt(0)
    s_barrier
    v_and_b32 v118, 7, v0
    v_lshlrev_b32 v118, 6, v118
    v_add_u32 v118, 147456, v118
    ds_read_b128 v[120:123], v118 offset:0
    ds_read_b128 v[124:127], v118 offset:16
    s_waitcnt lgkmcnt(0)
    v_add_f32 v116, v120, v122
    v_add_f32 v117, v121, v123
    v_add_f32 v116, v116, v124
    v_add_f32 v117, v117, v125
    v_add_f32 v116, v116, v126
    v_add_f32 v117, v117, v127
    ds_read_b128 v[120:123], v118 offset:32
    ds_read_b128 v[124:127], v118 offset:48
    s_waitcnt lgkmcnt(0)
    v_add_f32 v116, v116, v120
    v_add_f32 v117, v117, v121
    v_add_f32 v116, v116, v122
    v_add_f32 v117, v117, v123
    v_add_f32 v116, v116, v124
    v_add_f32 v117, v117, v125
    v_add_f32 v116, v116, v126
    v_add_f32 v117, v117, v127
    v_mul_f32 v116, 0x3acccccd, v116
    v_mul_f32 v117, 0x3acccccd, v117
    v_fma_f32 v117, -v116, v116, v117
    v_max_f32 v117, 0, v117
    v_add_f32 v117, 0x3727c5ac, v117
    v_rsq_f32 v117, v117
    v_sub_f32 v100, v100, v116
    v_mul_f32 v100, v100, v117
    v_sub_f32 v101, v101, v116
    v_mul_f32 v101, v101, v117
    v_sub_f32 v102, v102, v116
    v_mul_f32 v102, v102, v117
    v_sub_f32 v103, v103, v116
    v_mul_f32 v103, v103, v117
    v_sub_f32 v104, v104, v116
    v_mul_f32 v104, v104, v117
    v_sub_f32 v105, v105, v116
    v_mul_f32 v105, v105, v117
    v_sub_f32 v106, v106, v116
    v_mul_f32 v106, v106, v117
    v_sub_f32 v107, v107, v116
    v_mul_f32 v107, v107, v117
    v_cvt_pk_bf16_f32 v118, v100, v101
    v_lshlrev_b32 v100, 16, v118
    v_and_b32 v101, 0xffff0000, v118
    v_cvt_pk_bf16_f32 v118, v102, v103
    v_lshlrev_b32 v102, 16, v118
    v_and_b32 v103, 0xffff0000, v118
    v_cvt_pk_bf16_f32 v118, v104, v105
    v_lshlrev_b32 v104, 16, v118
    v_and_b32 v105, 0xffff0000, v118
    v_cvt_pk_bf16_f32 v118, v106, v107
    v_lshlrev_b32 v106, 16, v118
    v_and_b32 v107, 0xffff0000, v118
    s_cmp_ge_u32 s3, 2
    s_cbranch_scc1 L_two_24
    v_sub_f32 v108, v108, v116
    v_mul_f32 v108, v108, v117
    v_sub_f32 v109, v109, v116
    v_mul_f32 v109, v109, v117
    v_sub_f32 v110, v110, v116
    v_mul_f32 v110, v110, v117
    v_sub_f32 v111, v111, v116
    v_mul_f32 v111, v111, v117
    v_sub_f32 v112, v112, v116
    v_mul_f32 v112, v112, v117
    v_sub_f32 v113, v113, v116
    v_mul_f32 v113, v113, v117
    v_sub_f32 v114, v114, v116
    v_mul_f32 v114, v114, v117
    v_sub_f32 v115, v115, v116
    v_mul_f32 v115, v115, v117
    v_cvt_pk_bf16_f32 v118, v108, v109
    v_lshlrev_b32 v108, 16, v118
    v_and_b32 v109, 0xffff0000, v118
    v_cvt_pk_bf16_f32 v118, v110, v111
    v_lshlrev_b32 v110, 16, v118
    v_and_b32 v111, 0xffff0000, v118
    v_cvt_pk_bf16_f32 v118, v112, v113
    v_lshlrev_b32 v112, 16, v118
    v_and_b32 v113, 0xffff0000, v118
    v_cvt_pk_bf16_f32 v118, v114, v115
    v_lshlrev_b32 v114, 16, v118
    v_and_b32 v115, 0xffff0000, v118
    s_nop 1
L_two_24:
    v_mov_b32 v251, 156928
    ds_read_b32 v250, v251
    s_waitcnt lgkmcnt(0)
    v_readfirstlane_b32 s24, v250
    s_cmp_lg_u32 s3, 0
    s_cbranch_scc1 L_w0_25
    s_and_b32 s59, s2, 7
    s_lshl_b32 s59, s59, 10
    s_add_u32 s59, s59, 65536
    v_lshlrev_b32 v251, 3, v0
    s_mov_b32 s58, 0
    s_mov_b32 s60, 0xffffffff
    s_mov_b32 s61, 0xff
    s_mov_b64 exec, s[60:61]
L_poll_26:
    buffer_load_dwordx2 v[252:253], v251, s[4:7], s59 offen sc1
    s_waitcnt vmcnt(0)
    v_xor_b32 v252, s24, v252
    v_xor_b32 v253, s24, v253
    v_or_b32 v252, v252, v253
    v_cmp_ne_u32 vcc, 0, v252
    s_nop 1
    s_and_b64 vcc, vcc, s[60:61]
    s_cbranch_scc0 L_polld_27
    s_sleep 1
    s_add_u32 s58, s58, 1
    s_cmp_lt_u32 s58, 32768
    s_cbranch_scc1 L_poll_26
    s_load_dwordx2 s[20:21], s[0:1], 104
    s_waitcnt lgkmcnt(0)
    s_and_b32 s21, s21, 0xffff
    s_mov_b32 s22, 256
    s_mov_b32 s23, 0x20000
    v_mov_b32 v253, 0xdead0001
    v_mov_b32 v251, 8
    s_mov_b64 exec, 1
    buffer_store_dword v253, v251, s[20:23], 0 offen
L_polld_27:
    s_mov_b64 exec, -1
L_w0_25:
    s_barrier
    s_lshl_b32 s25, s3, 6
    v_add_u32 v1, s25, v0
    v_lshlrev_b32 v1, 4, v1
    s_cmp_ge_u32 s3, 5
    s_cbranch_scc1 L_tb_28
    s_mov_b32 s25, 262144
    buffer_load_dwordx4 v[128:131], v1, s[4:7], s25 offen sc1
    s_mov_b32 s25, 277504
    buffer_load_dwordx4 v[132:135], v1, s[4:7], s25 offen sc1
    s_mov_b32 s25, 292864
    buffer_load_dwordx4 v[136:139], v1, s[4:7], s25 offen sc1
    s_mov_b32 s25, 308224
    buffer_load_dwordx4 v[140:143], v1, s[4:7], s25 offen sc1
    s_waitcnt vmcnt(0)
    v_add_f32 v128, v128, v132
    v_add_f32 v136, v136, v140
    v_add_f32 v128, v128, v136
    v_add_f32 v129, v129, v133
    v_add_f32 v137, v137, v141
    v_add_f32 v129, v129, v137
    v_add_f32 v130, v130, v134
    v_add_f32 v138, v138, v142
    v_add_f32 v130, v130, v138
    v_add_f32 v131, v131, v135
    v_add_f32 v139, v139, v143
    v_add_f32 v131, v131, v139
    v_cvt_pk_bf16_f32 v132, v128, v129
    v_lshlrev_b32 v128, 16, v132
    v_and_b32 v129, 0xffff0000, v132
    v_cvt_pk_bf16_f32 v132, v130, v131
    v_lshlrev_b32 v130, 16, v132
    v_and_b32 v131, 0xffff0000, v132
    v_cmp_le_u32 vcc, 2560, v1
    v_add_f32 v132, 1.0, v128
    v_add_f32 v133, 1.0, v129
    v_add_f32 v134, 1.0, v130
    v_add_f32 v135, 1.0, v131
    v_cvt_pk_bf16_f32 v136, v132, v133
    v_lshlrev_b32 v132, 16, v136
    v_and_b32 v133, 0xffff0000, v136
    v_cvt_pk_bf16_f32 v136, v134, v135
    v_lshlrev_b32 v134, 16, v136
    v_and_b32 v135, 0xffff0000, v136
    v_cndmask_b32 v128, v128, v132, vcc
    v_cndmask_b32 v129, v129, v133, vcc
    v_cndmask_b32 v130, v130, v134, vcc
    v_cndmask_b32 v131, v131, v135, vcc
    v_add_u32 v1, 151552, v1
    ds_write_b128 v1, v[128:131]
    s_waitcnt lgkmcnt(0)
L_tb_28:
    s_barrier
    v_lshlrev_b32 v91, 5, v89
    v_add_u32 v91, 151552, v91
    v_lshlrev_b32 v119, 9, v89
    v_lshl_add_u32 v119, v90, 4, v119
    s_lshr_b32 s30, s34, 2
    s_mul_i32 s30, s30, 40960
    s_and_b32 s31, s34, 3
    s_lshl_b32 s31, s31, 7
    s_add_u32 s30, s30, s31
    v_add_u32 v119, s30, v119
    s_mov_b32 s35, 0x3e0293ee
    ds_read_b128 v[128:131], v91 offset:0
    ds_read_b128 v[132:135], v91 offset:16
    ds_read_b128 v[136:139], v91 offset:2560
    ds_read_b128 v[140:143], v91 offset:2576
    s_waitcnt lgkmcnt(0)
    v_fma_f32 v100, v100, v136, v128
    v_fma_f32 v101, v101, v137, v129
    v_fma_f32 v102, v102, v138, v130
    v_fma_f32 v103, v103, v139, v131
    v_fma_f32 v104, v104, v140, v132
    v_fma_f32 v105, v105, v141, v133
    v_fma_f32 v106, v106, v142, v134
    v_fma_f32 v107, v107, v143, v135
    v_mul_f32 v100, s35, v100
    v_mul_f32 v101, s35, v101
    v_mul_f32 v102, s35, v102
    v_mul_f32 v103, s35, v103
    v_mul_f32 v104, s35, v104
    v_mul_f32 v105, s35, v105
    v_mul_f32 v106, s35, v106
    v_mul_f32 v107, s35, v107
    v_cvt_pk_bf16_f32 v92, v100, v101
    v_cvt_pk_bf16_f32 v93, v102, v103
    v_cvt_pk_bf16_f32 v94, v104, v105
    v_cvt_pk_bf16_f32 v95, v106, v107
    s_mov_b32 s36, 1048576
    buffer_store_dwordx4 v[92:95], v119, s[4:7], s36 offen sc1
    s_cmp_ge_u32 s3, 2
    s_cbranch_scc1 L_two_29
    ds_read_b128 v[128:131], v91 offset:2048
    ds_read_b128 v[132:135], v91 offset:2064
    ds_read_b128 v[136:139], v91 offset:4608
    ds_read_b128 v[140:143], v91 offset:4624
    s_waitcnt lgkmcnt(0)
    v_fma_f32 v108, v108, v136, v128
    v_fma_f32 v109, v109, v137, v129
    v_fma_f32 v110, v110, v138, v130
    v_fma_f32 v111, v111, v139, v131
    v_fma_f32 v112, v112, v140, v132
    v_fma_f32 v113, v113, v141, v133
    v_fma_f32 v114, v114, v142, v134
    v_fma_f32 v115, v115, v143, v135
    v_mul_f32 v108, s35, v108
    v_mul_f32 v109, s35, v109
    v_mul_f32 v110, s35, v110
    v_mul_f32 v111, s35, v111
    v_mul_f32 v112, s35, v112
    v_mul_f32 v113, s35, v113
    v_mul_f32 v114, s35, v114
    v_mul_f32 v115, s35, v115
    v_cvt_pk_bf16_f32 v96, v108, v109
    v_cvt_pk_bf16_f32 v97, v110, v111
    v_cvt_pk_bf16_f32 v98, v112, v113
    v_cvt_pk_bf16_f32 v99, v114, v115
    s_mov_b32 s36, 1081344
    buffer_store_dwordx4 v[96:99], v119, s[4:7], s36 offen sc1
    s_nop 1
L_two_29:
    s_waitcnt vmcnt(0)
    s_barrier
    s_cmp_lg_u32 s3, 0
    s_cbranch_scc1 L_w0_30
    s_lshl_b32 s59, s2, 2
    s_add_u32 s59, s59, 35840
    v_mov_b32 v250, s24
    v_mov_b32 v251, 0
    s_mov_b64 exec, 1
    buffer_atomic_swap v250, v251, s[4:7], s59 offen
    s_mov_b64 exec, -1
L_w0_30:
    s_mov_b32 s47, 1048576
    s_add_u32 m0, s43, 131072
    s_nop 0
    buffer_load_dwordx4 v4, s[8:11], s47 offen lds
    s_mov_b32 s47, 1081344
    s_add_u32 m0, s43, 132096
    s_nop 0
    buffer_load_dwordx4 v4, s[8:11], s47 offen lds
    v_lshrrev_b32 v8, 3, v0
    v_and_b32 v9, 7, v0
    v_lshlrev_b32 v9, 4, v9
    s_lshl_b32 s62, s2, 3
    s_add_u32 s62, s62, s3
    s_cmp_lt_u32 s62, 1280
    s_cbranch_scc1 L_rp_31
    s_cmp_lt_u32 s62, 1480
    s_cbranch_scc1 L_rp_32
    s_cmp_lt_u32 s62, 1680
    s_cbranch_scc1 L_rp_33
    s_cmp_lt_u32 s62, 2220
    s_cbranch_scc1 L_rp_34
    s_cmp_lt_u32 s62, 2760
    s_cbranch_scc1 L_rp_35
    s_branch L_rpd_37
L_rp_31:
    s_load_dwordx2 s[72:73], s[0:1], 32
    s_mov_b32 s74, 5242880
    s_sub_u32 s65, s62, 0
    s_mov_b32 s66, 429496730
    s_mul_hi_u32 s66, s65, s66
    s_mul_i32 s67, s66, 10
    s_sub_u32 s65, s65, s67
    s_movk_i32 s63, 1280
    s_mul_i32 s84, s65, 524288
    s_lshl_b32 s67, s66, 10
    s_add_u32 s84, s84, s67
    s_add_u32 s84, s84, 4194304
    s_mov_b32 s86, 131072
    s_branch L_rpc_36
L_rp_32:
    s_load_dwordx2 s[72:73], s[0:1], 48
    s_mov_b32 s74, 819200
    s_sub_u32 s65, s62, 1280
    s_mov_b32 s66, 429496730
    s_mul_hi_u32 s66, s65, s66
    s_mul_i32 s67, s66, 10
    s_sub_u32 s65, s65, s67
    s_movk_i32 s63, 1280
    s_mul_i32 s84, s65, 81920
    s_lshl_b32 s67, s66, 10
    s_add_u32 s84, s84, s67
    s_add_u32 s84, s84, 9437184
    s_mov_b32 s86, 20480
    s_branch L_rpc_36
L_rp_33:
    s_load_dwordx2 s[72:73], s[0:1], 56
    s_mov_b32 s74, 819200
    s_sub_u32 s65, s62, 1480
    s_mov_b32 s66, 429496730
    s_mul_hi_u32 s66, s65, s66
    s_mul_i32 s67, s66, 10
    s_sub_u32 s65, s65, s67
    s_movk_i32 s63, 1280
    s_mul_i32 s84, s65, 81920
    s_lshl_b32 s67, s66, 10
    s_add_u32 s84, s84, s67
    s_add_u32 s84, s84, 10485760
    s_mov_b32 s86, 20480
    s_branch L_rpc_36
L_rp_34:
    s_load_dwordx2 s[72:73], s[0:1], 64
    s_mov_b32 s74, 2211840
    s_sub_u32 s65, s62, 1680
    s_mov_b32 s66, 159072863
    s_mul_hi_u32 s66, s65, s66
    s_mul_i32 s67, s66, 27
    s_sub_u32 s65, s65, s67
    s_movk_i32 s63, 3456
    s_mul_i32 s84, s65, 81920
    s_lshl_b32 s67, s66, 10
    s_add_u32 s84, s84, s67
    s_add_u32 s84, s84, 11534336
    s_mov_b32 s86, 20480
    s_branch L_rpc_36
L_rp_35:
    s_load_dwordx2 s[72:73], s[0:1], 72
    s_mov_b32 s74, 2211840
    s_sub_u32 s65, s62, 2220
    s_mov_b32 s66, 429496730
    s_mul_hi_u32 s66, s65, s66
    s_mul_i32 s67, s66, 10
    s_sub_u32 s65, s65, s67
    s_movk_i32 s63, 1280
    s_mul_i32 s84, s65, 221184
    s_lshl_b32 s67, s66, 10
    s_add_u32 s84, s84, s67
    s_add_u32 s84, s84, 14680064
    s_mov_b32 s86, 55296
    s_branch L_rpc_36
L_rpd_37:
    s_load_dwordx2 s[72:73], s[0:1], 32
    s_mov_b32 s74, 0
    s_mov_b32 s65, 0
    s_mov_b32 s66, 0
    s_movk_i32 s63, 1280
    s_mov_b32 s84, 0x7ff00000
    s_mov_b32 s86, 0
L_rpc_36:
    s_mul_i32 s66, s66, s63
    s_lshl_b32 s66, s66, 5
    s_lshl_b32 s65, s65, 7
    s_add_u32 s80, s66, s65
    v_mul_lo_u32 v24, v8, s63
    v_add_u32 v24, v24, v9
    s_lshl_b32 s82, s63, 3
    s_lshl_b32 s62, s2, 3
    s_add_u32 s62, s62, s3
    s_add_u32 s62, s62, 2048
    s_cmp_lt_u32 s62, 2220
    s_cbranch_scc1 L_rp_39
    s_cmp_lt_u32 s62, 2760
    s_cbranch_scc1 L_rp_40
    s_branch L_rpd_42
L_rp_39:
    s_load_dwordx2 s[76:77], s[0:1], 64
    s_mov_b32 s78, 2211840
    s_sub_u32 s65, s62, 1680
    s_mov_b32 s66, 159072863
    s_mul_hi_u32 s66, s65, s66
    s_mul_i32 s67, s66, 27
    s_sub_u32 s65, s65, s67
    s_movk_i32 s63, 3456
    s_mul_i32 s85, s65, 81920
    s_lshl_b32 s67, s66, 10
    s_add_u32 s85, s85, s67
    s_add_u32 s85, s85, 11534336
    s_mov_b32 s87, 20480
    s_branch L_rpc_41
L_rp_40:
    s_load_dwordx2 s[76:77], s[0:1], 72
    s_mov_b32 s78, 2211840
    s_sub_u32 s65, s62, 2220
    s_mov_b32 s66, 429496730
    s_mul_hi_u32 s66, s65, s66
    s_mul_i32 s67, s66, 10
    s_sub_u32 s65, s65, s67
    s_movk_i32 s63, 1280
    s_mul_i32 s85, s65, 221184
    s_lshl_b32 s67, s66, 10
    s_add_u32 s85, s85, s67
    s_add_u32 s85, s85, 14680064
    s_mov_b32 s87, 55296
    s_branch L_rpc_41
L_rpd_42:
    s_load_dwordx2 s[76:77], s[0:1], 32
    s_mov_b32 s78, 0
    s_mov_b32 s65, 0
    s_mov_b32 s66, 0
    s_movk_i32 s63, 1280
    s_mov_b32 s85, 0x7ff00000
    s_mov_b32 s87, 0
L_rpc_41:
    s_mul_i32 s66, s66, s63
    s_lshl_b32 s66, s66, 5
    s_lshl_b32 s65, s65, 7
    s_add_u32 s81, s66, s65
    v_mul_lo_u32 v25, v8, s63
    v_add_u32 v25, v25, v9
    s_lshl_b32 s83, s63, 3
    s_waitcnt lgkmcnt(0)
    s_and_b32 s73, s73, 0xffff
    s_mov_b32 s75, 0x20000
    s_and_b32 s77, s77, 0xffff
    s_mov_b32 s79, 0x20000
    v_lshrrev_b32 v26, 4, v0
    v_lshlrev_b32 v26, 3, v26
    v_bfe_u32 v8, v0, 2, 2
    v_add_u32 v26, v26, v8
    v_lshlrev_b32 v26, 7, v26
    v_and_b32 v8, 3, v0
    v_lshlrev_b32 v8, 3, v8
    v_add_u32 v26, v26, v8
    s_lshl_b32 s88, s3, 12
    s_add_u32 s88, s88, 131072
    v_add_u32 v26, s88, v26
    v_lshlrev_b32 v28, 4, v0
    s_lshl_b32 s45, s41, 3
    s_add_u32 s45, s45, s3
    s_mul_i32 s45, s45, 40960
    s_add_u32 s45, s45, 1048576
    v_lshlrev_b32 v31, 4, v0
    v_add_u32 v31, s45, v31
    v_lshrrev_b32 v2, 5, v0
    v_bfe_u32 v3, v0, 2, 2
    v_bfe_u32 v8, v0, 4, 1
    v_lshlrev_b32 v8, 5, v8
    v_lshlrev_b32 v9, 3, v2
    v_add_u32 v9, v9, v3
    v_lshlrev_b32 v9, 8, v9
    v_add_u32 v9, v9, v8
    v_and_b32 v10, 1, v0
    v_lshlrev_b32 v10, 4, v10
    v_bfe_u32 v11, v0, 1, 1
    v_lshlrev_b32 v11, 3, v11
    v_add_u32 v10, v10, v11
    v_add_u32 v9, v9, v10
    v_xor_b32 v10, 0, v3
    v_lshlrev_b32 v10, 6, v10
    v_add_u32 v236, v9, v10
    v_add_u32 v240, 0x10000, v236
    v_add_u32 v244, 0x20000, v236
    v_xor_b32 v10, 1, v3
    v_lshlrev_b32 v10, 6, v10
    v_add_u32 v237, v9, v10
    v_add_u32 v241, 0x10000, v237
    v_add_u32 v245, 0x20000, v237
    v_xor_b32 v10, 2, v3
    v_lshlrev_b32 v10, 6, v10
    v_add_u32 v238, v9, v10
    v_add_u32 v242, 0x10000, v238
    v_add_u32 v246, 0x20000, v238
    v_xor_b32 v10, 3, v3
    v_lshlrev_b32 v10, 6, v10
    v_add_u32 v239, v9, v10
    v_add_u32 v243, 0x10000, v239
    v_add_u32 v247, 0x20000, v239
    v_and_b32 v1, 31, v0
    v_and_b32 v9, 15, v0
    v_xor_b32 v9, v9, v2
    v_lshlrev_b32 v1, 8, v1
    v_xor_b32 v10, 0, v9
    v_lshlrev_b32 v10, 4, v10
    v_add_u32 v216, v1, v10
    v_xor_b32 v10, 2, v9
    v_lshlrev_b32 v10, 4, v10
    v_add_u32 v217, v1, v10
    v_xor_b32 v10, 4, v9
    v_lshlrev_b32 v10, 4, v10
    v_add_u32 v218, v1, v10
    v_xor_b32 v10, 6, v9
    v_lshlrev_b32 v10, 4, v10
    v_add_u32 v219, v1, v10
    v_xor_b32 v10, 8, v9
    v_lshlrev_b32 v10, 4, v10
    v_add_u32 v220, v1, v10
    v_xor_b32 v10, 10, v9
    v_lshlrev_b32 v10, 4, v10
    v_add_u32 v221, v1, v10
    v_xor_b32 v10, 12, v9
    v_lshlrev_b32 v10, 4, v10
    v_add_u32 v222, v1, v10
    v_xor_b32 v10, 14, v9
    v_lshlrev_b32 v10, 4, v10
    v_add_u32 v223, v1, v10
    v_lshlrev_b32 v9, 2, v2
    v_add_u32 v9, v9, v3
    v_lshlrev_b32 v9, 8, v9
    v_add_u32 v9, v9, v8
    v_and_b32 v10, 3, v0
    v_lshlrev_b32 v10, 3, v10
    v_add_u32 v9, v9, v10
    v_add_u32 v9, 65536, v9
    v_xor_b32 v10, 0, v3
    v_lshlrev_b32 v10, 6, v10
    v_add_u32 v224, v9, v10
    v_xor_b32 v10, 1, v3
    v_lshlrev_b32 v10, 6, v10
    v_add_u32 v225, v9, v10
    v_xor_b32 v10, 2, v3
    v_lshlrev_b32 v10, 6, v10
    v_add_u32 v226, v9, v10
    v_xor_b32 v10, 3, v3
    v_lshlrev_b32 v10, 6, v10
    v_add_u32 v227, v9, v10
    v_mov_b32 v228, 0
    v_mov_b32 v229, 0
    s_cmp_lg_u32 s3, 0
    s_cbranch_scc1 L_w0_44
    s_lshl_b32 s59, s41, 7
    s_add_u32 s59, s59, 35840
    v_lshlrev_b32 v251, 2, v0
    s_mov_b32 s58, 0
    s_mov_b32 s60, 0xffffffff
    s_mov_b32 s61, 0x0
    s_mov_b64 exec, s[60:61]
L_poll_45:
    buffer_load_dword v252, v251, s[4:7], s59 offen sc1
    s_waitcnt vmcnt(0)
    v_cmp_ne_u32 vcc, s24, v252
    s_nop 1
    s_and_b64 vcc, vcc, s[60:61]
    s_cbranch_scc0 L_polld_46
    s_sleep 1
    s_add_u32 s58, s58, 1
    s_cmp_lt_u32 s58, 32768
    s_cbranch_scc1 L_poll_45
    s_load_dwordx2 s[20:21], s[0:1], 104
    s_waitcnt lgkmcnt(0)
    s_and_b32 s21, s21, 0xffff
    s_mov_b32 s22, 256
    s_mov_b32 s23, 0x20000
    v_mov_b32 v253, 0xdead0003
    v_mov_b32 v251, 16
    s_mov_b64 exec, 1
    buffer_store_dword v253, v251, s[20:23], 0 offen
L_polld_46:
    s_mov_b64 exec, -1
L_w0_44:
    s_barrier
    s_mov_b32 s46, 0
    buffer_load_dwordx4 v[128:131], v31, s[4:7], s46 offen offset:0 sc1
    buffer_load_dwordx4 v[132:135], v31, s[4:7], s46 offen offset:1024 sc1
    buffer_load_dwordx4 v[136:139], v31, s[4:7], s46 offen offset:2048 sc1
    buffer_load_dwordx4 v[140:143], v31, s[4:7], s46 offen offset:3072 sc1
    ds_read_b64_tr_b16 v[192:193], v236 offset:49152
    ds_read_b64_tr_b16 v[194:195], v236 offset:50176
    ds_read_b64_tr_b16 v[196:197], v237 offset:49152
    ds_read_b64_tr_b16 v[198:199], v237 offset:50176
    ds_read_b64_tr_b16 v[200:201], v238 offset:49152
    ds_read_b64_tr_b16 v[202:203], v238 offset:50176
    ds_read_b64_tr_b16 v[204:205], v239 offset:49152
    ds_read_b64_tr_b16 v[206:207], v239 offset:50176
    s_waitcnt vmcnt(0)
    s_waitcnt lgkmcnt(6)
    v_mfma_f32_32x32x16_bf16 v[64:79], v[192:195], v[128:131], 0
    ds_read_b64_tr_b16 v[208:209], v236 offset:53248
    ds_read_b64_tr_b16 v[210:211], v236 offset:54272
    s_mov_b32 s46, 4096
    buffer_load_dwordx4 v[144:147], v31, s[4:7], s46 offen offset:0 sc1
    s_waitcnt lgkmcnt(6)
    v_mfma_f32_32x32x16_bf16 v[80:95], v[196:199], v[128:131], 0
    ds_read_b64_tr_b16 v[212:213], v237 offset:53248
    ds_read_b64_tr_b16 v[214:215], v237 offset:54272
    buffer_load_dwordx4 v[148:151], v31, s[4:7], s46 offen offset:1024 sc1
    s_waitcnt lgkmcnt(6)
    v_mfma_f32_32x32x16_bf16 v[96:111], v[200:203], v[128:131], 0
    ds_read_b64_tr_b16 v[192:193], v238 offset:53248
    ds_read_b64_tr_b16 v[194:195], v238 offset:54272
    buffer_load_dwordx4 v[152:155], v31, s[4:7], s46 offen offset:2048 sc1
    s_waitcnt lgkmcnt(6)
    v_mfma_f32_32x32x16_bf16 v[112:127], v[204:207], v[128:131], 0
    ds_read_b64_tr_b16 v[196:197], v239 offset:53248
    ds_read_b64_tr_b16 v[198:199], v239 offset:54272
    buffer_load_dwordx4 v[156:159], v31, s[4:7], s46 offen offset:3072 sc1
    s_waitcnt lgkmcnt(6)
    v_mfma_f32_32x32x16_bf16 v[64:79], v[208:211], v[132:135], v[64:79]
    ds_read_b64_tr_b16 v[200:201], v236 offset:57344
    ds_read_b64_tr_b16 v[202:203], v236 offset:58368
    s_mov_b32 s46, 8192
    buffer_load_dwordx4 v[160:163], v31, s[4:7], s46 offen offset:0 sc1
    s_waitcnt lgkmcnt(6)
    v_mfma_f32_32x32x16_bf16 v[80:95], v[212:215], v[132:135], v[80:95]
    ds_read_b64_tr_b16 v[204:205], v237 offset:57344
    ds_read_b64_tr_b16 v[206:207], v237 offset:58368
    buffer_load_dwordx4 v[164:167], v31, s[4:7], s46 offen offset:1024 sc1
    s_waitcnt lgkmcnt(6)
    v_mfma_f32_32x32x16_bf16 v[96:111], v[192:195], v[132:135], v[96:111]
    ds_read_b64_tr_b16 v[208:209], v238 offset:57344
    ds_read_b64_tr_b16 v[210:211], v238 offset:58368
    buffer_load_dwordx4 v[168:171], v31, s[4:7], s46 offen offset:2048 sc1
    s_waitcnt lgkmcnt(6)
    v_mfma_f32_32x32x16_bf16 v[112:127], v[196:199], v[132:135], v[112:127]
    ds_read_b64_tr_b16 v[212:213], v239 offset:57344
    ds_read_b64_tr_b16 v[214:215], v239 offset:58368
    buffer_load_dwordx4 v[172:175], v31, s[4:7], s46 offen offset:3072 sc1
    s_waitcnt lgkmcnt(6)
    v_mfma_f32_32x32x16_bf16 v[64:79], v[200:203], v[136:139], v[64:79]
    ds_read_b64_tr_b16 v[192:193], v236 offset:61440
    ds_read_b64_tr_b16 v[194:195], v236 offset:62464
    s_waitcnt lgkmcnt(6)
    v_mfma_f32_32x32x16_bf16 v[80:95], v[204:207], v[136:139], v[80:95]
    ds_read_b64_tr_b16 v[196:197], v237 offset:61440
    ds_read_b64_tr_b16 v[198:199], v237 offset:62464
    s_waitcnt lgkmcnt(6)
    v_mfma_f32_32x32x16_bf16 v[96:111], v[208:211], v[136:139], v[96:111]
    ds_read_b64_tr_b16 v[200:201], v238 offset:61440
    ds_read_b64_tr_b16 v[202:203], v238 offset:62464
    s_waitcnt lgkmcnt(6)
    v_mfma_f32_32x32x16_bf16 v[112:127], v[212:215], v[136:139], v[112:127]
    ds_read_b64_tr_b16 v[204:205], v239 offset:61440
    ds_read_b64_tr_b16 v[206:207], v239 offset:62464
    s_waitcnt lgkmcnt(6)
    v_mfma_f32_32x32x16_bf16 v[64:79], v[192:195], v[140:143], v[64:79]
    s_barrier
    ds_read_b64_tr_b16 v[208:209], v240 offset:49152
    ds_read_b64_tr_b16 v[210:211], v240 offset:50176
    s_mov_b32 s47, 1572864
    s_add_u32 m0, s43, 147456
    s_nop 0
    buffer_load_dwordx4 v4, s[8:11], s47 offen lds
    s_waitcnt lgkmcnt(6)
    v_mfma_f32_32x32x16_bf16 v[80:95], v[196:199], v[140:143], v[80:95]
    ds_read_b64_tr_b16 v[212:213], v241 offset:49152
    ds_read_b64_tr_b16 v[214:215], v241 offset:50176
    s_mov_b32 s47, 1605632
    s_add_u32 m0, s43, 148480
    s_nop 0
    buffer_load_dwordx4 v4, s[8:11], s47 offen lds
    s_waitcnt lgkmcnt(6)
    v_mfma_f32_32x32x16_bf16 v[96:111], v[200:203], v[140:143], v[96:111]
    ds_read_b64_tr_b16 v[192:193], v242 offset:49152
    ds_read_b64_tr_b16 v[194:195], v242 offset:50176
    s_mov_b32 s46, 12288
    buffer_load_dwordx4 v[176:179], v31, s[4:7], s46 offen offset:0 sc1
    s_waitcnt lgkmcnt(6)
    v_mfma_f32_32x32x16_bf16 v[112:127], v[204:207], v[140:143], v[112:127]
    ds_read_b64_tr_b16 v[196:197], v243 offset:49152
    ds_read_b64_tr_b16 v[198:199], v243 offset:50176
    buffer_load_dwordx4 v[180:183], v31, s[4:7], s46 offen offset:1024 sc1
    s_waitcnt vmcnt(8)
    s_waitcnt lgkmcnt(6)
    v_mfma_f32_32x32x16_bf16 v[64:79], v[208:211], v[144:147], v[64:79]
    ds_read_b64_tr_b16 v[200:201], v240 offset:53248
    ds_read_b64_tr_b16 v[202:203], v240 offset:54272
    buffer_load_dwordx4 v[184:187], v31, s[4:7], s46 offen offset:2048 sc1
    s_waitcnt lgkmcnt(6)
    v_mfma_f32_32x32x16_bf16 v[80:95], v[212:215], v[144:147], v[80:95]
    ds_read_b64_tr_b16 v[204:205], v241 offset:53248
    ds_read_b64_tr_b16 v[206:207], v241 offset:54272
    buffer_load_dwordx4 v[188:191], v31, s[4:7], s46 offen offset:3072 sc1
    s_waitcnt lgkmcnt(6)
    v_mfma_f32_32x32x16_bf16 v[96:111], v[192:195], v[144:147], v[96:111]
    ds_read_b64_tr_b16 v[208:209], v242 offset:53248
    ds_read_b64_tr_b16 v[210:211], v242 offset:54272
    s_waitcnt lgkmcnt(6)
    v_mfma_f32_32x32x16_bf16 v[112:127], v[196:199], v[144:147], v[112:127]
    ds_read_b64_tr_b16 v[212:213], v243 offset:53248
    ds_read_b64_tr_b16 v[214:215], v243 offset:54272
    s_waitcnt lgkmcnt(6)
    v_mfma_f32_32x32x16_bf16 v[64:79], v[200:203], v[148:151], v[64:79]
    ds_read_b64_tr_b16 v[192:193], v240 offset:57344
    ds_read_b64_tr_b16 v[194:195], v240 offset:58368
    s_waitcnt lgkmcnt(6)
    v_mfma_f32_32x32x16_bf16 v[80:95], v[204:207], v[148:151], v[80:95]
    ds_read_b64_tr_b16 v[196:197], v241 offset:57344
    ds_read_b64_tr_b16 v[198:199], v241 offset:58368
    s_waitcnt lgkmcnt(6)
    v_mfma_f32_32x32x16_bf16 v[96:111], v[208:211], v[148:151], v[96:111]
    ds_read_b64_tr_b16 v[200:201], v242 offset:57344
    ds_read_b64_tr_b16 v[202:203], v242 offset:58368
    s_waitcnt lgkmcnt(6)
    v_mfma_f32_32x32x16_bf16 v[112:127], v[212:215], v[148:151], v[112:127]
    ds_read_b64_tr_b16 v[204:205], v243 offset:57344
    ds_read_b64_tr_b16 v[206:207], v243 offset:58368
    s_waitcnt lgkmcnt(6)
    v_mfma_f32_32x32x16_bf16 v[64:79], v[192:195], v[152:155], v[64:79]
    ds_read_b64_tr_b16 v[208:209], v240 offset:61440
    ds_read_b64_tr_b16 v[210:211], v240 offset:62464
    s_waitcnt lgkmcnt(6)
    v_mfma_f32_32x32x16_bf16 v[80:95], v[196:199], v[152:155], v[80:95]
    ds_read_b64_tr_b16 v[212:213], v241 offset:61440
    ds_read_b64_tr_b16 v[214:215], v241 offset:62464
    s_waitcnt lgkmcnt(6)
    v_mfma_f32_32x32x16_bf16 v[96:111], v[200:203], v[152:155], v[96:111]
    ds_read_b64_tr_b16 v[192:193], v242 offset:61440
    ds_read_b64_tr_b16 v[194:195], v242 offset:62464
    s_waitcnt lgkmcnt(6)
    v_mfma_f32_32x32x16_bf16 v[112:127], v[204:207], v[152:155], v[112:127]
    ds_read_b64_tr_b16 v[196:197], v243 offset:61440
    ds_read_b64_tr_b16 v[198:199], v243 offset:62464
    s_waitcnt lgkmcnt(6)
    v_mfma_f32_32x32x16_bf16 v[64:79], v[208:211], v[156:159], v[64:79]
    s_barrier
    ds_read_b64_tr_b16 v[200:201], v244 offset:0
    ds_read_b64_tr_b16 v[202:203], v244 offset:1024
    s_mov_b32 s47, 2097152
    s_add_u32 m0, s43, 49152
    s_nop 0
    buffer_load_dwordx4 v4, s[8:11], s47 offen lds
    s_waitcnt lgkmcnt(6)
    v_mfma_f32_32x32x16_bf16 v[80:95], v[212:215], v[156:159], v[80:95]
    ds_read_b64_tr_b16 v[204:205], v245 offset:0
    ds_read_b64_tr_b16 v[206:207], v245 offset:1024
    s_mov_b32 s47, 2129920
    s_add_u32 m0, s43, 50176
    s_nop 0
    buffer_load_dwordx4 v4, s[8:11], s47 offen lds
    s_waitcnt lgkmcnt(6)
    v_mfma_f32_32x32x16_bf16 v[96:111], v[192:195], v[156:159], v[96:111]
    ds_read_b64_tr_b16 v[208:209], v246 offset:0
    ds_read_b64_tr_b16 v[210:211], v246 offset:1024
    s_mov_b32 s46, 16384
    buffer_load_dwordx4 v[128:131], v31, s[4:7], s46 offen offset:0 sc1
    s_waitcnt lgkmcnt(6)
    v_mfma_f32_32x32x16_bf16 v[112:127], v[196:199], v[156:159], v[112:127]
    ds_read_b64_tr_b16 v[212:213], v247 offset:0
    ds_read_b64_tr_b16 v[214:215], v247 offset:1024
    buffer_load_dwordx4 v[132:135], v31, s[4:7], s46 offen offset:1024 sc1
    s_waitcnt vmcnt(10)
    s_waitcnt lgkmcnt(6)
    v_mfma_f32_32x32x16_bf16 v[64:79], v[200:203], v[160:163], v[64:79]
    ds_read_b64_tr_b16 v[192:193], v244 offset:4096
    ds_read_b64_tr_b16 v[194:195], v244 offset:5120
    buffer_load_dwordx4 v[136:139], v31, s[4:7], s46 offen offset:2048 sc1
    s_waitcnt lgkmcnt(6)
    v_mfma_f32_32x32x16_bf16 v[80:95], v[204:207], v[160:163], v[80:95]
    ds_read_b64_tr_b16 v[196:197], v245 offset:4096
    ds_read_b64_tr_b16 v[198:199], v245 offset:5120
    buffer_load_dwordx4 v[140:143], v31, s[4:7], s46 offen offset:3072 sc1
    s_waitcnt lgkmcnt(6)
    v_mfma_f32_32x32x16_bf16 v[96:111], v[208:211], v[160:163], v[96:111]
    ds_read_b64_tr_b16 v[200:201], v246 offset:4096
    ds_read_b64_tr_b16 v[202:203], v246 offset:5120
    s_waitcnt lgkmcnt(6)
    v_mfma_f32_32x32x16_bf16 v[112:127], v[212:215], v[160:163], v[112:127]
    ds_read_b64_tr_b16 v[204:205], v247 offset:4096
    ds_read_b64_tr_b16 v[206:207], v247 offset:5120
    s_waitcnt lgkmcnt(6)
    v_mfma_f32_32x32x16_bf16 v[64:79], v[192:195], v[164:167], v[64:79]
    ds_read_b64_tr_b16 v[208:209], v244 offset:8192
    ds_read_b64_tr_b16 v[210:211], v244 offset:9216
    s_waitcnt lgkmcnt(6)
    v_mfma_f32_32x32x16_bf16 v[80:95], v[196:199], v[164:167], v[80:95]
    ds_read_b64_tr_b16 v[212:213], v245 offset:8192
    ds_read_b64_tr_b16 v[214:215], v245 offset:9216
    s_waitcnt lgkmcnt(6)
    v_mfma_f32_32x32x16_bf16 v[96:111], v[200:203], v[164:167], v[96:111]
    ds_read_b64_tr_b16 v[192:193], v246 offset:8192
    ds_read_b64_tr_b16 v[194:195], v246 offset:9216
    s_waitcnt lgkmcnt(6)
    v_mfma_f32_32x32x16_bf16 v[112:127], v[204:207], v[164:167], v[112:127]
    ds_read_b64_tr_b16 v[196:197], v247 offset:8192
    ds_read_b64_tr_b16 v[198:199], v247 offset:9216
    s_waitcnt lgkmcnt(6)
    v_mfma_f32_32x32x16_bf16 v[64:79], v[208:211], v[168:171], v[64:79]
    ds_read_b64_tr_b16 v[200:201], v244 offset:12288
    ds_read_b64_tr_b16 v[202:203], v244 offset:13312
    s_waitcnt lgkmcnt(6)
    v_mfma_f32_32x32x16_bf16 v[80:95], v[212:215], v[168:171], v[80:95]
    ds_read_b64_tr_b16 v[204:205], v245 offset:12288
    ds_read_b64_tr_b16 v[206:207], v245 offset:13312
    s_waitcnt lgkmcnt(6)
    v_mfma_f32_32x32x16_bf16 v[96:111], v[192:195], v[168:171], v[96:111]
    ds_read_b64_tr_b16 v[208:209], v246 offset:12288
    ds_read_b64_tr_b16 v[210:211], v246 offset:13312
    s_waitcnt lgkmcnt(6)
    v_mfma_f32_32x32x16_bf16 v[112:127], v[196:199], v[168:171], v[112:127]
    ds_read_b64_tr_b16 v[212:213], v247 offset:12288
    ds_read_b64_tr_b16 v[214:215], v247 offset:13312
    s_waitcnt lgkmcnt(6)
    v_mfma_f32_32x32x16_bf16 v[64:79], v[200:203], v[172:175], v[64:79]
    s_waitcnt vmcnt(10)
    s_barrier
    s_cmp_lg_u32 s3, 1
    s_cbranch_scc1 L_fw_47
    s_cmp_lt_u32 s2, 20
    s_cbranch_scc1 L_fw_47
    s_cmp_ge_u32 s2, 60
    s_cbranch_scc1 L_fw_47
    s_and_b32 s59, s2, 7
    s_lshl_b32 s59, s59, 10
    s_lshl_b32 s58, s2, 2
    s_add_u32 s59, s59, s58
    s_add_u32 s59, s59, 65776
    v_mul_u32_u24 v251, 160, v0
    s_mov_b32 s58, 0
    s_mov_b32 s60, 0xf
    s_mov_b32 s61, 0x0
    s_mov_b64 exec, s[60:61]
L_poll_48:
    buffer_load_dword v252, v251, s[4:7], s59 offen sc1
    s_waitcnt vmcnt(0)
    v_cmp_ne_u32 vcc, s24, v252
    s_nop 1
    s_and_b64 vcc, vcc, s[60:61]
    s_cbranch_scc0 L_polld_49
    s_sleep 1
    s_add_u32 s58, s58, 1
    s_cmp_lt_u32 s58, 32768
    s_cbranch_scc1 L_poll_48
    s_load_dwordx2 s[20:21], s[0:1], 104
    s_waitcnt lgkmcnt(0)
    s_and_b32 s21, s21, 0xffff
    s_mov_b32 s22, 256
    s_mov_b32 s23, 0x20000
    v_mov_b32 v253, 0xdead000c
    v_mov_b32 v251, 52
    s_mov_b64 exec, 1
    buffer_store_dword v253, v251, s[20:23], 0 offen
L_polld_49:
    s_mov_b64 exec, -1
    v_lshlrev_b32 v8, 2, v0
    s_lshl_b32 s64, s2, 8
    s_add_u32 s59, s64, 262144
    buffer_load_dword v9, v8, s[4:7], s59 offen sc1
    s_add_u32 s59, s64, 277504
    buffer_load_dword v10, v8, s[4:7], s59 offen sc1
    s_add_u32 s59, s64, 292864
    buffer_load_dword v11, v8, s[4:7], s59 offen sc1
    s_add_u32 s59, s64, 308224
    buffer_load_dword v12, v8, s[4:7], s59 offen sc1
L_fw_47:
    ds_read_b64_tr_b16 v[192:193], v244 offset:16384
    ds_read_b64_tr_b16 v[194:195], v244 offset:17408
    s_mov_b32 s47, 2621440
    s_add_u32 m0, s43, 114688
    s_nop 0
    buffer_load_dwordx4 v4, s[8:11], s47 offen lds
    s_waitcnt lgkmcnt(6)
    v_mfma_f32_32x32x16_bf16 v[80:95], v[204:207], v[172:175], v[80:95]
    ds_read_b64_tr_b16 v[196:197], v245 offset:16384
    ds_read_b64_tr_b16 v[198:199], v245 offset:17408
    s_mov_b32 s47, 2654208
    s_add_u32 m0, s43, 115712
    s_nop 0
    buffer_load_dwordx4 v4, s[8:11], s47 offen lds
    s_waitcnt lgkmcnt(6)
    v_mfma_f32_32x32x16_bf16 v[96:111], v[208:211], v[172:175], v[96:111]
    ds_read_b64_tr_b16 v[200:201], v246 offset:16384
    ds_read_b64_tr_b16 v[202:203], v246 offset:17408
    s_mov_b32 s46, 20480
    buffer_load_dwordx4 v[144:147], v31, s[4:7], s46 offen offset:0 sc1
    s_waitcnt lgkmcnt(6)
    v_mfma_f32_32x32x16_bf16 v[112:127], v[212:215], v[172:175], v[112:127]
    ds_read_b64_tr_b16 v[204:205], v247 offset:16384
    ds_read_b64_tr_b16 v[206:207], v247 offset:17408
    buffer_load_dwordx4 v[148:151], v31, s[4:7], s46 offen offset:1024 sc1
    s_waitcnt vmcnt(10)
    s_waitcnt lgkmcnt(6)
    v_mfma_f32_32x32x16_bf16 v[64:79], v[192:195], v[176:179], v[64:79]
    ds_read_b64_tr_b16 v[208:209], v244 offset:20480
    ds_read_b64_tr_b16 v[210:211], v244 offset:21504
    buffer_load_dwordx4 v[152:155], v31, s[4:7], s46 offen offset:2048 sc1
    s_waitcnt lgkmcnt(6)
    v_mfma_f32_32x32x16_bf16 v[80:95], v[196:199], v[176:179], v[80:95]
    ds_read_b64_tr_b16 v[212:213], v245 offset:20480
    ds_read_b64_tr_b16 v[214:215], v245 offset:21504
    buffer_load_dwordx4 v[156:159], v31, s[4:7], s46 offen offset:3072 sc1
    s_waitcnt lgkmcnt(6)
    v_mfma_f32_32x32x16_bf16 v[96:111], v[200:203], v[176:179], v[96:111]
    ds_read_b64_tr_b16 v[192:193], v246 offset:20480
    ds_read_b64_tr_b16 v[194:195], v246 offset:21504
    s_mov_b32 s42, 0
    s_add_u32 m0, s43, 0
    s_nop 0
    buffer_load_dwordx4 v5, s[12:15], s42 offen lds
    s_waitcnt lgkmcnt(6)
    v_mfma_f32_32x32x16_bf16 v[112:127], v[204:207], v[176:179], v[112:127]
    ds_read_b64_tr_b16 v[196:197], v247 offset:20480
    ds_read_b64_tr_b16 v[198:199], v247 offset:21504
    buffer_load_dwordx4 v6, s[12:15], s42 offen offset:1024 lds
    s_waitcnt lgkmcnt(6)
    v_mfma_f32_32x32x16_bf16 v[64:79], v[208:211], v[180:183], v[64:79]
    ds_read_b64_tr_b16 v[200:201], v244 offset:24576
    ds_read_b64_tr_b16 v[202:203], v244 offset:25600
    s_add_u32 m0, s44, 0
    s_nop 0
    buffer_load_dwordx4 v7, s[16:19], s42 offen lds
    s_waitcnt lgkmcnt(6)
    v_mfma_f32_32x32x16_bf16 v[80:95], v[212:215], v[180:183], v[80:95]
    ds_read_b64_tr_b16 v[204:205], v245 offset:24576
    ds_read_b64_tr_b16 v[206:207], v245 offset:25600
    buffer_load_dwordx4 v7, s[16:19], s42 offen offset:1024 lds
    s_waitcnt lgkmcnt(6)
    v_mfma_f32_32x32x16_bf16 v[96:111], v[192:195], v[180:183], v[96:111]
    ds_read_b64_tr_b16 v[208:209], v246 offset:24576
    ds_read_b64_tr_b16 v[210:211], v246 offset:25600
    s_waitcnt lgkmcnt(6)
    v_mfma_f32_32x32x16_bf16 v[112:127], v[196:199], v[180:183], v[112:127]
    ds_read_b64_tr_b16 v[212:213], v247 offset:24576
    ds_read_b64_tr_b16 v[214:215], v247 offset:25600
    s_waitcnt lgkmcnt(6)
    v_mfma_f32_32x32x16_bf16 v[64:79], v[200:203], v[184:187], v[64:79]
    ds_read_b64_tr_b16 v[192:193], v244 offset:28672
    ds_read_b64_tr_b16 v[194:195], v244 offset:29696
    s_waitcnt lgkmcnt(6)
    v_mfma_f32_32x32x16_bf16 v[80:95], v[204:207], v[184:187], v[80:95]
    ds_read_b64_tr_b16 v[196:197], v245 offset:28672
    ds_read_b64_tr_b16 v[198:199], v245 offset:29696
    s_waitcnt lgkmcnt(6)
    v_mfma_f32_32x32x16_bf16 v[96:111], v[208:211], v[184:187], v[96:111]
    ds_read_b64_tr_b16 v[200:201], v246 offset:28672
    ds_read_b64_tr_b16 v[202:203], v246 offset:29696
    s_waitcnt lgkmcnt(6)
    v_mfma_f32_32x32x16_bf16 v[112:127], v[212:215], v[184:187], v[112:127]
    ds_read_b64_tr_b16 v[204:205], v247 offset:28672
    ds_read_b64_tr_b16 v[206:207], v247 offset:29696
    s_waitcnt lgkmcnt(6)
    v_mfma_f32_32x32x16_bf16 v[64:79], v[192:195], v[188:191], v[64:79]
    s_waitcnt vmcnt(14)
    s_barrier
    ds_read_b64_tr_b16 v[208:209], v236 offset:49152
    ds_read_b64_tr_b16 v[210:211], v236 offset:50176
    s_mov_b32 s47, 3145728
    s_add_u32 m0, s43, 131072
    s_nop 0
    buffer_load_dwordx4 v4, s[8:11], s47 offen lds
    s_waitcnt lgkmcnt(6)
    v_mfma_f32_32x32x16_bf16 v[80:95], v[196:199], v[188:191], v[80:95]
    ds_read_b64_tr_b16 v[212:213], v237 offset:49152
    ds_read_b64_tr_b16 v[214:215], v237 offset:50176
    s_mov_b32 s47, 3178496
    s_add_u32 m0, s43, 132096
    s_nop 0
    buffer_load_dwordx4 v4, s[8:11], s47 offen lds
    s_waitcnt lgkmcnt(6)
    v_mfma_f32_32x32x16_bf16 v[96:111], v[200:203], v[188:191], v[96:111]
    ds_read_b64_tr_b16 v[192:193], v238 offset:49152
    ds_read_b64_tr_b16 v[194:195], v238 offset:50176
    s_mov_b32 s46, 24576
    buffer_load_dwordx4 v[160:163], v31, s[4:7], s46 offen offset:0 sc1
    s_waitcnt lgkmcnt(6)
    v_mfma_f32_32x32x16_bf16 v[112:127], v[204:207], v[188:191], v[112:127]
    ds_read_b64_tr_b16 v[196:197], v239 offset:49152
    ds_read_b64_tr_b16 v[198:199], v239 offset:50176
    buffer_load_dwordx4 v[164:167], v31, s[4:7], s46 offen offset:1024 sc1
    s_waitcnt vmcnt(14)
    s_waitcnt lgkmcnt(6)
    v_mfma_f32_32x32x16_bf16 v[64:79], v[208:211], v[128:131], v[64:79]
    ds_read_b64_tr_b16 v[200:201], v236 offset:53248
    ds_read_b64_tr_b16 v[202:203], v236 offset:54272
    buffer_load_dwordx4 v[168:171], v31, s[4:7], s46 offen offset:2048 sc1
    s_waitcnt lgkmcnt(6)
    v_mfma_f32_32x32x16_bf16 v[80:95], v[212:215], v[128:131], v[80:95]
    ds_read_b64_tr_b16 v[204:205], v237 offset:53248
    ds_read_b64_tr_b16 v[206:207], v237 offset:54272
    buffer_load_dwordx4 v[172:175], v31, s[4:7], s46 offen offset:3072 sc1
    s_waitcnt lgkmcnt(6)
    v_mfma_f32_32x32x16_bf16 v[96:111], v[192:195], v[128:131], v[96:111]
    ds_read_b64_tr_b16 v[208:209], v238 offset:53248
    ds_read_b64_tr_b16 v[210:211], v238 offset:54272
    s_waitcnt lgkmcnt(6)
    v_mfma_f32_32x32x16_bf16 v[112:127], v[196:199], v[128:131], v[112:127]
    ds_read_b64_tr_b16 v[212:213], v239 offset:53248
    ds_read_b64_tr_b16 v[214:215], v239 offset:54272
    s_waitcnt lgkmcnt(6)
    v_mfma_f32_32x32x16_bf16 v[64:79], v[200:203], v[132:135], v[64:79]
    ds_read_b64_tr_b16 v[192:193], v236 offset:57344
    ds_read_b64_tr_b16 v[194:195], v236 offset:58368
    s_waitcnt lgkmcnt(6)
    v_mfma_f32_32x32x16_bf16 v[80:95], v[204:207], v[132:135], v[80:95]
    ds_read_b64_tr_b16 v[196:197], v237 offset:57344
    ds_read_b64_tr_b16 v[198:199], v237 offset:58368
    s_waitcnt lgkmcnt(6)
    v_mfma_f32_32x32x16_bf16 v[96:111], v[208:211], v[132:135], v[96:111]
    ds_read_b64_tr_b16 v[200:201], v238 offset:57344
    ds_read_b64_tr_b16 v[202:203], v238 offset:58368
    s_waitcnt lgkmcnt(6)
    v_mfma_f32_32x32x16_bf16 v[112:127], v[212:215], v[132:135], v[112:127]
    ds_read_b64_tr_b16 v[204:205], v239 offset:57344
    ds_read_b64_tr_b16 v[206:207], v239 offset:58368
    s_waitcnt lgkmcnt(6)
    v_mfma_f32_32x32x16_bf16 v[64:79], v[192:195], v[136:139], v[64:79]
    ds_read_b64_tr_b16 v[208:209], v236 offset:61440
    ds_read_b64_tr_b16 v[210:211], v236 offset:62464
    s_waitcnt lgkmcnt(6)
    v_mfma_f32_32x32x16_bf16 v[80:95], v[196:199], v[136:139], v[80:95]
    ds_read_b64_tr_b16 v[212:213], v237 offset:61440
    ds_read_b64_tr_b16 v[214:215], v237 offset:62464
    s_waitcnt lgkmcnt(6)
    v_mfma_f32_32x32x16_bf16 v[96:111], v[200:203], v[136:139], v[96:111]
    ds_read_b64_tr_b16 v[192:193], v238 offset:61440
    ds_read_b64_tr_b16 v[194:195], v238 offset:62464
    s_waitcnt lgkmcnt(6)
    v_mfma_f32_32x32x16_bf16 v[112:127], v[204:207], v[136:139], v[112:127]
    ds_read_b64_tr_b16 v[196:197], v239 offset:61440
    ds_read_b64_tr_b16 v[198:199], v239 offset:62464
    s_waitcnt lgkmcnt(6)
    v_mfma_f32_32x32x16_bf16 v[64:79], v[208:211], v[140:143], v[64:79]
    s_waitcnt vmcnt(14)
    s_barrier
    s_cmp_lg_u32 s3, 1
    s_cbranch_scc1 L_fw_50
    s_cmp_lt_u32 s2, 20
    s_cbranch_scc1 L_fw_50
    s_cmp_ge_u32 s2, 60
    s_cbranch_scc1 L_fw_50
    s_waitcnt vmcnt(16)
    v_add_f32 v9, v9, v10
    v_add_f32 v11, v11, v12
    v_add_f32 v9, v9, v11
    v_cvt_pk_bf16_f32 v9, v9, v9
    v_lshlrev_b32 v9, 16, v9
    buffer_store_dword v9, v8, s[4:7], s64 offen sc1
L_fw_50:
    ds_read_b64_tr_b16 v[200:201], v240 offset:49152
    ds_read_b64_tr_b16 v[202:203], v240 offset:50176
    s_mov_b32 s47, 3670016
    s_add_u32 m0, s43, 147456
    s_nop 0
    buffer_load_dwordx4 v4, s[8:11], s47 offen lds
    s_waitcnt lgkmcnt(6)
    v_mfma_f32_32x32x16_bf16 v[80:95], v[212:215], v[140:143], v[80:95]
    ds_read_b64_tr_b16 v[204:205], v241 offset:49152
    ds_read_b64_tr_b16 v[206:207], v241 offset:50176
    s_mov_b32 s47, 3702784
    s_add_u32 m0, s43, 148480
    s_nop 0
    buffer_load_dwordx4 v4, s[8:11], s47 offen lds
    s_waitcnt lgkmcnt(6)
    v_mfma_f32_32x32x16_bf16 v[96:111], v[192:195], v[140:143], v[96:111]
    ds_read_b64_tr_b16 v[208:209], v242 offset:49152
    ds_read_b64_tr_b16 v[210:211], v242 offset:50176
    s_mov_b32 s46, 28672
    buffer_load_dwordx4 v[176:179], v31, s[4:7], s46 offen offset:0 sc1
    s_waitcnt lgkmcnt(6)
    v_mfma_f32_32x32x16_bf16 v[112:127], v[196:199], v[140:143], v[112:127]
    ds_read_b64_tr_b16 v[212:213], v243 offset:49152
    ds_read_b64_tr_b16 v[214:215], v243 offset:50176
    buffer_load_dwordx4 v[180:183], v31, s[4:7], s46 offen offset:1024 sc1
    s_waitcnt vmcnt(14)
    s_waitcnt lgkmcnt(6)
    v_mfma_f32_32x32x16_bf16 v[64:79], v[200:203], v[144:147], v[64:79]
    ds_read_b64_tr_b16 v[192:193], v240 offset:53248
    ds_read_b64_tr_b16 v[194:195], v240 offset:54272
    buffer_load_dwordx4 v[184:187], v31, s[4:7], s46 offen offset:2048 sc1
    s_waitcnt lgkmcnt(6)
    v_mfma_f32_32x32x16_bf16 v[80:95], v[204:207], v[144:147], v[80:95]
    ds_read_b64_tr_b16 v[196:197], v241 offset:53248
    ds_read_b64_tr_b16 v[198:199], v241 offset:54272
    buffer_load_dwordx4 v[188:191], v31, s[4:7], s46 offen offset:3072 sc1
    s_waitcnt lgkmcnt(6)
    v_mfma_f32_32x32x16_bf16 v[96:111], v[208:211], v[144:147], v[96:111]
    ds_read_b64_tr_b16 v[200:201], v242 offset:53248
    ds_read_b64_tr_b16 v[202:203], v242 offset:54272
    s_waitcnt lgkmcnt(6)
    v_mfma_f32_32x32x16_bf16 v[112:127], v[212:215], v[144:147], v[112:127]
    ds_read_b64_tr_b16 v[204:205], v243 offset:53248
    ds_read_b64_tr_b16 v[206:207], v243 offset:54272
    s_waitcnt lgkmcnt(6)
    v_mfma_f32_32x32x16_bf16 v[64:79], v[192:195], v[148:151], v[64:79]
    ds_read_b64_tr_b16 v[208:209], v240 offset:57344
    ds_read_b64_tr_b16 v[210:211], v240 offset:58368
    s_waitcnt lgkmcnt(6)
    v_mfma_f32_32x32x16_bf16 v[80:95], v[196:199], v[148:151], v[80:95]
    ds_read_b64_tr_b16 v[212:213], v241 offset:57344
    ds_read_b64_tr_b16 v[214:215], v241 offset:58368
    s_waitcnt lgkmcnt(6)
    v_mfma_f32_32x32x16_bf16 v[96:111], v[200:203], v[148:151], v[96:111]
    ds_read_b64_tr_b16 v[192:193], v242 offset:57344
    ds_read_b64_tr_b16 v[194:195], v242 offset:58368
    s_waitcnt lgkmcnt(6)
    v_mfma_f32_32x32x16_bf16 v[112:127], v[204:207], v[148:151], v[112:127]
    ds_read_b64_tr_b16 v[196:197], v243 offset:57344
    ds_read_b64_tr_b16 v[198:199], v243 offset:58368
    s_waitcnt lgkmcnt(6)
    v_mfma_f32_32x32x16_bf16 v[64:79], v[208:211], v[152:155], v[64:79]
    ds_read_b64_tr_b16 v[200:201], v240 offset:61440
    ds_read_b64_tr_b16 v[202:203], v240 offset:62464
    s_waitcnt lgkmcnt(6)
    v_mfma_f32_32x32x16_bf16 v[80:95], v[212:215], v[152:155], v[80:95]
    ds_read_b64_tr_b16 v[204:205], v241 offset:61440
    ds_read_b64_tr_b16 v[206:207], v241 offset:62464
    s_waitcnt lgkmcnt(6)
    v_mfma_f32_32x32x16_bf16 v[96:111], v[192:195], v[152:155], v[96:111]
    ds_read_b64_tr_b16 v[208:209], v242 offset:61440
    ds_read_b64_tr_b16 v[210:211], v242 offset:62464
    s_waitcnt lgkmcnt(6)
    v_mfma_f32_32x32x16_bf16 v[112:127], v[196:199], v[152:155], v[112:127]
    ds_read_b64_tr_b16 v[212:213], v243 offset:61440
    ds_read_b64_tr_b16 v[214:215], v243 offset:62464
    s_waitcnt lgkmcnt(6)
    v_mfma_f32_32x32x16_bf16 v[64:79], v[200:203], v[156:159], v[64:79]
    s_waitcnt vmcnt(10)
    s_barrier
    ds_read_b64_tr_b16 v[192:193], v244 offset:0
    ds_read_b64_tr_b16 v[194:195], v244 offset:1024
    s_mov_b32 s47, 4194304
    s_add_u32 m0, s43, 49152
    s_nop 0
    buffer_load_dwordx4 v4, s[8:11], s47 offen lds
    s_waitcnt lgkmcnt(6)
    v_mfma_f32_32x32x16_bf16 v[80:95], v[204:207], v[156:159], v[80:95]
    ds_read_b64_tr_b16 v[196:197], v245 offset:0
    ds_read_b64_tr_b16 v[198:199], v245 offset:1024
    s_mov_b32 s47, 4227072
    s_add_u32 m0, s43, 50176
    s_nop 0
    buffer_load_dwordx4 v4, s[8:11], s47 offen lds
    s_waitcnt lgkmcnt(6)
    v_mfma_f32_32x32x16_bf16 v[96:111], v[208:211], v[156:159], v[96:111]
    ds_read_b64_tr_b16 v[200:201], v246 offset:0
    ds_read_b64_tr_b16 v[202:203], v246 offset:1024
    s_mov_b32 s46, 32768
    buffer_load_dwordx4 v[128:131], v31, s[4:7], s46 offen offset:0 sc1
    s_waitcnt lgkmcnt(6)
    v_mfma_f32_32x32x16_bf16 v[112:127], v[212:215], v[156:159], v[112:127]
    ds_read_b64_tr_b16 v[204:205], v247 offset:0
    ds_read_b64_tr_b16 v[206:207], v247 offset:1024
    buffer_load_dwordx4 v[132:135], v31, s[4:7], s46 offen offset:1024 sc1
    s_waitcnt vmcnt(10)
    s_waitcnt lgkmcnt(6)
    v_mfma_f32_32x32x16_bf16 v[64:79], v[192:195], v[160:163], v[64:79]
    ds_read_b64_tr_b16 v[208:209], v244 offset:4096
    ds_read_b64_tr_b16 v[210:211], v244 offset:5120
    buffer_load_dwordx4 v[136:139], v31, s[4:7], s46 offen offset:2048 sc1
    s_waitcnt lgkmcnt(6)
    v_mfma_f32_32x32x16_bf16 v[80:95], v[196:199], v[160:163], v[80:95]
    ds_read_b64_tr_b16 v[212:213], v245 offset:4096
    ds_read_b64_tr_b16 v[214:215], v245 offset:5120
    buffer_load_dwordx4 v[140:143], v31, s[4:7], s46 offen offset:3072 sc1
    s_waitcnt lgkmcnt(6)
    v_mfma_f32_32x32x16_bf16 v[96:111], v[200:203], v[160:163], v[96:111]
    ds_read_b64_tr_b16 v[192:193], v246 offset:4096
    ds_read_b64_tr_b16 v[194:195], v246 offset:5120
    s_waitcnt lgkmcnt(6)
    v_mfma_f32_32x32x16_bf16 v[112:127], v[204:207], v[160:163], v[112:127]
    ds_read_b64_tr_b16 v[196:197], v247 offset:4096
    ds_read_b64_tr_b16 v[198:199], v247 offset:5120
    s_waitcnt lgkmcnt(6)
    v_mfma_f32_32x32x16_bf16 v[64:79], v[208:211], v[164:167], v[64:79]
    ds_read_b64_tr_b16 v[200:201], v244 offset:8192
    ds_read_b64_tr_b16 v[202:203], v244 offset:9216
    s_waitcnt lgkmcnt(6)
    v_mfma_f32_32x32x16_bf16 v[80:95], v[212:215], v[164:167], v[80:95]
    ds_read_b64_tr_b16 v[204:205], v245 offset:8192
    ds_read_b64_tr_b16 v[206:207], v245 offset:9216
    s_waitcnt lgkmcnt(6)
    v_mfma_f32_32x32x16_bf16 v[96:111], v[192:195], v[164:167], v[96:111]
    ds_read_b64_tr_b16 v[208:209], v246 offset:8192
    ds_read_b64_tr_b16 v[210:211], v246 offset:9216
    s_waitcnt lgkmcnt(6)
    v_mfma_f32_32x32x16_bf16 v[112:127], v[196:199], v[164:167], v[112:127]
    ds_read_b64_tr_b16 v[212:213], v247 offset:8192
    ds_read_b64_tr_b16 v[214:215], v247 offset:9216
    s_waitcnt lgkmcnt(6)
    v_mfma_f32_32x32x16_bf16 v[64:79], v[200:203], v[168:171], v[64:79]
    ds_read_b64_tr_b16 v[192:193], v244 offset:12288
    ds_read_b64_tr_b16 v[194:195], v244 offset:13312
    s_waitcnt lgkmcnt(6)
    v_mfma_f32_32x32x16_bf16 v[80:95], v[204:207], v[168:171], v[80:95]
    ds_read_b64_tr_b16 v[196:197], v245 offset:12288
    ds_read_b64_tr_b16 v[198:199], v245 offset:13312
    s_waitcnt lgkmcnt(6)
    v_mfma_f32_32x32x16_bf16 v[96:111], v[208:211], v[168:171], v[96:111]
    ds_read_b64_tr_b16 v[200:201], v246 offset:12288
    ds_read_b64_tr_b16 v[202:203], v246 offset:13312
    s_waitcnt lgkmcnt(6)
    v_mfma_f32_32x32x16_bf16 v[112:127], v[212:215], v[168:171], v[112:127]
    ds_read_b64_tr_b16 v[204:205], v247 offset:12288
    ds_read_b64_tr_b16 v[206:207], v247 offset:13312
    s_waitcnt lgkmcnt(6)
    v_mfma_f32_32x32x16_bf16 v[64:79], v[192:195], v[172:175], v[64:79]
    s_waitcnt vmcnt(10)
    s_barrier
    ds_read_b64_tr_b16 v[208:209], v244 offset:16384
    ds_read_b64_tr_b16 v[210:211], v244 offset:17408
    s_mov_b32 s47, 4718592
    s_add_u32 m0, s43, 114688
    s_nop 0
    buffer_load_dwordx4 v4, s[8:11], s47 offen lds
    s_waitcnt lgkmcnt(6)
    v_mfma_f32_32x32x16_bf16 v[80:95], v[196:199], v[172:175], v[80:95]
    ds_read_b64_tr_b16 v[212:213], v245 offset:16384
    ds_read_b64_tr_b16 v[214:215], v245 offset:17408
    s_mov_b32 s47, 4751360
    s_add_u32 m0, s43, 115712
    s_nop 0
    buffer_load_dwordx4 v4, s[8:11], s47 offen lds
    s_waitcnt lgkmcnt(6)
    v_mfma_f32_32x32x16_bf16 v[96:111], v[200:203], v[172:175], v[96:111]
    ds_read_b64_tr_b16 v[192:193], v246 offset:16384
    ds_read_b64_tr_b16 v[194:195], v246 offset:17408
    s_mov_b32 s46, 36864
    buffer_load_dwordx4 v[144:147], v31, s[4:7], s46 offen offset:0 sc1
    s_waitcnt lgkmcnt(6)
    v_mfma_f32_32x32x16_bf16 v[112:127], v[204:207], v[172:175], v[112:127]
    ds_read_b64_tr_b16 v[196:197], v247 offset:16384
    ds_read_b64_tr_b16 v[198:199], v247 offset:17408
    buffer_load_dwordx4 v[148:151], v31, s[4:7], s46 offen offset:1024 sc1
    s_waitcnt vmcnt(10)
    s_waitcnt lgkmcnt(6)
    v_mfma_f32_32x32x16_bf16 v[64:79], v[208:211], v[176:179], v[64:79]
    ds_read_b64_tr_b16 v[200:201], v244 offset:20480
    ds_read_b64_tr_b16 v[202:203], v244 offset:21504
    buffer_load_dwordx4 v[152:155], v31, s[4:7], s46 offen offset:2048 sc1
    s_waitcnt lgkmcnt(6)
    v_mfma_f32_32x32x16_bf16 v[80:95], v[212:215], v[176:179], v[80:95]
    ds_read_b64_tr_b16 v[204:205], v245 offset:20480
    ds_read_b64_tr_b16 v[206:207], v245 offset:21504
    buffer_load_dwordx4 v[156:159], v31, s[4:7], s46 offen offset:3072 sc1
    s_waitcnt lgkmcnt(6)
    v_mfma_f32_32x32x16_bf16 v[96:111], v[192:195], v[176:179], v[96:111]
    ds_read_b64_tr_b16 v[208:209], v246 offset:20480
    ds_read_b64_tr_b16 v[210:211], v246 offset:21504
    s_mov_b32 s42, 16384
    s_add_u32 m0, s43, 16384
    s_nop 0
    buffer_load_dwordx4 v5, s[12:15], s42 offen lds
    s_waitcnt lgkmcnt(6)
    v_mfma_f32_32x32x16_bf16 v[112:127], v[196:199], v[176:179], v[112:127]
    ds_read_b64_tr_b16 v[212:213], v247 offset:20480
    ds_read_b64_tr_b16 v[214:215], v247 offset:21504
    buffer_load_dwordx4 v6, s[12:15], s42 offen offset:1024 lds
    s_waitcnt lgkmcnt(6)
    v_mfma_f32_32x32x16_bf16 v[64:79], v[200:203], v[180:183], v[64:79]
    ds_read_b64_tr_b16 v[192:193], v244 offset:24576
    ds_read_b64_tr_b16 v[194:195], v244 offset:25600
    s_add_u32 m0, s44, 16384
    s_nop 0
    buffer_load_dwordx4 v7, s[16:19], s42 offen lds
    s_waitcnt lgkmcnt(6)
    v_mfma_f32_32x32x16_bf16 v[80:95], v[204:207], v[180:183], v[80:95]
    ds_read_b64_tr_b16 v[196:197], v245 offset:24576
    ds_read_b64_tr_b16 v[198:199], v245 offset:25600
    buffer_load_dwordx4 v7, s[16:19], s42 offen offset:1024 lds
    s_waitcnt lgkmcnt(6)
    v_mfma_f32_32x32x16_bf16 v[96:111], v[208:211], v[180:183], v[96:111]
    ds_read_b64_tr_b16 v[200:201], v246 offset:24576
    ds_read_b64_tr_b16 v[202:203], v246 offset:25600
    s_waitcnt lgkmcnt(6)
    v_mfma_f32_32x32x16_bf16 v[112:127], v[212:215], v[180:183], v[112:127]
    ds_read_b64_tr_b16 v[204:205], v247 offset:24576
    ds_read_b64_tr_b16 v[206:207], v247 offset:25600
    s_waitcnt lgkmcnt(6)
    v_mfma_f32_32x32x16_bf16 v[64:79], v[192:195], v[184:187], v[64:79]
    ds_read_b64_tr_b16 v[208:209], v244 offset:28672
    ds_read_b64_tr_b16 v[210:211], v244 offset:29696
    s_waitcnt lgkmcnt(6)
    v_mfma_f32_32x32x16_bf16 v[80:95], v[196:199], v[184:187], v[80:95]
    ds_read_b64_tr_b16 v[212:213], v245 offset:28672
    ds_read_b64_tr_b16 v[214:215], v245 offset:29696
    s_waitcnt lgkmcnt(6)
    v_mfma_f32_32x32x16_bf16 v[96:111], v[200:203], v[184:187], v[96:111]
    ds_read_b64_tr_b16 v[192:193], v246 offset:28672
    ds_read_b64_tr_b16 v[194:195], v246 offset:29696
    s_waitcnt lgkmcnt(6)
    v_mfma_f32_32x32x16_bf16 v[112:127], v[204:207], v[184:187], v[112:127]
    ds_read_b64_tr_b16 v[196:197], v247 offset:28672
    ds_read_b64_tr_b16 v[198:199], v247 offset:29696
    s_waitcnt lgkmcnt(6)
    v_mfma_f32_32x32x16_bf16 v[64:79], v[208:211], v[188:191], v[64:79]
    s_waitcnt vmcnt(14)
    s_barrier
    s_cmp_lg_u32 s3, 1
    s_cbranch_scc1 L_fw_51
    s_cmp_lt_u32 s2, 20
    s_cbranch_scc1 L_fw_51
    s_cmp_ge_u32 s2, 60
    s_cbranch_scc1 L_fw_51
    s_waitcnt vmcnt(22)
    s_lshl_b32 s59, s2, 2
    s_add_u32 s59, s59, 32768
    v_mov_b32 v250, s24
    v_mul_u32_u24 v251, 256, v0
    s_mov_b64 exec, 255
    buffer_atomic_swap v250, v251, s[4:7], s59 offen
    s_mov_b64 exec, -1
L_fw_51:
    ds_read_b64_tr_b16 v[200:201], v236 offset:49152
    ds_read_b64_tr_b16 v[202:203], v236 offset:50176
    s_waitcnt lgkmcnt(6)
    v_mfma_f32_32x32x16_bf16 v[80:95], v[212:215], v[188:191], v[80:95]
    ds_read_b64_tr_b16 v[204:205], v237 offset:49152
    ds_read_b64_tr_b16 v[206:207], v237 offset:50176
    s_waitcnt lgkmcnt(6)
    v_mfma_f32_32x32x16_bf16 v[96:111], v[192:195], v[188:191], v[96:111]
    ds_read_b64_tr_b16 v[208:209], v238 offset:49152
    ds_read_b64_tr_b16 v[210:211], v238 offset:50176
    s_waitcnt lgkmcnt(6)
    v_mfma_f32_32x32x16_bf16 v[112:127], v[196:199], v[188:191], v[112:127]
    ds_read_b64_tr_b16 v[212:213], v239 offset:49152
    ds_read_b64_tr_b16 v[214:215], v239 offset:50176
    s_waitcnt vmcnt(10)
    s_waitcnt lgkmcnt(6)
    v_mfma_f32_32x32x16_bf16 v[64:79], v[200:203], v[128:131], v[64:79]
    ds_read_b64_tr_b16 v[192:193], v236 offset:53248
    ds_read_b64_tr_b16 v[194:195], v236 offset:54272
    s_waitcnt lgkmcnt(6)
    v_mfma_f32_32x32x16_bf16 v[80:95], v[204:207], v[128:131], v[80:95]
    ds_read_b64_tr_b16 v[196:197], v237 offset:53248
    ds_read_b64_tr_b16 v[198:199], v237 offset:54272
    s_waitcnt lgkmcnt(6)
    v_mfma_f32_32x32x16_bf16 v[96:111], v[208:211], v[128:131], v[96:111]
    ds_read_b64_tr_b16 v[200:201], v238 offset:53248
    ds_read_b64_tr_b16 v[202:203], v238 offset:54272
    s_waitcnt lgkmcnt(6)
    v_mfma_f32_32x32x16_bf16 v[112:127], v[212:215], v[128:131], v[112:127]
    ds_read_b64_tr_b16 v[204:205], v239 offset:53248
    ds_read_b64_tr_b16 v[206:207], v239 offset:54272
    s_waitcnt lgkmcnt(6)
    v_mfma_f32_32x32x16_bf16 v[64:79], v[192:195], v[132:135], v[64:79]
    ds_read_b64_tr_b16 v[208:209], v236 offset:57344
    ds_read_b64_tr_b16 v[210:211], v236 offset:58368
    s_waitcnt lgkmcnt(6)
    v_mfma_f32_32x32x16_bf16 v[80:95], v[196:199], v[132:135], v[80:95]
    ds_read_b64_tr_b16 v[212:213], v237 offset:57344
    ds_read_b64_tr_b16 v[214:215], v237 offset:58368
    s_waitcnt lgkmcnt(6)
    v_mfma_f32_32x32x16_bf16 v[96:111], v[200:203], v[132:135], v[96:111]
    ds_read_b64_tr_b16 v[192:193], v238 offset:57344
    ds_read_b64_tr_b16 v[194:195], v238 offset:58368
    s_waitcnt lgkmcnt(6)
    v_mfma_f32_32x32x16_bf16 v[112:127], v[204:207], v[132:135], v[112:127]
    ds_read_b64_tr_b16 v[196:197], v239 offset:57344
    ds_read_b64_tr_b16 v[198:199], v239 offset:58368
    s_waitcnt lgkmcnt(6)
    v_mfma_f32_32x32x16_bf16 v[64:79], v[208:211], v[136:139], v[64:79]
    ds_read_b64_tr_b16 v[200:201], v236 offset:61440
    ds_read_b64_tr_b16 v[202:203], v236 offset:62464
    s_waitcnt lgkmcnt(6)
    v_mfma_f32_32x32x16_bf16 v[80:95], v[212:215], v[136:139], v[80:95]
    ds_read_b64_tr_b16 v[204:205], v237 offset:61440
    ds_read_b64_tr_b16 v[206:207], v237 offset:62464
    s_waitcnt lgkmcnt(6)
    v_mfma_f32_32x32x16_bf16 v[96:111], v[192:195], v[136:139], v[96:111]
    ds_read_b64_tr_b16 v[208:209], v238 offset:61440
    ds_read_b64_tr_b16 v[210:211], v238 offset:62464
    s_waitcnt lgkmcnt(6)
    v_mfma_f32_32x32x16_bf16 v[112:127], v[196:199], v[136:139], v[112:127]
    ds_read_b64_tr_b16 v[212:213], v239 offset:61440
    ds_read_b64_tr_b16 v[214:215], v239 offset:62464
    s_waitcnt lgkmcnt(6)
    v_mfma_f32_32x32x16_bf16 v[64:79], v[200:203], v[140:143], v[64:79]
    s_waitcnt vmcnt(8)
    s_barrier
    ds_read_b64_tr_b16 v[192:193], v240 offset:49152
    ds_read_b64_tr_b16 v[194:195], v240 offset:50176
    s_waitcnt lgkmcnt(6)
    v_mfma_f32_32x32x16_bf16 v[80:95], v[204:207], v[140:143], v[80:95]
    ds_read_b64_tr_b16 v[196:197], v240 offset:53248
    ds_read_b64_tr_b16 v[198:199], v240 offset:54272
    s_waitcnt lgkmcnt(6)
    v_mfma_f32_32x32x16_bf16 v[96:111], v[208:211], v[140:143], v[96:111]
    ds_read_b64_tr_b16 v[200:201], v240 offset:57344
    ds_read_b64_tr_b16 v[202:203], v240 offset:58368
    s_waitcnt lgkmcnt(6)
    v_mfma_f32_32x32x16_bf16 v[112:127], v[212:215], v[140:143], v[112:127]
    ds_read_b64_tr_b16 v[204:205], v240 offset:61440
    ds_read_b64_tr_b16 v[206:207], v240 offset:62464
    s_waitcnt vmcnt(4)
    s_waitcnt lgkmcnt(6)
    v_mfma_f32_32x32x16_bf16 v[64:79], v[192:195], v[144:147], v[64:79]
    ds_read_b64_tr_b16 v[208:209], v241 offset:49152
    ds_read_b64_tr_b16 v[210:211], v241 offset:50176
    s_waitcnt lgkmcnt(6)
    v_mfma_f32_32x32x16_bf16 v[64:79], v[196:199], v[148:151], v[64:79]
    ds_read_b64_tr_b16 v[212:213], v241 offset:53248
    ds_read_b64_tr_b16 v[214:215], v241 offset:54272
    s_waitcnt lgkmcnt(6)
    v_mfma_f32_32x32x16_bf16 v[64:79], v[200:203], v[152:155], v[64:79]
    ds_read_b64_tr_b16 v[192:193], v241 offset:57344
    ds_read_b64_tr_b16 v[194:195], v241 offset:58368
    s_waitcnt lgkmcnt(6)
    v_mfma_f32_32x32x16_bf16 v[64:79], v[204:207], v[156:159], v[64:79]
    ds_read_b64_tr_b16 v[196:197], v241 offset:61440
    ds_read_b64_tr_b16 v[198:199], v241 offset:62464
    s_waitcnt lgkmcnt(6)
    v_mfma_f32_32x32x16_bf16 v[80:95], v[208:211], v[144:147], v[80:95]
    ds_read_b64_tr_b16 v[200:201], v242 offset:49152
    ds_read_b64_tr_b16 v[202:203], v242 offset:50176
    s_waitcnt lgkmcnt(6)
    v_mfma_f32_32x32x16_bf16 v[80:95], v[212:215], v[148:151], v[80:95]
    ds_read_b64_tr_b16 v[204:205], v242 offset:53248
    ds_read_b64_tr_b16 v[206:207], v242 offset:54272
    s_waitcnt lgkmcnt(6)
    v_mfma_f32_32x32x16_bf16 v[80:95], v[192:195], v[152:155], v[80:95]
    ds_read_b64_tr_b16 v[208:209], v242 offset:57344
    ds_read_b64_tr_b16 v[210:211], v242 offset:58368
    v_cvt_pk_bf16_f32 v32, v64, v65
    v_cvt_pk_bf16_f32 v33, v66, v67
    v_cvt_pk_bf16_f32 v34, v68, v69
    s_waitcnt lgkmcnt(6)
    v_mfma_f32_32x32x16_bf16 v[80:95], v[196:199], v[156:159], v[80:95]
    ds_read_b64_tr_b16 v[212:213], v242 offset:61440
    ds_read_b64_tr_b16 v[214:215], v242 offset:62464
    v_cvt_pk_bf16_f32 v35, v70, v71
    v_cvt_pk_bf16_f32 v36, v72, v73
    v_cvt_pk_bf16_f32 v37, v74, v75
    s_waitcnt lgkmcnt(6)
    v_mfma_f32_32x32x16_bf16 v[96:111], v[200:203], v[144:147], v[96:111]
    ds_read_b64_tr_b16 v[192:193], v243 offset:49152
    ds_read_b64_tr_b16 v[194:195], v243 offset:50176
    v_cvt_pk_bf16_f32 v38, v76, v77
    v_cvt_pk_bf16_f32 v39, v78, v79
    s_waitcnt lgkmcnt(6)
    v_mfma_f32_32x32x16_bf16 v[96:111], v[204:207], v[148:151], v[96:111]
    ds_read_b64_tr_b16 v[196:197], v243 offset:53248
    ds_read_b64_tr_b16 v[198:199], v243 offset:54272
    s_waitcnt lgkmcnt(6)
    v_mfma_f32_32x32x16_bf16 v[96:111], v[208:211], v[152:155], v[96:111]
    ds_read_b64_tr_b16 v[200:201], v243 offset:57344
    ds_read_b64_tr_b16 v[202:203], v243 offset:58368
    v_cvt_pk_bf16_f32 v40, v80, v81
    v_cvt_pk_bf16_f32 v41, v82, v83
    v_cvt_pk_bf16_f32 v42, v84, v85
    s_waitcnt lgkmcnt(6)
    v_mfma_f32_32x32x16_bf16 v[96:111], v[212:215], v[156:159], v[96:111]
    ds_read_b64_tr_b16 v[204:205], v243 offset:61440
    ds_read_b64_tr_b16 v[206:207], v243 offset:62464
    v_cvt_pk_bf16_f32 v43, v86, v87
    v_cvt_pk_bf16_f32 v44, v88, v89
    v_cvt_pk_bf16_f32 v45, v90, v91
    s_waitcnt lgkmcnt(6)
    v_mfma_f32_32x32x16_bf16 v[112:127], v[192:195], v[144:147], v[112:127]
    s_barrier
    ds_read_b128 v[208:211], v216 offset:0
    s_mov_b32 s42, 32768
    s_add_u32 m0, s43, 32768
    s_nop 0
    buffer_load_dwordx4 v5, s[12:15], s42 offen lds
    v_cvt_pk_bf16_f32 v46, v92, v93
    v_cvt_pk_bf16_f32 v47, v94, v95
    s_waitcnt lgkmcnt(5)
    v_mfma_f32_32x32x16_bf16 v[112:127], v[196:199], v[148:151], v[112:127]
    ds_read_b128 v[212:215], v217 offset:0
    buffer_load_dwordx4 v6, s[12:15], s42 offen offset:1024 lds
    s_waitcnt lgkmcnt(4)
    v_mfma_f32_32x32x16_bf16 v[112:127], v[200:203], v[152:155], v[112:127]
    ds_read_b128 v[192:195], v218 offset:0
    s_add_u32 m0, s44, 32768
    s_nop 0
    buffer_load_dwordx4 v7, s[16:19], s42 offen lds
    v_cvt_pk_bf16_f32 v48, v96, v97
    v_cvt_pk_bf16_f32 v49, v98, v99
    v_cvt_pk_bf16_f32 v50, v100, v101
    s_waitcnt lgkmcnt(3)
    v_mfma_f32_32x32x16_bf16 v[112:127], v[204:207], v[156:159], v[112:127]
    ds_read_b128 v[196:199], v219 offset:0
    buffer_load_dwordx4 v7, s[16:19], s42 offen offset:1024 lds
    v_cvt_pk_bf16_f32 v51, v102, v103
    v_cvt_pk_bf16_f32 v52, v104, v105
    v_cvt_pk_bf16_f32 v53, v106, v107
    s_waitcnt lgkmcnt(3)
    v_mfma_f32_32x32x16_bf16 v[128:143], v[208:211], v[32:35], 0
    ds_read_b128 v[200:203], v220 offset:0
    s_add_u32 m0, s88, 0
    s_nop 0
    buffer_load_dwordx4 v24, s[72:75], s80 offen lds
    s_add_u32 s80, s80, s82
    v_cvt_pk_bf16_f32 v54, v108, v109
    v_cvt_pk_bf16_f32 v55, v110, v111
    s_waitcnt lgkmcnt(3)
    v_mfma_f32_32x32x16_bf16 v[128:143], v[212:215], v[36:39], v[128:143]
    ds_read_b128 v[204:207], v221 offset:0
    s_waitcnt lgkmcnt(3)
    v_mfma_f32_32x32x16_bf16 v[128:143], v[192:195], v[40:43], v[128:143]
    ds_read_b128 v[208:211], v222 offset:0
    v_cvt_pk_bf16_f32 v56, v112, v113
    v_cvt_pk_bf16_f32 v57, v114, v115
    v_cvt_pk_bf16_f32 v58, v116, v117
    s_waitcnt lgkmcnt(3)
    v_mfma_f32_32x32x16_bf16 v[128:143], v[196:199], v[44:47], v[128:143]
    ds_read_b128 v[212:215], v223 offset:0
    v_cvt_pk_bf16_f32 v59, v118, v119
    v_cvt_pk_bf16_f32 v60, v120, v121
    v_cvt_pk_bf16_f32 v61, v122, v123
    s_waitcnt lgkmcnt(3)
    v_mfma_f32_32x32x16_bf16 v[128:143], v[200:203], v[48:51], v[128:143]
    ds_read_b128 v[192:195], v216 offset:8192
    v_cvt_pk_bf16_f32 v62, v124, v125
    v_cvt_pk_bf16_f32 v63, v126, v127
    s_waitcnt lgkmcnt(3)
    v_mfma_f32_32x32x16_bf16 v[128:143], v[204:207], v[52:55], v[128:143]
    ds_read_b128 v[196:199], v217 offset:8192
    s_waitcnt lgkmcnt(3)
    v_mfma_f32_32x32x16_bf16 v[128:143], v[208:211], v[56:59], v[128:143]
    ds_read_b128 v[200:203], v218 offset:8192
    s_waitcnt lgkmcnt(3)
    v_mfma_f32_32x32x16_bf16 v[128:143], v[212:215], v[60:63], v[128:143]
    ds_read_b128 v[204:207], v219 offset:8192
    v_mov_b32 v64, 0
    v_mov_b32 v65, 0
    v_mov_b32 v66, 0
    v_mov_b32 v67, 0
    v_mov_b32 v68, 0
    v_mov_b32 v69, 0
    v_mov_b32 v70, 0
    v_mov_b32 v71, 0
    s_waitcnt lgkmcnt(3)
    v_mfma_f32_32x32x16_bf16 v[144:159], v[192:195], v[32:35], 0
    ds_read_b128 v[208:211], v220 offset:8192
    v_mov_b32 v72, 0
    v_mov_b32 v73, 0
    v_mov_b32 v74, 0
    v_mov_b32 v75, 0
    v_mov_b32 v76, 0
    v_mov_b32 v77, 0
    v_mov_b32 v78, 0
    s_waitcnt lgkmcnt(3)
    v_mfma_f32_32x32x16_bf16 v[144:159], v[196:199], v[36:39], v[144:159]
    ds_read_b128 v[212:215], v221 offset:8192
    v_mov_b32 v79, 0
    v_mov_b32 v80, 0
    v_mov_b32 v81, 0
    v_mov_b32 v82, 0
    v_mov_b32 v83, 0
    v_mov_b32 v84, 0
    v_mov_b32 v85, 0
    s_waitcnt lgkmcnt(3)
    v_mfma_f32_32x32x16_bf16 v[144:159], v[200:203], v[40:43], v[144:159]
    ds_read_b128 v[192:195], v222 offset:8192
    v_mov_b32 v86, 0
    v_mov_b32 v87, 0
    v_mov_b32 v88, 0
    v_mov_b32 v89, 0
    v_mov_b32 v90, 0
    v_mov_b32 v91, 0
    v_mov_b32 v92, 0
    v_max3_f32 v230, v128, v129, v130
    v_max3_f32 v230, v230, v131, v132
    v_max3_f32 v230, v230, v133, v134
    v_max3_f32 v230, v230, v135, v136
    v_max3_f32 v230, v230, v137, v138
    v_max3_f32 v230, v230, v139, v140
    v_max3_f32 v230, v230, v141, v142
    v_max_f32 v230, v230, v143
    s_waitcnt lgkmcnt(3)
    v_mfma_f32_32x32x16_bf16 v[144:159], v[204:207], v[44:47], v[144:159]
    ds_read_b128 v[196:199], v223 offset:8192
    v_mov_b32 v93, 0
    v_mov_b32 v94, 0
    v_mov_b32 v95, 0
    v_mov_b32 v96, 0
    v_mov_b32 v97, 0
    v_mov_b32 v98, 0
    v_mov_b32 v99, 0
    v_mov_b32 v231, v230
    s_nop 1
    v_permlane32_swap_b32 v230, v231
    v_max_f32 v230, v230, v231
    v_sub_f32 v128, v128, v230
    v_sub_f32 v129, v129, v230
    v_sub_f32 v130, v130, v230
    s_waitcnt lgkmcnt(3)
    v_mfma_f32_32x32x16_bf16 v[144:159], v[208:211], v[48:51], v[144:159]
    ds_read_b64_tr_b16 v[200:201], v224 offset:0
    ds_read_b64_tr_b16 v[202:203], v224 offset:2048
    v_mov_b32 v100, 0
    v_mov_b32 v101, 0
    v_mov_b32 v102, 0
    v_mov_b32 v103, 0
    v_mov_b32 v104, 0
    v_mov_b32 v105, 0
    v_mov_b32 v106, 0
    v_sub_f32 v131, v131, v230
    v_sub_f32 v132, v132, v230
    v_sub_f32 v133, v133, v230
    v_sub_f32 v134, v134, v230
    v_sub_f32 v135, v135, v230
    v_sub_f32 v136, v136, v230
    v_sub_f32 v137, v137, v230
    s_waitcnt lgkmcnt(4)
    v_mfma_f32_32x32x16_bf16 v[144:159], v[212:215], v[52:55], v[144:159]
    ds_read_b64_tr_b16 v[204:205], v225 offset:0
    ds_read_b64_tr_b16 v[206:207], v225 offset:2048
    v_mov_b32 v107, 0
    v_mov_b32 v108, 0
    v_mov_b32 v109, 0
    v_mov_b32 v110, 0
    v_mov_b32 v111, 0
    v_mov_b32 v112, 0
    v_mov_b32 v113, 0
    v_sub_f32 v138, v138, v230
    v_sub_f32 v139, v139, v230
    v_sub_f32 v140, v140, v230
    v_sub_f32 v141, v141, v230
    v_sub_f32 v142, v142, v230
    v_sub_f32 v143, v143, v230
    v_sub_f32 v176, 0, v230
    v_sub_f32 v177, 0, v230
    s_waitcnt lgkmcnt(5)
    v_mfma_f32_32x32x16_bf16 v[144:159], v[192:195], v[56:59], v[144:159]
    ds_read_b64_tr_b16 v[208:209], v226 offset:0
    ds_read_b64_tr_b16 v[210:211], v226 offset:2048
    v_mov_b32 v114, 0
    v_mov_b32 v115, 0
    v_mov_b32 v116, 0
    v_mov_b32 v117, 0
    v_mov_b32 v118, 0
    v_mov_b32 v119, 0
    v_mov_b32 v120, 0
    v_sub_f32 v178, 0, v230
    v_sub_f32 v179, 0, v230
    v_sub_f32 v180, 0, v230
    v_sub_f32 v181, 0, v230
    v_sub_f32 v182, 0, v230
    v_sub_f32 v183, 0, v230
    v_sub_f32 v184, 0, v230
    s_waitcnt lgkmcnt(6)
    v_mfma_f32_32x32x16_bf16 v[144:159], v[196:199], v[60:63], v[144:159]
    ds_read_b64_tr_b16 v[212:213], v227 offset:0
    ds_read_b64_tr_b16 v[214:215], v227 offset:2048
    v_mov_b32 v121, 0
    v_mov_b32 v122, 0
    v_mov_b32 v123, 0
    v_mov_b32 v124, 0
    v_mov_b32 v125, 0
    v_mov_b32 v126, 0
    v_mov_b32 v127, 0
    v_sub_f32 v185, 0, v230
    v_sub_f32 v186, 0, v230
    v_sub_f32 v187, 0, v230
    v_sub_f32 v188, 0, v230
    v_sub_f32 v189, 0, v230
    v_sub_f32 v190, 0, v230
    v_sub_f32 v191, 0, v230
    v_exp_f32 v128, v128
    v_exp_f32 v129, v129
    v_exp_f32 v130, v130
    v_exp_f32 v131, v131
    v_exp_f32 v132, v132
    v_exp_f32 v133, v133
    v_exp_f32 v134, v134
    v_exp_f32 v135, v135
    v_add_f32 v228, v228, v128
    v_add_f32 v229, v229, v129
    v_cvt_pk_bf16_f32 v160, v128, v129
    v_add_f32 v228, v228, v130
    v_add_f32 v229, v229, v131
    v_cvt_pk_bf16_f32 v161, v130, v131
    v_add_f32 v228, v228, v132
    v_add_f32 v229, v229, v133
    v_cvt_pk_bf16_f32 v162, v132, v133
    v_add_f32 v228, v228, v134
    v_add_f32 v229, v229, v135
    v_cvt_pk_bf16_f32 v163, v134, v135
    s_waitcnt lgkmcnt(6)
    s_nop 0
    v_mfma_f32_32x32x16_bf16 v[64:79], v[200:203], v[160:163], v[64:79]
    ds_read_b64_tr_b16 v[192:193], v224 offset:4096
    ds_read_b64_tr_b16 v[194:195], v224 offset:6144
    s_add_u32 m0, s88, 1024
    s_nop 0
    buffer_load_dwordx4 v24, s[72:75], s80 offen lds
    s_add_u32 s80, s80, s82
    v_exp_f32 v136, v136
    v_exp_f32 v137, v137
    v_exp_f32 v138, v138
    v_exp_f32 v139, v139
    s_waitcnt lgkmcnt(6)
    v_mfma_f32_32x32x16_bf16 v[80:95], v[204:207], v[160:163], v[80:95]
    ds_read_b64_tr_b16 v[196:197], v225 offset:4096
    ds_read_b64_tr_b16 v[198:199], v225 offset:6144
    v_exp_f32 v140, v140
    v_exp_f32 v141, v141
    v_exp_f32 v142, v142
    v_exp_f32 v143, v143
    v_add_f32 v228, v228, v136
    v_add_f32 v229, v229, v137
    v_cvt_pk_bf16_f32 v164, v136, v137
    v_add_f32 v228, v228, v138
    v_add_f32 v229, v229, v139
    v_cvt_pk_bf16_f32 v165, v138, v139
    s_waitcnt lgkmcnt(6)
    v_mfma_f32_32x32x16_bf16 v[96:111], v[208:211], v[160:163], v[96:111]
    ds_read_b64_tr_b16 v[200:201], v226 offset:4096
    ds_read_b64_tr_b16 v[202:203], v226 offset:6144
    v_add_f32 v228, v228, v140
    v_add_f32 v229, v229, v141
    v_cvt_pk_bf16_f32 v166, v140, v141
    v_add_f32 v228, v228, v142
    v_add_f32 v229, v229, v143
    v_cvt_pk_bf16_f32 v167, v142, v143
    s_waitcnt lgkmcnt(6)
    v_mfma_f32_32x32x16_bf16 v[112:127], v[212:215], v[160:163], v[112:127]
    ds_read_b64_tr_b16 v[204:205], v227 offset:4096
    ds_read_b64_tr_b16 v[206:207], v227 offset:6144
    v_sub_f32 v144, v144, v230
    v_sub_f32 v145, v145, v230
    v_sub_f32 v146, v146, v230
    v_sub_f32 v147, v147, v230
    v_sub_f32 v148, v148, v230
    v_sub_f32 v149, v149, v230
    v_sub_f32 v150, v150, v230
    v_sub_f32 v151, v151, v230
    s_waitcnt lgkmcnt(6)
    v_mfma_f32_32x32x16_bf16 v[64:79], v[192:195], v[164:167], v[64:79]
    s_waitcnt vmcnt(6)
    s_barrier
    ds_read_b128 v[208:211], v216 offset:16384
    s_mov_b32 s42, 49152
    s_add_u32 m0, s43, 49152
    s_nop 0
    buffer_load_dwordx4 v5, s[12:15], s42 offen lds
    v_sub_f32 v152, v152, v230
    v_sub_f32 v153, v153, v230
    v_sub_f32 v154, v154, v230
    v_sub_f32 v155, v155, v230
    v_sub_f32 v156, v156, v230
    v_sub_f32 v157, v157, v230
    v_sub_f32 v158, v158, v230
    v_sub_f32 v159, v159, v230
    s_waitcnt lgkmcnt(5)
    v_mfma_f32_32x32x16_bf16 v[80:95], v[196:199], v[164:167], v[80:95]
    ds_read_b128 v[212:215], v217 offset:16384
    buffer_load_dwordx4 v6, s[12:15], s42 offen offset:1024 lds
    v_exp_f32 v144, v144
    v_exp_f32 v145, v145
    s_waitcnt lgkmcnt(4)
    v_mfma_f32_32x32x16_bf16 v[96:111], v[200:203], v[164:167], v[96:111]
    ds_read_b128 v[192:195], v218 offset:16384
    s_add_u32 m0, s44, 49152
    s_nop 0
    buffer_load_dwordx4 v7, s[16:19], s42 offen lds
    v_exp_f32 v146, v146
    v_add_f32 v228, v228, v144
    v_add_f32 v229, v229, v145
    v_cvt_pk_bf16_f32 v168, v144, v145
    s_waitcnt lgkmcnt(3)
    v_mfma_f32_32x32x16_bf16 v[112:127], v[204:207], v[164:167], v[112:127]
    ds_read_b128 v[196:199], v219 offset:16384
    buffer_load_dwordx4 v7, s[16:19], s42 offen offset:1024 lds
    v_exp_f32 v147, v147
    v_add_f32 v228, v228, v146
    s_waitcnt lgkmcnt(3)
    v_mfma_f32_32x32x16_bf16 v[128:143], v[208:211], v[32:35], v[176:191]
    ds_read_b128 v[200:203], v220 offset:16384
    v_exp_f32 v148, v148
    v_exp_f32 v149, v149
    v_add_f32 v229, v229, v147
    v_cvt_pk_bf16_f32 v169, v146, v147
    s_waitcnt lgkmcnt(3)
    v_mfma_f32_32x32x16_bf16 v[128:143], v[212:215], v[36:39], v[128:143]
    ds_read_b128 v[204:207], v221 offset:16384
    v_exp_f32 v150, v150
    v_add_f32 v228, v228, v148
    v_add_f32 v229, v229, v149
    v_cvt_pk_bf16_f32 v170, v148, v149
    s_waitcnt lgkmcnt(3)
    v_mfma_f32_32x32x16_bf16 v[128:143], v[192:195], v[40:43], v[128:143]
    ds_read_b128 v[208:211], v222 offset:16384
    v_exp_f32 v151, v151
    v_add_f32 v228, v228, v150
    s_waitcnt lgkmcnt(3)
    v_mfma_f32_32x32x16_bf16 v[128:143], v[196:199], v[44:47], v[128:143]
    ds_read_b128 v[212:215], v223 offset:16384
    v_exp_f32 v152, v152
    v_exp_f32 v153, v153
    v_add_f32 v229, v229, v151
    v_cvt_pk_bf16_f32 v171, v150, v151
    s_waitcnt lgkmcnt(3)
    v_mfma_f32_32x32x16_bf16 v[128:143], v[200:203], v[48:51], v[128:143]
    ds_read_b64_tr_b16 v[192:193], v224 offset:8192
    ds_read_b64_tr_b16 v[194:195], v224 offset:10240
    v_exp_f32 v154, v154
    v_add_f32 v228, v228, v152
    v_add_f32 v229, v229, v153
    v_cvt_pk_bf16_f32 v172, v152, v153
    s_waitcnt lgkmcnt(4)
    v_mfma_f32_32x32x16_bf16 v[128:143], v[204:207], v[52:55], v[128:143]
    ds_read_b64_tr_b16 v[196:197], v225 offset:8192
    ds_read_b64_tr_b16 v[198:199], v225 offset:10240
    v_exp_f32 v155, v155
    v_add_f32 v228, v228, v154
    s_waitcnt lgkmcnt(5)
    v_mfma_f32_32x32x16_bf16 v[128:143], v[208:211], v[56:59], v[128:143]
    ds_read_b64_tr_b16 v[200:201], v226 offset:8192
    ds_read_b64_tr_b16 v[202:203], v226 offset:10240
    v_exp_f32 v156, v156
    v_exp_f32 v157, v157
    v_add_f32 v229, v229, v155
    v_cvt_pk_bf16_f32 v173, v154, v155
    s_waitcnt lgkmcnt(6)
    v_mfma_f32_32x32x16_bf16 v[128:143], v[212:215], v[60:63], v[128:143]
    ds_read_b64_tr_b16 v[204:205], v227 offset:8192
    ds_read_b64_tr_b16 v[206:207], v227 offset:10240
    v_exp_f32 v158, v158
    v_add_f32 v228, v228, v156
    v_add_f32 v229, v229, v157
    v_cvt_pk_bf16_f32 v174, v156, v157
    s_waitcnt lgkmcnt(6)
    v_mfma_f32_32x32x16_bf16 v[64:79], v[192:195], v[168:171], v[64:79]
    ds_read_b64_tr_b16 v[208:209], v224 offset:12288
    ds_read_b64_tr_b16 v[210:211], v224 offset:14336
    s_add_u32 m0, s88, 2048
    s_nop 0
    buffer_load_dwordx4 v24, s[72:75], s80 offen lds
    s_add_u32 s80, s80, s82
    v_exp_f32 v159, v159
    v_add_f32 v228, v228, v158
    s_waitcnt lgkmcnt(6)
    v_mfma_f32_32x32x16_bf16 v[80:95], v[196:199], v[168:171], v[80:95]
    ds_read_b64_tr_b16 v[212:213], v225 offset:12288
    ds_read_b64_tr_b16 v[214:215], v225 offset:14336
    v_add_f32 v229, v229, v159
    v_cvt_pk_bf16_f32 v175, v158, v159
    s_waitcnt lgkmcnt(6)
    v_mfma_f32_32x32x16_bf16 v[96:111], v[200:203], v[168:171], v[96:111]
    ds_read_b64_tr_b16 v[192:193], v226 offset:12288
    ds_read_b64_tr_b16 v[194:195], v226 offset:14336
    s_waitcnt lgkmcnt(6)
    v_mfma_f32_32x32x16_bf16 v[112:127], v[204:207], v[168:171], v[112:127]
    ds_read_b64_tr_b16 v[196:197], v227 offset:12288
    ds_read_b64_tr_b16 v[198:199], v227 offset:14336
    v_exp_f32 v128, v128
    v_exp_f32 v129, v129
    s_waitcnt lgkmcnt(6)
    v_mfma_f32_32x32x16_bf16 v[64:79], v[208:211], v[172:175], v[64:79]
    ds_read_b128 v[200:203], v216 offset:24576
    v_exp_f32 v130, v130
    v_add_f32 v228, v228, v128
    v_add_f32 v229, v229, v129
    v_cvt_pk_bf16_f32 v160, v128, v129
    s_waitcnt lgkmcnt(5)
    v_mfma_f32_32x32x16_bf16 v[80:95], v[212:215], v[172:175], v[80:95]
    ds_read_b128 v[204:207], v217 offset:24576
    v_exp_f32 v131, v131
    v_add_f32 v228, v228, v130
    s_waitcnt lgkmcnt(4)
    v_mfma_f32_32x32x16_bf16 v[96:111], v[192:195], v[172:175], v[96:111]
    ds_read_b128 v[208:211], v218 offset:24576
    v_exp_f32 v132, v132
    v_add_f32 v229, v229, v131
    v_cvt_pk_bf16_f32 v161, v130, v131
    s_waitcnt lgkmcnt(3)
    v_mfma_f32_32x32x16_bf16 v[112:127], v[196:199], v[172:175], v[112:127]
    ds_read_b128 v[212:215], v219 offset:24576
    v_exp_f32 v133, v133
    v_add_f32 v228, v228, v132
    s_waitcnt lgkmcnt(3)
    v_mfma_f32_32x32x16_bf16 v[144:159], v[200:203], v[32:35], v[176:191]
    ds_read_b128 v[192:195], v220 offset:24576
    v_exp_f32 v134, v134
    v_add_f32 v229, v229, v133
    v_cvt_pk_bf16_f32 v162, v132, v133
    s_waitcnt lgkmcnt(3)
    v_mfma_f32_32x32x16_bf16 v[144:159], v[204:207], v[36:39], v[144:159]
    ds_read_b128 v[196:199], v221 offset:24576
    v_exp_f32 v135, v135
    v_add_f32 v228, v228, v134
    s_waitcnt lgkmcnt(3)
    v_mfma_f32_32x32x16_bf16 v[144:159], v[208:211], v[40:43], v[144:159]
    ds_read_b128 v[200:203], v222 offset:24576
    v_exp_f32 v136, v136
    v_exp_f32 v137, v137
    v_add_f32 v229, v229, v135
    v_cvt_pk_bf16_f32 v163, v134, v135
    s_waitcnt lgkmcnt(3)
    v_mfma_f32_32x32x16_bf16 v[144:159], v[212:215], v[44:47], v[144:159]
    ds_read_b128 v[204:207], v223 offset:24576
    v_exp_f32 v138, v138
    v_add_f32 v228, v228, v136
    v_add_f32 v229, v229, v137
    v_cvt_pk_bf16_f32 v164, v136, v137
    s_waitcnt lgkmcnt(3)
    v_mfma_f32_32x32x16_bf16 v[144:159], v[192:195], v[48:51], v[144:159]
    ds_read_b64_tr_b16 v[208:209], v224 offset:16384
    ds_read_b64_tr_b16 v[210:211], v224 offset:18432
    v_exp_f32 v139, v139
    v_add_f32 v228, v228, v138
    s_waitcnt lgkmcnt(4)
    v_mfma_f32_32x32x16_bf16 v[144:159], v[196:199], v[52:55], v[144:159]
    ds_read_b64_tr_b16 v[212:213], v225 offset:16384
    ds_read_b64_tr_b16 v[214:215], v225 offset:18432
    v_exp_f32 v140, v140
    v_add_f32 v229, v229, v139
    v_cvt_pk_bf16_f32 v165, v138, v139
    s_waitcnt lgkmcnt(5)
    v_mfma_f32_32x32x16_bf16 v[144:159], v[200:203], v[56:59], v[144:159]
    ds_read_b64_tr_b16 v[192:193], v226 offset:16384
    ds_read_b64_tr_b16 v[194:195], v226 offset:18432
    v_exp_f32 v141, v141
    v_add_f32 v228, v228, v140
    s_waitcnt lgkmcnt(6)
    v_mfma_f32_32x32x16_bf16 v[144:159], v[204:207], v[60:63], v[144:159]
    ds_read_b64_tr_b16 v[196:197], v227 offset:16384
    ds_read_b64_tr_b16 v[198:199], v227 offset:18432
    v_exp_f32 v142, v142
    v_add_f32 v229, v229, v141
    v_cvt_pk_bf16_f32 v166, v140, v141
    s_waitcnt lgkmcnt(6)
    v_mfma_f32_32x32x16_bf16 v[64:79], v[208:211], v[160:163], v[64:79]
    ds_read_b64_tr_b16 v[200:201], v224 offset:20480
    ds_read_b64_tr_b16 v[202:203], v224 offset:22528
    s_add_u32 m0, s88, 3072
    s_nop 0
    buffer_load_dwordx4 v24, s[72:75], s80 offen lds
    v_exp_f32 v143, v143
    v_add_f32 v228, v228, v142
    s_waitcnt lgkmcnt(6)
    v_mfma_f32_32x32x16_bf16 v[80:95], v[212:215], v[160:163], v[80:95]
    ds_read_b64_tr_b16 v[204:205], v225 offset:20480
    ds_read_b64_tr_b16 v[206:207], v225 offset:22528
    v_add_f32 v229, v229, v143
    v_cvt_pk_bf16_f32 v167, v142, v143
    s_waitcnt lgkmcnt(6)
    v_mfma_f32_32x32x16_bf16 v[96:111], v[192:195], v[160:163], v[96:111]
    ds_read_b64_tr_b16 v[208:209], v226 offset:20480
    ds_read_b64_tr_b16 v[210:211], v226 offset:22528
    s_waitcnt lgkmcnt(6)
    v_mfma_f32_32x32x16_bf16 v[112:127], v[196:199], v[160:163], v[112:127]
    ds_read_b64_tr_b16 v[212:213], v227 offset:20480
    ds_read_b64_tr_b16 v[214:215], v227 offset:22528
    v_exp_f32 v144, v144
    v_exp_f32 v145, v145
    s_waitcnt lgkmcnt(6)
    v_mfma_f32_32x32x16_bf16 v[64:79], v[200:203], v[164:167], v[64:79]
    s_waitcnt vmcnt(8)
    s_barrier
    ds_read_b128 v[192:195], v216 offset:32768
    s_mov_b32 s42, 65536
    s_add_u32 m0, s43, 0
    s_nop 0
    buffer_load_dwordx4 v5, s[12:15], s42 offen lds
    v_exp_f32 v146, v146
    v_add_f32 v228, v228, v144
    v_add_f32 v229, v229, v145
    v_cvt_pk_bf16_f32 v168, v144, v145
    s_waitcnt lgkmcnt(5)
    v_mfma_f32_32x32x16_bf16 v[80:95], v[204:207], v[164:167], v[80:95]
    ds_read_b128 v[196:199], v217 offset:32768
    buffer_load_dwordx4 v6, s[12:15], s42 offen offset:1024 lds
    v_exp_f32 v147, v147
    v_add_f32 v228, v228, v146
    s_waitcnt lgkmcnt(4)
    v_mfma_f32_32x32x16_bf16 v[96:111], v[208:211], v[164:167], v[96:111]
    ds_read_b128 v[200:203], v218 offset:32768
    s_add_u32 m0, s44, 0
    s_nop 0
    buffer_load_dwordx4 v7, s[16:19], s42 offen lds
    v_exp_f32 v148, v148
    v_add_f32 v229, v229, v147
    v_cvt_pk_bf16_f32 v169, v146, v147
    s_waitcnt lgkmcnt(3)
    v_mfma_f32_32x32x16_bf16 v[112:127], v[212:215], v[164:167], v[112:127]
    ds_read_b128 v[204:207], v219 offset:32768
    buffer_load_dwordx4 v7, s[16:19], s42 offen offset:1024 lds
    v_exp_f32 v149, v149
    v_add_f32 v228, v228, v148
    s_waitcnt lgkmcnt(3)
    v_mfma_f32_32x32x16_bf16 v[128:143], v[192:195], v[32:35], v[176:191]
    ds_read_b128 v[208:211], v220 offset:32768
    v_exp_f32 v150, v150
    v_add_f32 v229, v229, v149
    v_cvt_pk_bf16_f32 v170, v148, v149
    s_waitcnt lgkmcnt(3)
    v_mfma_f32_32x32x16_bf16 v[128:143], v[196:199], v[36:39], v[128:143]
    ds_read_b128 v[212:215], v221 offset:32768
    v_exp_f32 v151, v151
    v_add_f32 v228, v228, v150
    s_waitcnt lgkmcnt(3)
    v_mfma_f32_32x32x16_bf16 v[128:143], v[200:203], v[40:43], v[128:143]
    ds_read_b128 v[192:195], v222 offset:32768
    v_exp_f32 v152, v152
    v_exp_f32 v153, v153
    v_add_f32 v229, v229, v151
    v_cvt_pk_bf16_f32 v171, v150, v151
    s_waitcnt lgkmcnt(3)
    v_mfma_f32_32x32x16_bf16 v[128:143], v[204:207], v[44:47], v[128:143]
    ds_read_b128 v[196:199], v223 offset:32768
    v_exp_f32 v154, v154
    v_add_f32 v228, v228, v152
    v_add_f32 v229, v229, v153
    v_cvt_pk_bf16_f32 v172, v152, v153
    s_waitcnt lgkmcnt(3)
    v_mfma_f32_32x32x16_bf16 v[128:143], v[208:211], v[48:51], v[128:143]
    ds_read_b64_tr_b16 v[200:201], v224 offset:24576
    ds_read_b64_tr_b16 v[202:203], v224 offset:26624
    v_exp_f32 v155, v155
    v_add_f32 v228, v228, v154
    s_waitcnt lgkmcnt(4)
    v_mfma_f32_32x32x16_bf16 v[128:143], v[212:215], v[52:55], v[128:143]
    ds_read_b64_tr_b16 v[204:205], v225 offset:24576
    ds_read_b64_tr_b16 v[206:207], v225 offset:26624
    v_exp_f32 v156, v156
    v_add_f32 v229, v229, v155
    v_cvt_pk_bf16_f32 v173, v154, v155
    s_waitcnt lgkmcnt(5)
    v_mfma_f32_32x32x16_bf16 v[128:143], v[192:195], v[56:59], v[128:143]
    ds_read_b64_tr_b16 v[208:209], v226 offset:24576
    ds_read_b64_tr_b16 v[210:211], v226 offset:26624
    v_exp_f32 v157, v157
    v_add_f32 v228, v228, v156
    s_waitcnt lgkmcnt(6)
    v_mfma_f32_32x32x16_bf16 v[128:143], v[196:199], v[60:63], v[128:143]
    ds_read_b64_tr_b16 v[212:213], v227 offset:24576
    ds_read_b64_tr_b16 v[214:215], v227 offset:26624
    v_exp_f32 v158, v158
    v_add_f32 v229, v229, v157
    v_cvt_pk_bf16_f32 v174, v156, v157
    s_waitcnt lgkmcnt(6)
    v_mfma_f32_32x32x16_bf16 v[64:79], v[200:203], v[168:171], v[64:79]
    ds_read_b64_tr_b16 v[192:193], v224 offset:28672
    ds_read_b64_tr_b16 v[194:195], v224 offset:30720
    v_exp_f32 v159, v159
    v_add_f32 v228, v228, v158
    s_waitcnt lgkmcnt(6)
    v_mfma_f32_32x32x16_bf16 v[80:95], v[204:207], v[168:171], v[80:95]
    ds_read_b64_tr_b16 v[196:197], v225 offset:28672
    ds_read_b64_tr_b16 v[198:199], v225 offset:30720
    v_add_f32 v229, v229, v159
    v_cvt_pk_bf16_f32 v175, v158, v159
    s_waitcnt lgkmcnt(6)
    v_mfma_f32_32x32x16_bf16 v[96:111], v[208:211], v[168:171], v[96:111]
    ds_read_b64_tr_b16 v[200:201], v226 offset:28672
    ds_read_b64_tr_b16 v[202:203], v226 offset:30720
    s_waitcnt lgkmcnt(6)
    v_mfma_f32_32x32x16_bf16 v[112:127], v[212:215], v[168:171], v[112:127]
    ds_read_b64_tr_b16 v[204:205], v227 offset:28672
    ds_read_b64_tr_b16 v[206:207], v227 offset:30720
    v_exp_f32 v128, v128
    v_exp_f32 v129, v129
    s_waitcnt lgkmcnt(6)
    v_mfma_f32_32x32x16_bf16 v[64:79], v[192:195], v[172:175], v[64:79]
    ds_read_b128 v[208:211], v216 offset:40960
    v_exp_f32 v130, v130
    v_add_f32 v228, v228, v128
    v_add_f32 v229, v229, v129
    v_cvt_pk_bf16_f32 v160, v128, v129
    s_waitcnt lgkmcnt(5)
    v_mfma_f32_32x32x16_bf16 v[80:95], v[196:199], v[172:175], v[80:95]
    ds_read_b128 v[212:215], v217 offset:40960
    v_exp_f32 v131, v131
    v_add_f32 v228, v228, v130
    s_waitcnt lgkmcnt(4)
    v_mfma_f32_32x32x16_bf16 v[96:111], v[200:203], v[172:175], v[96:111]
    ds_read_b128 v[192:195], v218 offset:40960
    v_exp_f32 v132, v132
    v_add_f32 v229, v229, v131
    v_cvt_pk_bf16_f32 v161, v130, v131
    s_waitcnt lgkmcnt(3)
    v_mfma_f32_32x32x16_bf16 v[112:127], v[204:207], v[172:175], v[112:127]
    ds_read_b128 v[196:199], v219 offset:40960
    v_exp_f32 v133, v133
    v_add_f32 v228, v228, v132
    s_waitcnt lgkmcnt(3)
    v_mfma_f32_32x32x16_bf16 v[144:159], v[208:211], v[32:35], v[176:191]
    ds_read_b128 v[200:203], v220 offset:40960
    v_exp_f32 v134, v134
    v_add_f32 v229, v229, v133
    v_cvt_pk_bf16_f32 v162, v132, v133
    s_waitcnt lgkmcnt(3)
    v_mfma_f32_32x32x16_bf16 v[144:159], v[212:215], v[36:39], v[144:159]
    ds_read_b128 v[204:207], v221 offset:40960
    v_exp_f32 v135, v135
    v_add_f32 v228, v228, v134
    s_waitcnt lgkmcnt(3)
    v_mfma_f32_32x32x16_bf16 v[144:159], v[192:195], v[40:43], v[144:159]
    ds_read_b128 v[208:211], v222 offset:40960
    v_exp_f32 v136, v136
    v_exp_f32 v137, v137
    v_add_f32 v229, v229, v135
    v_cvt_pk_bf16_f32 v163, v134, v135
    s_waitcnt lgkmcnt(3)
    v_mfma_f32_32x32x16_bf16 v[144:159], v[196:199], v[44:47], v[144:159]
    ds_read_b128 v[212:215], v223 offset:40960
    v_exp_f32 v138, v138
    v_add_f32 v228, v228, v136
    v_add_f32 v229, v229, v137
    v_cvt_pk_bf16_f32 v164, v136, v137
    s_waitcnt lgkmcnt(3)
    v_mfma_f32_32x32x16_bf16 v[144:159], v[200:203], v[48:51], v[144:159]
    ds_read_b64_tr_b16 v[192:193], v224 offset:32768
    ds_read_b64_tr_b16 v[194:195], v224 offset:34816
    v_exp_f32 v139, v139
    v_add_f32 v228, v228, v138
    s_waitcnt lgkmcnt(4)
    v_mfma_f32_32x32x16_bf16 v[144:159], v[204:207], v[52:55], v[144:159]
    ds_read_b64_tr_b16 v[196:197], v225 offset:32768
    ds_read_b64_tr_b16 v[198:199], v225 offset:34816
    v_exp_f32 v140, v140
    v_add_f32 v229, v229, v139
    v_cvt_pk_bf16_f32 v165, v138, v139
    s_waitcnt lgkmcnt(5)
    v_mfma_f32_32x32x16_bf16 v[144:159], v[208:211], v[56:59], v[144:159]
    ds_read_b64_tr_b16 v[200:201], v226 offset:32768
    ds_read_b64_tr_b16 v[202:203], v226 offset:34816
    v_exp_f32 v141, v141
    v_add_f32 v228, v228, v140
    s_waitcnt lgkmcnt(6)
    v_mfma_f32_32x32x16_bf16 v[144:159], v[212:215], v[60:63], v[144:159]
    ds_read_b64_tr_b16 v[204:205], v227 offset:32768
    ds_read_b64_tr_b16 v[206:207], v227 offset:34816
    v_exp_f32 v142, v142
    v_add_f32 v229, v229, v141
    v_cvt_pk_bf16_f32 v166, v140, v141
    s_waitcnt lgkmcnt(6)
    v_mfma_f32_32x32x16_bf16 v[64:79], v[192:195], v[160:163], v[64:79]
    ds_read_b64_tr_b16 v[208:209], v224 offset:36864
    ds_read_b64_tr_b16 v[210:211], v224 offset:38912
    v_exp_f32 v143, v143
    v_add_f32 v228, v228, v142
    s_waitcnt lgkmcnt(6)
    v_mfma_f32_32x32x16_bf16 v[80:95], v[196:199], v[160:163], v[80:95]
    ds_read_b64_tr_b16 v[212:213], v225 offset:36864
    ds_read_b64_tr_b16 v[214:215], v225 offset:38912
    v_add_f32 v229, v229, v143
    v_cvt_pk_bf16_f32 v167, v142, v143
    s_waitcnt lgkmcnt(6)
    v_mfma_f32_32x32x16_bf16 v[96:111], v[200:203], v[160:163], v[96:111]
    ds_read_b64_tr_b16 v[192:193], v226 offset:36864
    ds_read_b64_tr_b16 v[194:195], v226 offset:38912
    s_waitcnt lgkmcnt(6)
    v_mfma_f32_32x32x16_bf16 v[112:127], v[204:207], v[160:163], v[112:127]
    ds_read_b64_tr_b16 v[196:197], v227 offset:36864
    ds_read_b64_tr_b16 v[198:199], v227 offset:38912
    v_exp_f32 v144, v144
    v_exp_f32 v145, v145
    s_waitcnt lgkmcnt(6)
    v_mfma_f32_32x32x16_bf16 v[64:79], v[208:211], v[164:167], v[64:79]
    s_waitcnt vmcnt(6)
    s_barrier
    ds_read_b128 v[200:203], v216 offset:49152
    s_mov_b32 s42, 81920
    s_add_u32 m0, s43, 16384
    s_nop 0
    buffer_load_dwordx4 v5, s[12:15], s42 offen lds
    v_exp_f32 v146, v146
    v_add_f32 v228, v228, v144
    v_add_f32 v229, v229, v145
    v_cvt_pk_bf16_f32 v168, v144, v145
    s_waitcnt lgkmcnt(5)
    v_mfma_f32_32x32x16_bf16 v[80:95], v[212:215], v[164:167], v[80:95]
    ds_read_b128 v[204:207], v217 offset:49152
    buffer_load_dwordx4 v6, s[12:15], s42 offen offset:1024 lds
    v_exp_f32 v147, v147
    v_add_f32 v228, v228, v146
    s_waitcnt lgkmcnt(4)
    v_mfma_f32_32x32x16_bf16 v[96:111], v[192:195], v[164:167], v[96:111]
    ds_read_b128 v[208:211], v218 offset:49152
    s_add_u32 m0, s44, 16384
    s_nop 0
    buffer_load_dwordx4 v7, s[16:19], s42 offen lds
    v_exp_f32 v148, v148
    v_add_f32 v229, v229, v147
    v_cvt_pk_bf16_f32 v169, v146, v147
    s_waitcnt lgkmcnt(3)
    v_mfma_f32_32x32x16_bf16 v[112:127], v[196:199], v[164:167], v[112:127]
    ds_read_b128 v[212:215], v219 offset:49152
    buffer_load_dwordx4 v7, s[16:19], s42 offen offset:1024 lds
    v_exp_f32 v149, v149
    v_add_f32 v228, v228, v148
    s_waitcnt lgkmcnt(3)
    v_mfma_f32_32x32x16_bf16 v[128:143], v[200:203], v[32:35], v[176:191]
    ds_read_b128 v[192:195], v220 offset:49152
    s_waitcnt vmcnt(8)
    ds_read_b64_tr_b16 v[8:9], v26 offset:0
    ds_read_b64_tr_b16 v[10:11], v26 offset:512
    v_exp_f32 v150, v150
    v_add_f32 v229, v229, v149
    v_cvt_pk_bf16_f32 v170, v148, v149
    s_waitcnt lgkmcnt(5)
    v_mfma_f32_32x32x16_bf16 v[128:143], v[204:207], v[36:39], v[128:143]
    ds_read_b128 v[196:199], v221 offset:49152
    ds_read_b64_tr_b16 v[12:13], v26 offset:32
    ds_read_b64_tr_b16 v[14:15], v26 offset:544
    v_exp_f32 v151, v151
    v_add_f32 v228, v228, v150
    s_waitcnt lgkmcnt(7)
    v_mfma_f32_32x32x16_bf16 v[128:143], v[208:211], v[40:43], v[128:143]
    ds_read_b128 v[200:203], v222 offset:49152
    ds_read_b64_tr_b16 v[16:17], v26 offset:64
    ds_read_b64_tr_b16 v[18:19], v26 offset:576
    v_exp_f32 v152, v152
    v_exp_f32 v153, v153
    v_add_f32 v229, v229, v151
    v_cvt_pk_bf16_f32 v171, v150, v151
    s_waitcnt lgkmcnt(9)
    v_mfma_f32_32x32x16_bf16 v[128:143], v[212:215], v[44:47], v[128:143]
    ds_read_b128 v[204:207], v223 offset:49152
    ds_read_b64_tr_b16 v[20:21], v26 offset:96
    ds_read_b64_tr_b16 v[22:23], v26 offset:608
    v_exp_f32 v154, v154
    v_add_f32 v228, v228, v152
    v_add_f32 v229, v229, v153
    v_cvt_pk_bf16_f32 v172, v152, v153
    s_waitcnt lgkmcnt(11)
    v_mfma_f32_32x32x16_bf16 v[128:143], v[192:195], v[48:51], v[128:143]
    ds_read_b64_tr_b16 v[208:209], v224 offset:40960
    ds_read_b64_tr_b16 v[210:211], v224 offset:43008
    s_waitcnt lgkmcnt(2)
    buffer_store_dwordx4 v[8:11], v28, s[4:7], s84 offen sc1
    s_add_u32 s84, s84, s86
    v_exp_f32 v155, v155
    v_add_f32 v228, v228, v154
    v_mfma_f32_32x32x16_bf16 v[128:143], v[196:199], v[52:55], v[128:143]
    ds_read_b64_tr_b16 v[212:213], v225 offset:40960
    ds_read_b64_tr_b16 v[214:215], v225 offset:43008
    v_exp_f32 v156, v156
    v_add_f32 v229, v229, v155
    v_cvt_pk_bf16_f32 v173, v154, v155
    v_mfma_f32_32x32x16_bf16 v[128:143], v[200:203], v[56:59], v[128:143]
    ds_read_b64_tr_b16 v[192:193], v226 offset:40960
    ds_read_b64_tr_b16 v[194:195], v226 offset:43008
    v_exp_f32 v157, v157
    v_add_f32 v228, v228, v156
    v_mfma_f32_32x32x16_bf16 v[128:143], v[204:207], v[60:63], v[128:143]
    ds_read_b64_tr_b16 v[196:197], v227 offset:40960
    ds_read_b64_tr_b16 v[198:199], v227 offset:43008
    v_exp_f32 v158, v158
    v_add_f32 v229, v229, v157
    v_cvt_pk_bf16_f32 v174, v156, v157
    s_waitcnt lgkmcnt(6)
    v_mfma_f32_32x32x16_bf16 v[64:79], v[208:211], v[168:171], v[64:79]
    ds_read_b64_tr_b16 v[200:201], v224 offset:45056
    ds_read_b64_tr_b16 v[202:203], v224 offset:47104
    buffer_store_dwordx4 v[12:15], v28, s[4:7], s84 offen sc1
    s_add_u32 s84, s84, s86
    v_exp_f32 v159, v159
    v_add_f32 v228, v228, v158
    s_waitcnt lgkmcnt(6)
    v_mfma_f32_32x32x16_bf16 v[80:95], v[212:215], v[168:171], v[80:95]
    ds_read_b64_tr_b16 v[204:205], v225 offset:45056
    ds_read_b64_tr_b16 v[206:207], v225 offset:47104
    v_add_f32 v229, v229, v159
    v_cvt_pk_bf16_f32 v175, v158, v159
    s_waitcnt lgkmcnt(6)
    v_mfma_f32_32x32x16_bf16 v[96:111], v[192:195], v[168:171], v[96:111]
    ds_read_b64_tr_b16 v[208:209], v226 offset:45056
    ds_read_b64_tr_b16 v[210:211], v226 offset:47104
    s_waitcnt lgkmcnt(6)
    v_mfma_f32_32x32x16_bf16 v[112:127], v[196:199], v[168:171], v[112:127]
    ds_read_b64_tr_b16 v[212:213], v227 offset:45056
    ds_read_b64_tr_b16 v[214:215], v227 offset:47104
    v_exp_f32 v128, v128
    v_exp_f32 v129, v129
    s_waitcnt lgkmcnt(6)
    v_mfma_f32_32x32x16_bf16 v[64:79], v[200:203], v[172:175], v[64:79]
    ds_read_b128 v[192:195], v216 offset:57344
    buffer_store_dwordx4 v[16:19], v28, s[4:7], s84 offen sc1
    s_add_u32 s84, s84, s86
    v_exp_f32 v130, v130
    v_add_f32 v228, v228, v128
    v_add_f32 v229, v229, v129
    v_cvt_pk_bf16_f32 v160, v128, v129
    s_waitcnt lgkmcnt(5)
    v_mfma_f32_32x32x16_bf16 v[80:95], v[204:207], v[172:175], v[80:95]
    ds_read_b128 v[196:199], v217 offset:57344
    v_exp_f32 v131, v131
    v_add_f32 v228, v228, v130
    s_waitcnt lgkmcnt(4)
    v_mfma_f32_32x32x16_bf16 v[96:111], v[208:211], v[172:175], v[96:111]
    ds_read_b128 v[200:203], v218 offset:57344
    v_exp_f32 v132, v132
    v_add_f32 v229, v229, v131
    v_cvt_pk_bf16_f32 v161, v130, v131
    s_waitcnt lgkmcnt(3)
    v_mfma_f32_32x32x16_bf16 v[112:127], v[212:215], v[172:175], v[112:127]
    ds_read_b128 v[204:207], v219 offset:57344
    v_exp_f32 v133, v133
    v_add_f32 v228, v228, v132
    s_waitcnt lgkmcnt(3)
    v_mfma_f32_32x32x16_bf16 v[144:159], v[192:195], v[32:35], v[176:191]
    ds_read_b128 v[208:211], v220 offset:57344
    buffer_store_dwordx4 v[20:23], v28, s[4:7], s84 offen sc1
    v_exp_f32 v134, v134
    v_add_f32 v229, v229, v133
    v_cvt_pk_bf16_f32 v162, v132, v133
    s_waitcnt lgkmcnt(3)
    v_mfma_f32_32x32x16_bf16 v[144:159], v[196:199], v[36:39], v[144:159]
    ds_read_b128 v[212:215], v221 offset:57344
    v_exp_f32 v135, v135
    v_add_f32 v228, v228, v134
    s_waitcnt lgkmcnt(3)
    v_mfma_f32_32x32x16_bf16 v[144:159], v[200:203], v[40:43], v[144:159]
    ds_read_b128 v[192:195], v222 offset:57344
    v_exp_f32 v136, v136
    v_exp_f32 v137, v137
    v_add_f32 v229, v229, v135
    v_cvt_pk_bf16_f32 v163, v134, v135
    s_waitcnt lgkmcnt(3)
    v_mfma_f32_32x32x16_bf16 v[144:159], v[204:207], v[44:47], v[144:159]
    ds_read_b128 v[196:199], v223 offset:57344
    v_exp_f32 v138, v138
    v_add_f32 v228, v228, v136
    v_add_f32 v229, v229, v137
    v_cvt_pk_bf16_f32 v164, v136, v137
    s_waitcnt lgkmcnt(3)
    v_mfma_f32_32x32x16_bf16 v[144:159], v[208:211], v[48:51], v[144:159]
    ds_read_b64_tr_b16 v[200:201], v224 offset:49152
    ds_read_b64_tr_b16 v[202:203], v224 offset:51200
    s_add_u32 m0, s88, 0
    s_nop 0
    buffer_load_dwordx4 v25, s[76:79], s81 offen lds
    s_add_u32 s81, s81, s83
    v_exp_f32 v139, v139
    v_add_f32 v228, v228, v138
    s_waitcnt lgkmcnt(4)
    v_mfma_f32_32x32x16_bf16 v[144:159], v[212:215], v[52:55], v[144:159]
    ds_read_b64_tr_b16 v[204:205], v225 offset:49152
    ds_read_b64_tr_b16 v[206:207], v225 offset:51200
    v_exp_f32 v140, v140
    v_add_f32 v229, v229, v139
    v_cvt_pk_bf16_f32 v165, v138, v139
    s_waitcnt lgkmcnt(5)
    v_mfma_f32_32x32x16_bf16 v[144:159], v[192:195], v[56:59], v[144:159]
    ds_read_b64_tr_b16 v[208:209], v226 offset:49152
    ds_read_b64_tr_b16 v[210:211], v226 offset:51200
    v_exp_f32 v141, v141
    v_add_f32 v228, v228, v140
    s_waitcnt lgkmcnt(6)
    v_mfma_f32_32x32x16_bf16 v[144:159], v[196:199], v[60:63], v[144:159]
    ds_read_b64_tr_b16 v[212:213], v227 offset:49152
    ds_read_b64_tr_b16 v[214:215], v227 offset:51200
    v_exp_f32 v142, v142
    v_add_f32 v229, v229, v141
    v_cvt_pk_bf16_f32 v166, v140, v141
    s_waitcnt lgkmcnt(6)
    v_mfma_f32_32x32x16_bf16 v[64:79], v[200:203], v[160:163], v[64:79]
    ds_read_b64_tr_b16 v[192:193], v224 offset:53248
    ds_read_b64_tr_b16 v[194:195], v224 offset:55296
    v_exp_f32 v143, v143
    v_add_f32 v228, v228, v142
    s_waitcnt lgkmcnt(6)
    v_mfma_f32_32x32x16_bf16 v[80:95], v[204:207], v[160:163], v[80:95]
    ds_read_b64_tr_b16 v[196:197], v225 offset:53248
    ds_read_b64_tr_b16 v[198:199], v225 offset:55296
    v_add_f32 v229, v229, v143
    v_cvt_pk_bf16_f32 v167, v142, v143
    s_waitcnt lgkmcnt(6)
    v_mfma_f32_32x32x16_bf16 v[96:111], v[208:211], v[160:163], v[96:111]
    ds_read_b64_tr_b16 v[200:201], v226 offset:53248
    ds_read_b64_tr_b16 v[202:203], v226 offset:55296
    s_waitcnt lgkmcnt(6)
    v_mfma_f32_32x32x16_bf16 v[112:127], v[212:215], v[160:163], v[112:127]
    ds_read_b64_tr_b16 v[204:205], v227 offset:53248
    ds_read_b64_tr_b16 v[206:207], v227 offset:55296
    v_exp_f32 v144, v144
    v_exp_f32 v145, v145
    s_waitcnt lgkmcnt(6)
    v_mfma_f32_32x32x16_bf16 v[64:79], v[192:195], v[164:167], v[64:79]
    s_waitcnt vmcnt(9)
    s_barrier
    ds_read_b128 v[208:211], v216 offset:0
    s_mov_b32 s42, 98304
    s_add_u32 m0, s43, 32768
    s_nop 0
    buffer_load_dwordx4 v5, s[12:15], s42 offen lds
    v_exp_f32 v146, v146
    v_add_f32 v228, v228, v144
    v_add_f32 v229, v229, v145
    v_cvt_pk_bf16_f32 v168, v144, v145
    s_waitcnt lgkmcnt(5)
    v_mfma_f32_32x32x16_bf16 v[80:95], v[196:199], v[164:167], v[80:95]
    ds_read_b128 v[212:215], v217 offset:0
    buffer_load_dwordx4 v6, s[12:15], s42 offen offset:1024 lds
    v_exp_f32 v147, v147
    v_add_f32 v228, v228, v146
    s_waitcnt lgkmcnt(4)
    v_mfma_f32_32x32x16_bf16 v[96:111], v[200:203], v[164:167], v[96:111]
    ds_read_b128 v[192:195], v218 offset:0
    s_add_u32 m0, s44, 32768
    s_nop 0
    buffer_load_dwordx4 v7, s[16:19], s42 offen lds
    v_exp_f32 v148, v148
    v_add_f32 v229, v229, v147
    v_cvt_pk_bf16_f32 v169, v146, v147
    s_waitcnt lgkmcnt(3)
    v_mfma_f32_32x32x16_bf16 v[112:127], v[204:207], v[164:167], v[112:127]
    ds_read_b128 v[196:199], v219 offset:0
    buffer_load_dwordx4 v7, s[16:19], s42 offen offset:1024 lds
    v_exp_f32 v149, v149
    v_add_f32 v228, v228, v148
    s_waitcnt lgkmcnt(3)
    v_mfma_f32_32x32x16_bf16 v[128:143], v[208:211], v[32:35], v[176:191]
    ds_read_b128 v[200:203], v220 offset:0
    s_add_u32 m0, s88, 1024
    s_nop 0
    buffer_load_dwordx4 v25, s[76:79], s81 offen lds
    s_add_u32 s81, s81, s83
    v_exp_f32 v150, v150
    v_add_f32 v229, v229, v149
    v_cvt_pk_bf16_f32 v170, v148, v149
    s_waitcnt lgkmcnt(3)
    v_mfma_f32_32x32x16_bf16 v[128:143], v[212:215], v[36:39], v[128:143]
    ds_read_b128 v[204:207], v221 offset:0
    v_exp_f32 v151, v151
    v_add_f32 v228, v228, v150
    s_waitcnt lgkmcnt(3)
    v_mfma_f32_32x32x16_bf16 v[128:143], v[192:195], v[40:43], v[128:143]
    ds_read_b128 v[208:211], v222 offset:0
    v_exp_f32 v152, v152
    v_exp_f32 v153, v153
    v_add_f32 v229, v229, v151
    v_cvt_pk_bf16_f32 v171, v150, v151
    s_waitcnt lgkmcnt(3)
    v_mfma_f32_32x32x16_bf16 v[128:143], v[196:199], v[44:47], v[128:143]
    ds_read_b128 v[212:215], v223 offset:0
    v_exp_f32 v154, v154
    v_add_f32 v228, v228, v152
    v_add_f32 v229, v229, v153
    v_cvt_pk_bf16_f32 v172, v152, v153
    s_waitcnt lgkmcnt(3)
    v_mfma_f32_32x32x16_bf16 v[128:143], v[200:203], v[48:51], v[128:143]
    ds_read_b64_tr_b16 v[192:193], v224 offset:57344
    ds_read_b64_tr_b16 v[194:195], v224 offset:59392
    v_exp_f32 v155, v155
    v_add_f32 v228, v228, v154
    s_waitcnt lgkmcnt(4)
    v_mfma_f32_32x32x16_bf16 v[128:143], v[204:207], v[52:55], v[128:143]
    ds_read_b64_tr_b16 v[196:197], v225 offset:57344
    ds_read_b64_tr_b16 v[198:199], v225 offset:59392
    v_exp_f32 v156, v156
    v_add_f32 v229, v229, v155
    v_cvt_pk_bf16_f32 v173, v154, v155
    s_waitcnt lgkmcnt(5)
    v_mfma_f32_32x32x16_bf16 v[128:143], v[208:211], v[56:59], v[128:143]
    ds_read_b64_tr_b16 v[200:201], v226 offset:57344
    ds_read_b64_tr_b16 v[202:203], v226 offset:59392
    v_exp_f32 v157, v157
    v_add_f32 v228, v228, v156
    s_waitcnt lgkmcnt(6)
    v_mfma_f32_32x32x16_bf16 v[128:143], v[212:215], v[60:63], v[128:143]
    ds_read_b64_tr_b16 v[204:205], v227 offset:57344
    ds_read_b64_tr_b16 v[206:207], v227 offset:59392
    v_exp_f32 v158, v158
    v_add_f32 v229, v229, v157
    v_cvt_pk_bf16_f32 v174, v156, v157
    s_waitcnt lgkmcnt(6)
    v_mfma_f32_32x32x16_bf16 v[64:79], v[192:195], v[168:171], v[64:79]
    ds_read_b64_tr_b16 v[208:209], v224 offset:61440
    ds_read_b64_tr_b16 v[210:211], v224 offset:63488
    s_add_u32 m0, s88, 2048
    s_nop 0
    buffer_load_dwordx4 v25, s[76:79], s81 offen lds
    s_add_u32 s81, s81, s83
    v_exp_f32 v159, v159
    v_add_f32 v228, v228, v158
    s_waitcnt lgkmcnt(6)
    v_mfma_f32_32x32x16_bf16 v[80:95], v[196:199], v[168:171], v[80:95]
    ds_read_b64_tr_b16 v[212:213], v225 offset:61440
    ds_read_b64_tr_b16 v[214:215], v225 offset:63488
    v_add_f32 v229, v229, v159
    v_cvt_pk_bf16_f32 v175, v158, v159
    s_waitcnt lgkmcnt(6)
    v_mfma_f32_32x32x16_bf16 v[96:111], v[200:203], v[168:171], v[96:111]
    ds_read_b64_tr_b16 v[192:193], v226 offset:61440
    ds_read_b64_tr_b16 v[194:195], v226 offset:63488
    s_waitcnt lgkmcnt(6)
    v_mfma_f32_32x32x16_bf16 v[112:127], v[204:207], v[168:171], v[112:127]
    ds_read_b64_tr_b16 v[196:197], v227 offset:61440
    ds_read_b64_tr_b16 v[198:199], v227 offset:63488
    v_exp_f32 v128, v128
    v_exp_f32 v129, v129
    s_waitcnt lgkmcnt(6)
    v_mfma_f32_32x32x16_bf16 v[64:79], v[208:211], v[172:175], v[64:79]
    ds_read_b128 v[200:203], v216 offset:8192
    v_exp_f32 v130, v130
    v_add_f32 v228, v228, v128
    v_add_f32 v229, v229, v129
    v_cvt_pk_bf16_f32 v160, v128, v129
    s_waitcnt lgkmcnt(5)
    v_mfma_f32_32x32x16_bf16 v[80:95], v[212:215], v[172:175], v[80:95]
    ds_read_b128 v[204:207], v217 offset:8192
    v_exp_f32 v131, v131
    v_add_f32 v228, v228, v130
    s_waitcnt lgkmcnt(4)
    v_mfma_f32_32x32x16_bf16 v[96:111], v[192:195], v[172:175], v[96:111]
    ds_read_b128 v[208:211], v218 offset:8192
    v_exp_f32 v132, v132
    v_add_f32 v229, v229, v131
    v_cvt_pk_bf16_f32 v161, v130, v131
    s_waitcnt lgkmcnt(3)
    v_mfma_f32_32x32x16_bf16 v[112:127], v[196:199], v[172:175], v[112:127]
    ds_read_b128 v[212:215], v219 offset:8192
    v_exp_f32 v133, v133
    v_add_f32 v228, v228, v132
    s_waitcnt lgkmcnt(3)
    v_mfma_f32_32x32x16_bf16 v[144:159], v[200:203], v[32:35], v[176:191]
    ds_read_b128 v[192:195], v220 offset:8192
    s_add_u32 m0, s88, 3072
    s_nop 0
    buffer_load_dwordx4 v25, s[76:79], s81 offen lds
    v_exp_f32 v134, v134
    v_add_f32 v229, v229, v133
    v_cvt_pk_bf16_f32 v162, v132, v133
    s_waitcnt lgkmcnt(3)
    v_mfma_f32_32x32x16_bf16 v[144:159], v[204:207], v[36:39], v[144:159]
    ds_read_b128 v[196:199], v221 offset:8192
    v_exp_f32 v135, v135
    v_add_f32 v228, v228, v134
    s_waitcnt lgkmcnt(3)
    v_mfma_f32_32x32x16_bf16 v[144:159], v[208:211], v[40:43], v[144:159]
    ds_read_b128 v[200:203], v222 offset:8192
    v_exp_f32 v136, v136
    v_exp_f32 v137, v137
    v_add_f32 v229, v229, v135
    v_cvt_pk_bf16_f32 v163, v134, v135
    s_waitcnt lgkmcnt(3)
    v_mfma_f32_32x32x16_bf16 v[144:159], v[212:215], v[44:47], v[144:159]
    ds_read_b128 v[204:207], v223 offset:8192
    v_exp_f32 v138, v138
    v_add_f32 v228, v228, v136
    v_add_f32 v229, v229, v137
    v_cvt_pk_bf16_f32 v164, v136, v137
    s_waitcnt lgkmcnt(3)
    v_mfma_f32_32x32x16_bf16 v[144:159], v[192:195], v[48:51], v[144:159]
    ds_read_b64_tr_b16 v[208:209], v224 offset:0
    ds_read_b64_tr_b16 v[210:211], v224 offset:2048
    v_exp_f32 v139, v139
    v_add_f32 v228, v228, v138
    s_waitcnt lgkmcnt(4)
    v_mfma_f32_32x32x16_bf16 v[144:159], v[196:199], v[52:55], v[144:159]
    ds_read_b64_tr_b16 v[212:213], v225 offset:0
    ds_read_b64_tr_b16 v[214:215], v225 offset:2048
    v_exp_f32 v140, v140
    v_add_f32 v229, v229, v139
    v_cvt_pk_bf16_f32 v165, v138, v139
    s_waitcnt lgkmcnt(5)
    v_mfma_f32_32x32x16_bf16 v[144:159], v[200:203], v[56:59], v[144:159]
    ds_read_b64_tr_b16 v[192:193], v226 offset:0
    ds_read_b64_tr_b16 v[194:195], v226 offset:2048
    v_exp_f32 v141, v141
    v_add_f32 v228, v228, v140
    s_waitcnt lgkmcnt(6)
    v_mfma_f32_32x32x16_bf16 v[144:159], v[204:207], v[60:63], v[144:159]
    ds_read_b64_tr_b16 v[196:197], v227 offset:0
    ds_read_b64_tr_b16 v[198:199], v227 offset:2048
    v_exp_f32 v142, v142
    v_add_f32 v229, v229, v141
    v_cvt_pk_bf16_f32 v166, v140, v141
    s_waitcnt lgkmcnt(6)
    v_mfma_f32_32x32x16_bf16 v[64:79], v[208:211], v[160:163], v[64:79]
    ds_read_b64_tr_b16 v[200:201], v224 offset:4096
    ds_read_b64_tr_b16 v[202:203], v224 offset:6144
    v_exp_f32 v143, v143
    v_add_f32 v228, v228, v142
    s_waitcnt lgkmcnt(6)
    v_mfma_f32_32x32x16_bf16 v[80:95], v[212:215], v[160:163], v[80:95]
    ds_read_b64_tr_b16 v[204:205], v225 offset:4096
    ds_read_b64_tr_b16 v[206:207], v225 offset:6144
    v_add_f32 v229, v229, v143
    v_cvt_pk_bf16_f32 v167, v142, v143
    s_waitcnt lgkmcnt(6)
    v_mfma_f32_32x32x16_bf16 v[96:111], v[192:195], v[160:163], v[96:111]
    ds_read_b64_tr_b16 v[208:209], v226 offset:4096
    ds_read_b64_tr_b16 v[210:211], v226 offset:6144
    s_waitcnt lgkmcnt(6)
    v_mfma_f32_32x32x16_bf16 v[112:127], v[196:199], v[160:163], v[112:127]
    ds_read_b64_tr_b16 v[212:213], v227 offset:4096
    ds_read_b64_tr_b16 v[214:215], v227 offset:6144
    v_exp_f32 v144, v144
    v_exp_f32 v145, v145
    s_waitcnt lgkmcnt(6)
    v_mfma_f32_32x32x16_bf16 v[64:79], v[200:203], v[164:167], v[64:79]
    s_waitcnt vmcnt(8)
    s_barrier
    s_cmp_lg_u32 s3, 0
    s_cbranch_scc1 L_w0_52
    s_lshl_b32 s59, s2, 2
    s_add_u32 s59, s59, 73728
    v_mov_b32 v250, s24
    v_mul_u32_u24 v251, 1024, v0
    s_mov_b64 exec, 255
    buffer_atomic_swap v250, v251, s[4:7], s59 offen
    s_mov_b64 exec, -1
L_w0_52:
    ds_read_b128 v[192:195], v216 offset:16384
    s_mov_b32 s42, 114688
    s_add_u32 m0, s43, 49152
    s_nop 0
    buffer_load_dwordx4 v5, s[12:15], s42 offen lds
    v_exp_f32 v146, v146
    v_add_f32 v228, v228, v144
    v_add_f32 v229, v229, v145
    v_cvt_pk_bf16_f32 v168, v144, v145
    s_waitcnt lgkmcnt(5)
    v_mfma_f32_32x32x16_bf16 v[80:95], v[204:207], v[164:167], v[80:95]
    ds_read_b128 v[196:199], v217 offset:16384
    buffer_load_dwordx4 v6, s[12:15], s42 offen offset:1024 lds
    v_exp_f32 v147, v147
    v_add_f32 v228, v228, v146
    s_waitcnt lgkmcnt(4)
    v_mfma_f32_32x32x16_bf16 v[96:111], v[208:211], v[164:167], v[96:111]
    ds_read_b128 v[200:203], v218 offset:16384
    s_add_u32 m0, s44, 49152
    s_nop 0
    buffer_load_dwordx4 v7, s[16:19], s42 offen lds
    v_exp_f32 v148, v148
    v_add_f32 v229, v229, v147
    v_cvt_pk_bf16_f32 v169, v146, v147
    s_waitcnt lgkmcnt(3)
    v_mfma_f32_32x32x16_bf16 v[112:127], v[212:215], v[164:167], v[112:127]
    ds_read_b128 v[204:207], v219 offset:16384
    buffer_load_dwordx4 v7, s[16:19], s42 offen offset:1024 lds
    v_exp_f32 v149, v149
    v_add_f32 v228, v228, v148
    s_waitcnt lgkmcnt(3)
    v_mfma_f32_32x32x16_bf16 v[128:143], v[192:195], v[32:35], v[176:191]
    ds_read_b128 v[208:211], v220 offset:16384
    v_exp_f32 v150, v150
    v_add_f32 v229, v229, v149
    v_cvt_pk_bf16_f32 v170, v148, v149
    s_waitcnt lgkmcnt(3)
    v_mfma_f32_32x32x16_bf16 v[128:143], v[196:199], v[36:39], v[128:143]
    ds_read_b128 v[212:215], v221 offset:16384
    v_exp_f32 v151, v151
    v_add_f32 v228, v228, v150
    s_waitcnt lgkmcnt(3)
    v_mfma_f32_32x32x16_bf16 v[128:143], v[200:203], v[40:43], v[128:143]
    ds_read_b128 v[192:195], v222 offset:16384
    v_exp_f32 v152, v152
    v_exp_f32 v153, v153
    v_add_f32 v229, v229, v151
    v_cvt_pk_bf16_f32 v171, v150, v151
    s_waitcnt lgkmcnt(3)
    v_mfma_f32_32x32x16_bf16 v[128:143], v[204:207], v[44:47], v[128:143]
    ds_read_b128 v[196:199], v223 offset:16384
    v_exp_f32 v154, v154
    v_add_f32 v228, v228, v152
    v_add_f32 v229, v229, v153
    v_cvt_pk_bf16_f32 v172, v152, v153
    s_waitcnt lgkmcnt(3)
    v_mfma_f32_32x32x16_bf16 v[128:143], v[208:211], v[48:51], v[128:143]
    ds_read_b64_tr_b16 v[200:201], v224 offset:8192
    ds_read_b64_tr_b16 v[202:203], v224 offset:10240
    v_exp_f32 v155, v155
    v_add_f32 v228, v228, v154
    s_waitcnt lgkmcnt(4)
    v_mfma_f32_32x32x16_bf16 v[128:143], v[212:215], v[52:55], v[128:143]
    ds_read_b64_tr_b16 v[204:205], v225 offset:8192
    ds_read_b64_tr_b16 v[206:207], v225 offset:10240
    v_exp_f32 v156, v156
    v_add_f32 v229, v229, v155
    v_cvt_pk_bf16_f32 v173, v154, v155
    s_waitcnt lgkmcnt(5)
    v_mfma_f32_32x32x16_bf16 v[128:143], v[192:195], v[56:59], v[128:143]
    ds_read_b64_tr_b16 v[208:209], v226 offset:8192
    ds_read_b64_tr_b16 v[210:211], v226 offset:10240
    v_exp_f32 v157, v157
    v_add_f32 v228, v228, v156
    s_waitcnt lgkmcnt(6)
    v_mfma_f32_32x32x16_bf16 v[128:143], v[196:199], v[60:63], v[128:143]
    ds_read_b64_tr_b16 v[212:213], v227 offset:8192
    ds_read_b64_tr_b16 v[214:215], v227 offset:10240
    v_exp_f32 v158, v158
    v_add_f32 v229, v229, v157
    v_cvt_pk_bf16_f32 v174, v156, v157
    s_waitcnt lgkmcnt(6)
    v_mfma_f32_32x32x16_bf16 v[64:79], v[200:203], v[168:171], v[64:79]
    ds_read_b64_tr_b16 v[192:193], v224 offset:12288
    ds_read_b64_tr_b16 v[194:195], v224 offset:14336
    v_exp_f32 v159, v159
    v_add_f32 v228, v228, v158
    s_waitcnt lgkmcnt(6)
    v_mfma_f32_32x32x16_bf16 v[80:95], v[204:207], v[168:171], v[80:95]
    ds_read_b64_tr_b16 v[196:197], v225 offset:12288
    ds_read_b64_tr_b16 v[198:199], v225 offset:14336
    v_add_f32 v229, v229, v159
    v_cvt_pk_bf16_f32 v175, v158, v159
    s_waitcnt lgkmcnt(6)
    v_mfma_f32_32x32x16_bf16 v[96:111], v[208:211], v[168:171], v[96:111]
    ds_read_b64_tr_b16 v[200:201], v226 offset:12288
    ds_read_b64_tr_b16 v[202:203], v226 offset:14336
    s_waitcnt lgkmcnt(6)
    v_mfma_f32_32x32x16_bf16 v[112:127], v[212:215], v[168:171], v[112:127]
    ds_read_b64_tr_b16 v[204:205], v227 offset:12288
    ds_read_b64_tr_b16 v[206:207], v227 offset:14336
    v_exp_f32 v128, v128
    v_exp_f32 v129, v129
    s_waitcnt lgkmcnt(6)
    v_mfma_f32_32x32x16_bf16 v[64:79], v[192:195], v[172:175], v[64:79]
    ds_read_b128 v[208:211], v216 offset:24576
    v_exp_f32 v130, v130
    v_add_f32 v228, v228, v128
    v_add_f32 v229, v229, v129
    v_cvt_pk_bf16_f32 v160, v128, v129
    s_waitcnt lgkmcnt(5)
    v_mfma_f32_32x32x16_bf16 v[80:95], v[196:199], v[172:175], v[80:95]
    ds_read_b128 v[212:215], v217 offset:24576
    v_exp_f32 v131, v131
    v_add_f32 v228, v228, v130
    s_waitcnt lgkmcnt(4)
    v_mfma_f32_32x32x16_bf16 v[96:111], v[200:203], v[172:175], v[96:111]
    ds_read_b128 v[192:195], v218 offset:24576
    v_exp_f32 v132, v132
    v_add_f32 v229, v229, v131
    v_cvt_pk_bf16_f32 v161, v130, v131
    s_waitcnt lgkmcnt(3)
    v_mfma_f32_32x32x16_bf16 v[112:127], v[204:207], v[172:175], v[112:127]
    ds_read_b128 v[196:199], v219 offset:24576
    v_exp_f32 v133, v133
    v_add_f32 v228, v228, v132
    s_waitcnt lgkmcnt(3)
    v_mfma_f32_32x32x16_bf16 v[144:159], v[208:211], v[32:35], v[176:191]
    ds_read_b128 v[200:203], v220 offset:24576
    v_exp_f32 v134, v134
    v_add_f32 v229, v229, v133
    v_cvt_pk_bf16_f32 v162, v132, v133
    s_waitcnt lgkmcnt(3)
    v_mfma_f32_32x32x16_bf16 v[144:159], v[212:215], v[36:39], v[144:159]
    ds_read_b128 v[204:207], v221 offset:24576
    v_exp_f32 v135, v135
    v_add_f32 v228, v228, v134
    s_waitcnt lgkmcnt(3)
    v_mfma_f32_32x32x16_bf16 v[144:159], v[192:195], v[40:43], v[144:159]
    ds_read_b128 v[208:211], v222 offset:24576
    v_exp_f32 v136, v136
    v_exp_f32 v137, v137
    v_add_f32 v229, v229, v135
    v_cvt_pk_bf16_f32 v163, v134, v135
    s_waitcnt lgkmcnt(3)
    v_mfma_f32_32x32x16_bf16 v[144:159], v[196:199], v[44:47], v[144:159]
    ds_read_b128 v[212:215], v223 offset:24576
    v_exp_f32 v138, v138
    v_add_f32 v228, v228, v136
    v_add_f32 v229, v229, v137
    v_cvt_pk_bf16_f32 v164, v136, v137
    s_waitcnt lgkmcnt(3)
    v_mfma_f32_32x32x16_bf16 v[144:159], v[200:203], v[48:51], v[144:159]
    ds_read_b64_tr_b16 v[192:193], v224 offset:16384
    ds_read_b64_tr_b16 v[194:195], v224 offset:18432
    v_exp_f32 v139, v139
    v_add_f32 v228, v228, v138
    s_waitcnt lgkmcnt(4)
    v_mfma_f32_32x32x16_bf16 v[144:159], v[204:207], v[52:55], v[144:159]
    ds_read_b64_tr_b16 v[196:197], v225 offset:16384
    ds_read_b64_tr_b16 v[198:199], v225 offset:18432
    v_exp_f32 v140, v140
    v_add_f32 v229, v229, v139
    v_cvt_pk_bf16_f32 v165, v138, v139
    s_waitcnt lgkmcnt(5)
    v_mfma_f32_32x32x16_bf16 v[144:159], v[208:211], v[56:59], v[144:159]
    ds_read_b64_tr_b16 v[200:201], v226 offset:16384
    ds_read_b64_tr_b16 v[202:203], v226 offset:18432
    v_exp_f32 v141, v141
    v_add_f32 v228, v228, v140
    s_waitcnt lgkmcnt(6)
    v_mfma_f32_32x32x16_bf16 v[144:159], v[212:215], v[60:63], v[144:159]
    ds_read_b64_tr_b16 v[204:205], v227 offset:16384
    ds_read_b64_tr_b16 v[206:207], v227 offset:18432
    v_exp_f32 v142, v142
    v_add_f32 v229, v229, v141
    v_cvt_pk_bf16_f32 v166, v140, v141
    s_waitcnt lgkmcnt(6)
    v_mfma_f32_32x32x16_bf16 v[64:79], v[192:195], v[160:163], v[64:79]
    ds_read_b64_tr_b16 v[208:209], v224 offset:20480
    ds_read_b64_tr_b16 v[210:211], v224 offset:22528
    v_exp_f32 v143, v143
    v_add_f32 v228, v228, v142
    s_waitcnt lgkmcnt(6)
    v_mfma_f32_32x32x16_bf16 v[80:95], v[196:199], v[160:163], v[80:95]
    ds_read_b64_tr_b16 v[212:213], v225 offset:20480
    ds_read_b64_tr_b16 v[214:215], v225 offset:22528
    v_add_f32 v229, v229, v143
    v_cvt_pk_bf16_f32 v167, v142, v143
    s_waitcnt lgkmcnt(6)
    v_mfma_f32_32x32x16_bf16 v[96:111], v[200:203], v[160:163], v[96:111]
    ds_read_b64_tr_b16 v[192:193], v226 offset:20480
    ds_read_b64_tr_b16 v[194:195], v226 offset:22528
    s_waitcnt lgkmcnt(6)
    v_mfma_f32_32x32x16_bf16 v[112:127], v[204:207], v[160:163], v[112:127]
    ds_read_b64_tr_b16 v[196:197], v227 offset:20480
    ds_read_b64_tr_b16 v[198:199], v227 offset:22528
    v_exp_f32 v144, v144
    v_exp_f32 v145, v145
    s_waitcnt lgkmcnt(6)
    v_mfma_f32_32x32x16_bf16 v[64:79], v[208:211], v[164:167], v[64:79]
    s_waitcnt vmcnt(7)
    s_barrier
    ds_read_b128 v[200:203], v216 offset:32768
    s_waitcnt vmcnt(4)
    ds_read_b64_tr_b16 v[8:9], v26 offset:0
    ds_read_b64_tr_b16 v[10:11], v26 offset:512
    v_exp_f32 v146, v146
    v_add_f32 v228, v228, v144
    v_add_f32 v229, v229, v145
    v_cvt_pk_bf16_f32 v168, v144, v145
    s_waitcnt lgkmcnt(7)
    v_mfma_f32_32x32x16_bf16 v[80:95], v[212:215], v[164:167], v[80:95]
    ds_read_b128 v[204:207], v217 offset:32768
    ds_read_b64_tr_b16 v[12:13], v26 offset:32
    ds_read_b64_tr_b16 v[14:15], v26 offset:544
    v_exp_f32 v147, v147
    v_add_f32 v228, v228, v146
    s_waitcnt lgkmcnt(8)
    v_mfma_f32_32x32x16_bf16 v[96:111], v[192:195], v[164:167], v[96:111]
    ds_read_b128 v[208:211], v218 offset:32768
    ds_read_b64_tr_b16 v[16:17], v26 offset:64
    ds_read_b64_tr_b16 v[18:19], v26 offset:576
    v_exp_f32 v148, v148
    v_add_f32 v229, v229, v147
    v_cvt_pk_bf16_f32 v169, v146, v147
    s_waitcnt lgkmcnt(9)
    v_mfma_f32_32x32x16_bf16 v[112:127], v[196:199], v[164:167], v[112:127]
    ds_read_b128 v[212:215], v219 offset:32768
    ds_read_b64_tr_b16 v[20:21], v26 offset:96
    ds_read_b64_tr_b16 v[22:23], v26 offset:608
    v_exp_f32 v149, v149
    v_add_f32 v228, v228, v148
    s_waitcnt lgkmcnt(11)
    v_mfma_f32_32x32x16_bf16 v[128:143], v[200:203], v[32:35], v[176:191]
    ds_read_b128 v[192:195], v220 offset:32768
    s_waitcnt lgkmcnt(1)
    buffer_store_dwordx4 v[8:11], v28, s[4:7], s85 offen sc1
    s_add_u32 s85, s85, s87
    v_exp_f32 v150, v150
    v_add_f32 v229, v229, v149
    v_cvt_pk_bf16_f32 v170, v148, v149
    v_mfma_f32_32x32x16_bf16 v[128:143], v[204:207], v[36:39], v[128:143]
    ds_read_b128 v[196:199], v221 offset:32768
    v_exp_f32 v151, v151
    v_add_f32 v228, v228, v150
    v_mfma_f32_32x32x16_bf16 v[128:143], v[208:211], v[40:43], v[128:143]
    ds_read_b128 v[200:203], v222 offset:32768
    v_exp_f32 v152, v152
    v_exp_f32 v153, v153
    v_add_f32 v229, v229, v151
    v_cvt_pk_bf16_f32 v171, v150, v151
    v_mfma_f32_32x32x16_bf16 v[128:143], v[212:215], v[44:47], v[128:143]
    ds_read_b128 v[204:207], v223 offset:32768
    v_exp_f32 v154, v154
    v_add_f32 v228, v228, v152
    v_add_f32 v229, v229, v153
    v_cvt_pk_bf16_f32 v172, v152, v153
    s_waitcnt lgkmcnt(3)
    v_mfma_f32_32x32x16_bf16 v[128:143], v[192:195], v[48:51], v[128:143]
    ds_read_b64_tr_b16 v[208:209], v224 offset:24576
    ds_read_b64_tr_b16 v[210:211], v224 offset:26624
    buffer_store_dwordx4 v[12:15], v28, s[4:7], s85 offen sc1
    s_add_u32 s85, s85, s87
    v_exp_f32 v155, v155
    v_add_f32 v228, v228, v154
    s_waitcnt lgkmcnt(4)
    v_mfma_f32_32x32x16_bf16 v[128:143], v[196:199], v[52:55], v[128:143]
    ds_read_b64_tr_b16 v[212:213], v225 offset:24576
    ds_read_b64_tr_b16 v[214:215], v225 offset:26624
    v_exp_f32 v156, v156
    v_add_f32 v229, v229, v155
    v_cvt_pk_bf16_f32 v173, v154, v155
    s_waitcnt lgkmcnt(5)
    v_mfma_f32_32x32x16_bf16 v[128:143], v[200:203], v[56:59], v[128:143]
    ds_read_b64_tr_b16 v[192:193], v226 offset:24576
    ds_read_b64_tr_b16 v[194:195], v226 offset:26624
    v_exp_f32 v157, v157
    v_add_f32 v228, v228, v156
    s_waitcnt lgkmcnt(6)
    v_mfma_f32_32x32x16_bf16 v[128:143], v[204:207], v[60:63], v[128:143]
    ds_read_b64_tr_b16 v[196:197], v227 offset:24576
    ds_read_b64_tr_b16 v[198:199], v227 offset:26624
    v_exp_f32 v158, v158
    v_add_f32 v229, v229, v157
    v_cvt_pk_bf16_f32 v174, v156, v157
    s_waitcnt lgkmcnt(6)
    v_mfma_f32_32x32x16_bf16 v[64:79], v[208:211], v[168:171], v[64:79]
    ds_read_b64_tr_b16 v[200:201], v224 offset:28672
    ds_read_b64_tr_b16 v[202:203], v224 offset:30720
    buffer_store_dwordx4 v[16:19], v28, s[4:7], s85 offen sc1
    s_add_u32 s85, s85, s87
    v_exp_f32 v159, v159
    v_add_f32 v228, v228, v158
    s_waitcnt lgkmcnt(6)
    v_mfma_f32_32x32x16_bf16 v[80:95], v[212:215], v[168:171], v[80:95]
    ds_read_b64_tr_b16 v[204:205], v225 offset:28672
    ds_read_b64_tr_b16 v[206:207], v225 offset:30720
    v_add_f32 v229, v229, v159
    v_cvt_pk_bf16_f32 v175, v158, v159
    s_waitcnt lgkmcnt(6)
    v_mfma_f32_32x32x16_bf16 v[96:111], v[192:195], v[168:171], v[96:111]
    ds_read_b64_tr_b16 v[208:209], v226 offset:28672
    ds_read_b64_tr_b16 v[210:211], v226 offset:30720
    s_waitcnt lgkmcnt(6)
    v_mfma_f32_32x32x16_bf16 v[112:127], v[196:199], v[168:171], v[112:127]
    ds_read_b64_tr_b16 v[212:213], v227 offset:28672
    ds_read_b64_tr_b16 v[214:215], v227 offset:30720
    v_exp_f32 v128, v128
    v_exp_f32 v129, v129
    s_waitcnt lgkmcnt(6)
    v_mfma_f32_32x32x16_bf16 v[64:79], v[200:203], v[172:175], v[64:79]
    ds_read_b128 v[192:195], v216 offset:40960
    buffer_store_dwordx4 v[20:23], v28, s[4:7], s85 offen sc1
    v_exp_f32 v130, v130
    v_add_f32 v228, v228, v128
    v_add_f32 v229, v229, v129
    v_cvt_pk_bf16_f32 v160, v128, v129
    s_waitcnt lgkmcnt(5)
    v_mfma_f32_32x32x16_bf16 v[80:95], v[204:207], v[172:175], v[80:95]
    ds_read_b128 v[196:199], v217 offset:40960
    v_exp_f32 v131, v131
    v_add_f32 v228, v228, v130
    s_waitcnt lgkmcnt(4)
    v_mfma_f32_32x32x16_bf16 v[96:111], v[208:211], v[172:175], v[96:111]
    ds_read_b128 v[200:203], v218 offset:40960
    v_exp_f32 v132, v132
    v_add_f32 v229, v229, v131
    v_cvt_pk_bf16_f32 v161, v130, v131
    s_waitcnt lgkmcnt(3)
    v_mfma_f32_32x32x16_bf16 v[112:127], v[212:215], v[172:175], v[112:127]
    ds_read_b128 v[204:207], v219 offset:40960
    v_exp_f32 v133, v133
    v_add_f32 v228, v228, v132
    s_waitcnt lgkmcnt(3)
    v_mfma_f32_32x32x16_bf16 v[144:159], v[192:195], v[32:35], v[176:191]
    ds_read_b128 v[208:211], v220 offset:40960
    v_exp_f32 v134, v134
    v_add_f32 v229, v229, v133
    v_cvt_pk_bf16_f32 v162, v132, v133
    s_waitcnt lgkmcnt(3)
    v_mfma_f32_32x32x16_bf16 v[144:159], v[196:199], v[36:39], v[144:159]
    ds_read_b128 v[212:215], v221 offset:40960
    v_exp_f32 v135, v135
    v_add_f32 v228, v228, v134
    s_waitcnt lgkmcnt(3)
    v_mfma_f32_32x32x16_bf16 v[144:159], v[200:203], v[40:43], v[144:159]
    ds_read_b128 v[192:195], v222 offset:40960
    v_exp_f32 v136, v136
    v_exp_f32 v137, v137
    v_add_f32 v229, v229, v135
    v_cvt_pk_bf16_f32 v163, v134, v135
    s_waitcnt lgkmcnt(3)
    v_mfma_f32_32x32x16_bf16 v[144:159], v[204:207], v[44:47], v[144:159]
    ds_read_b128 v[196:199], v223 offset:40960
    v_exp_f32 v138, v138
    v_add_f32 v228, v228, v136
    v_add_f32 v229, v229, v137
    v_cvt_pk_bf16_f32 v164, v136, v137
    s_waitcnt lgkmcnt(3)
    v_mfma_f32_32x32x16_bf16 v[144:159], v[208:211], v[48:51], v[144:159]
    ds_read_b64_tr_b16 v[200:201], v224 offset:32768
    ds_read_b64_tr_b16 v[202:203], v224 offset:34816
    v_exp_f32 v139, v139
    v_add_f32 v228, v228, v138
    s_waitcnt lgkmcnt(4)
    v_mfma_f32_32x32x16_bf16 v[144:159], v[212:215], v[52:55], v[144:159]
    ds_read_b64_tr_b16 v[204:205], v225 offset:32768
    ds_read_b64_tr_b16 v[206:207], v225 offset:34816
    v_exp_f32 v140, v140
    v_add_f32 v229, v229, v139
    v_cvt_pk_bf16_f32 v165, v138, v139
    s_waitcnt lgkmcnt(5)
    v_mfma_f32_32x32x16_bf16 v[144:159], v[192:195], v[56:59], v[144:159]
    ds_read_b64_tr_b16 v[208:209], v226 offset:32768
    ds_read_b64_tr_b16 v[210:211], v226 offset:34816
    v_exp_f32 v141, v141
    v_add_f32 v228, v228, v140
    s_waitcnt lgkmcnt(6)
    v_mfma_f32_32x32x16_bf16 v[144:159], v[196:199], v[60:63], v[144:159]
    ds_read_b64_tr_b16 v[212:213], v227 offset:32768
    ds_read_b64_tr_b16 v[214:215], v227 offset:34816
    v_exp_f32 v142, v142
    v_add_f32 v229, v229, v141
    v_cvt_pk_bf16_f32 v166, v140, v141
    s_waitcnt lgkmcnt(6)
    v_mfma_f32_32x32x16_bf16 v[64:79], v[200:203], v[160:163], v[64:79]
    ds_read_b64_tr_b16 v[192:193], v224 offset:36864
    ds_read_b64_tr_b16 v[194:195], v224 offset:38912
    v_exp_f32 v143, v143
    v_add_f32 v228, v228, v142
    s_waitcnt lgkmcnt(6)
    v_mfma_f32_32x32x16_bf16 v[80:95], v[204:207], v[160:163], v[80:95]
    ds_read_b64_tr_b16 v[196:197], v225 offset:36864
    ds_read_b64_tr_b16 v[198:199], v225 offset:38912
    v_add_f32 v229, v229, v143
    v_cvt_pk_bf16_f32 v167, v142, v143
    s_waitcnt lgkmcnt(6)
    v_mfma_f32_32x32x16_bf16 v[96:111], v[208:211], v[160:163], v[96:111]
    ds_read_b64_tr_b16 v[200:201], v226 offset:36864
    ds_read_b64_tr_b16 v[202:203], v226 offset:38912
    s_waitcnt lgkmcnt(6)
    v_mfma_f32_32x32x16_bf16 v[112:127], v[212:215], v[160:163], v[112:127]
    ds_read_b64_tr_b16 v[204:205], v227 offset:36864
    ds_read_b64_tr_b16 v[206:207], v227 offset:38912
    v_exp_f32 v144, v144
    v_exp_f32 v145, v145
    s_waitcnt lgkmcnt(6)
    v_mfma_f32_32x32x16_bf16 v[64:79], v[192:195], v[164:167], v[64:79]
    s_waitcnt vmcnt(0)
    s_barrier
    s_cmp_lg_u32 s3, 0
    s_cbranch_scc1 L_w0_53
    s_lshl_b32 s59, s2, 2
    s_add_u32 s59, s59, 81920
    v_mov_b32 v250, s24
    v_mul_u32_u24 v251, 1024, v0
    s_mov_b64 exec, 255
    buffer_atomic_swap v250, v251, s[4:7], s59 offen
    s_mov_b64 exec, -1
L_w0_53:
    s_cmp_lg_u32 s3, 0
    s_cbranch_scc1 L_w0_54
    s_and_b32 s59, s2, 7
    s_lshl_b32 s58, s59, 10
    s_add_u32 s58, s58, 73728
    v_lshlrev_b32 v245, 4, v0
    buffer_load_dwordx4 v[240:243], v245, s[4:7], s58 offen sc1
    s_lshl_b32 s58, s59, 7
    s_add_u32 s58, s58, 34816
    v_lshlrev_b32 v245, 2, v0
    buffer_load_dword v244, v245, s[4:7], s58 offen sc1
    s_lshl_b32 s58, s59, 8
    s_add_u32 s58, s58, 32848
    buffer_load_dword v246, v245, s[4:7], s58 offen sc1
L_w0_54:
    ds_read_b128 v[208:211], v216 offset:49152
    v_exp_f32 v146, v146
    v_add_f32 v228, v228, v144
    v_add_f32 v229, v229, v145
    v_cvt_pk_bf16_f32 v168, v144, v145
    s_waitcnt lgkmcnt(5)
    v_mfma_f32_32x32x16_bf16 v[80:95], v[196:199], v[164:167], v[80:95]
    ds_read_b128 v[212:215], v217 offset:49152
    v_exp_f32 v147, v147
    v_add_f32 v228, v228, v146
    s_waitcnt lgkmcnt(4)
    v_mfma_f32_32x32x16_bf16 v[96:111], v[200:203], v[164:167], v[96:111]
    ds_read_b128 v[192:195], v218 offset:49152
    v_exp_f32 v148, v148
    v_add_f32 v229, v229, v147
    v_cvt_pk_bf16_f32 v169, v146, v147
    s_waitcnt lgkmcnt(3)
    v_mfma_f32_32x32x16_bf16 v[112:127], v[204:207], v[164:167], v[112:127]
    ds_read_b128 v[196:199], v219 offset:49152
    v_exp_f32 v149, v149
    v_add_f32 v228, v228, v148
    s_waitcnt lgkmcnt(3)
    v_mfma_f32_32x32x16_bf16 v[128:143], v[208:211], v[32:35], v[176:191]
    ds_read_b128 v[200:203], v220 offset:49152
    v_exp_f32 v150, v150
    v_add_f32 v229, v229, v149
    v_cvt_pk_bf16_f32 v170, v148, v149
    s_waitcnt lgkmcnt(3)
    v_mfma_f32_32x32x16_bf16 v[128:143], v[212:215], v[36:39], v[128:143]
    ds_read_b128 v[204:207], v221 offset:49152
    v_exp_f32 v151, v151
    v_add_f32 v228, v228, v150
    s_waitcnt lgkmcnt(3)
    v_mfma_f32_32x32x16_bf16 v[128:143], v[192:195], v[40:43], v[128:143]
    ds_read_b128 v[208:211], v222 offset:49152
    v_exp_f32 v152, v152
    v_exp_f32 v153, v153
    v_add_f32 v229, v229, v151
    v_cvt_pk_bf16_f32 v171, v150, v151
    s_waitcnt lgkmcnt(3)
    v_mfma_f32_32x32x16_bf16 v[128:143], v[196:199], v[44:47], v[128:143]
    ds_read_b128 v[212:215], v223 offset:49152
    v_exp_f32 v154, v154
    v_add_f32 v228, v228, v152
    v_add_f32 v229, v229, v153
    v_cvt_pk_bf16_f32 v172, v152, v153
    s_waitcnt lgkmcnt(3)
    v_mfma_f32_32x32x16_bf16 v[128:143], v[200:203], v[48:51], v[128:143]
    ds_read_b64_tr_b16 v[192:193], v224 offset:40960
    ds_read_b64_tr_b16 v[194:195], v224 offset:43008
    v_exp_f32 v155, v155
    v_add_f32 v228, v228, v154
    s_waitcnt lgkmcnt(4)
    v_mfma_f32_32x32x16_bf16 v[128:143], v[204:207], v[52:55], v[128:143]
    ds_read_b64_tr_b16 v[196:197], v225 offset:40960
    ds_read_b64_tr_b16 v[198:199], v225 offset:43008
    v_exp_f32 v156, v156
    v_add_f32 v229, v229, v155
    v_cvt_pk_bf16_f32 v173, v154, v155
    s_waitcnt lgkmcnt(5)
    v_mfma_f32_32x32x16_bf16 v[128:143], v[208:211], v[56:59], v[128:143]
    ds_read_b64_tr_b16 v[200:201], v226 offset:40960
    ds_read_b64_tr_b16 v[202:203], v226 offset:43008
    v_exp_f32 v157, v157
    v_add_f32 v228, v228, v156
    s_waitcnt lgkmcnt(6)
    v_mfma_f32_32x32x16_bf16 v[128:143], v[212:215], v[60:63], v[128:143]
    ds_read_b64_tr_b16 v[204:205], v227 offset:40960
    ds_read_b64_tr_b16 v[206:207], v227 offset:43008
    v_exp_f32 v158, v158
    v_add_f32 v229, v229, v157
    v_cvt_pk_bf16_f32 v174, v156, v157
    s_waitcnt lgkmcnt(6)
    v_mfma_f32_32x32x16_bf16 v[64:79], v[192:195], v[168:171], v[64:79]
    ds_read_b64_tr_b16 v[208:209], v224 offset:45056
    ds_read_b64_tr_b16 v[210:211], v224 offset:47104
    v_exp_f32 v159, v159
    v_add_f32 v228, v228, v158
    s_waitcnt lgkmcnt(6)
    v_mfma_f32_32x32x16_bf16 v[80:95], v[196:199], v[168:171], v[80:95]
    ds_read_b64_tr_b16 v[212:213], v225 offset:45056
    ds_read_b64_tr_b16 v[214:215], v225 offset:47104
    v_add_f32 v229, v229, v159
    v_cvt_pk_bf16_f32 v175, v158, v159
    s_waitcnt lgkmcnt(6)
    v_mfma_f32_32x32x16_bf16 v[96:111], v[200:203], v[168:171], v[96:111]
    ds_read_b64_tr_b16 v[192:193], v226 offset:45056
    ds_read_b64_tr_b16 v[194:195], v226 offset:47104
    s_waitcnt lgkmcnt(6)
    v_mfma_f32_32x32x16_bf16 v[112:127], v[204:207], v[168:171], v[112:127]
    ds_read_b64_tr_b16 v[196:197], v227 offset:45056
    ds_read_b64_tr_b16 v[198:199], v227 offset:47104
    v_exp_f32 v128, v128
    v_exp_f32 v129, v129
    s_waitcnt lgkmcnt(6)
    v_mfma_f32_32x32x16_bf16 v[64:79], v[208:211], v[172:175], v[64:79]
    ds_read_b128 v[200:203], v216 offset:57344
    v_exp_f32 v130, v130
    v_add_f32 v228, v228, v128
    v_add_f32 v229, v229, v129
    v_cvt_pk_bf16_f32 v160, v128, v129
    s_waitcnt lgkmcnt(5)
    v_mfma_f32_32x32x16_bf16 v[80:95], v[212:215], v[172:175], v[80:95]
    ds_read_b128 v[204:207], v217 offset:57344
    v_exp_f32 v131, v131
    v_add_f32 v228, v228, v130
    s_waitcnt lgkmcnt(4)
    v_mfma_f32_32x32x16_bf16 v[96:111], v[192:195], v[172:175], v[96:111]
    ds_read_b128 v[208:211], v218 offset:57344
    v_exp_f32 v132, v132
    v_add_f32 v229, v229, v131
    v_cvt_pk_bf16_f32 v161, v130, v131
    s_waitcnt lgkmcnt(3)
    v_mfma_f32_32x32x16_bf16 v[112:127], v[196:199], v[172:175], v[112:127]
    ds_read_b128 v[212:215], v219 offset:57344
    v_exp_f32 v133, v133
    v_add_f32 v228, v228, v132
    s_waitcnt lgkmcnt(3)
    v_mfma_f32_32x32x16_bf16 v[144:159], v[200:203], v[32:35], v[176:191]
    ds_read_b128 v[192:195], v220 offset:57344
    v_exp_f32 v134, v134
    v_add_f32 v229, v229, v133
    v_cvt_pk_bf16_f32 v162, v132, v133
    s_waitcnt lgkmcnt(3)
    v_mfma_f32_32x32x16_bf16 v[144:159], v[204:207], v[36:39], v[144:159]
    ds_read_b128 v[196:199], v221 offset:57344
    v_exp_f32 v135, v135
    v_add_f32 v228, v228, v134
    s_waitcnt lgkmcnt(3)
    v_mfma_f32_32x32x16_bf16 v[144:159], v[208:211], v[40:43], v[144:159]
    ds_read_b128 v[200:203], v222 offset:57344
    v_exp_f32 v136, v136
    v_exp_f32 v137, v137
    v_add_f32 v229, v229, v135
    v_cvt_pk_bf16_f32 v163, v134, v135
    s_waitcnt lgkmcnt(3)
    v_mfma_f32_32x32x16_bf16 v[144:159], v[212:215], v[44:47], v[144:159]
    ds_read_b128 v[204:207], v223 offset:57344
    v_exp_f32 v138, v138
    v_add_f32 v228, v228, v136
    v_add_f32 v229, v229, v137
    v_cvt_pk_bf16_f32 v164, v136, v137
    s_waitcnt lgkmcnt(3)
    v_mfma_f32_32x32x16_bf16 v[144:159], v[192:195], v[48:51], v[144:159]
    ds_read_b64_tr_b16 v[208:209], v224 offset:49152
    ds_read_b64_tr_b16 v[210:211], v224 offset:51200
    v_exp_f32 v139, v139
    v_add_f32 v228, v228, v138
    s_waitcnt lgkmcnt(4)
    v_mfma_f32_32x32x16_bf16 v[144:159], v[196:199], v[52:55], v[144:159]
    ds_read_b64_tr_b16 v[212:213], v225 offset:49152
    ds_read_b64_tr_b16 v[214:215], v225 offset:51200
    v_exp_f32 v140, v140
    v_add_f32 v229, v229, v139
    v_cvt_pk_bf16_f32 v165, v138, v139
    s_waitcnt lgkmcnt(5)
    v_mfma_f32_32x32x16_bf16 v[144:159], v[200:203], v[56:59], v[144:159]
    ds_read_b64_tr_b16 v[192:193], v226 offset:49152
    ds_read_b64_tr_b16 v[194:195], v226 offset:51200
    v_exp_f32 v141, v141
    v_add_f32 v228, v228, v140
    s_waitcnt lgkmcnt(6)
    v_mfma_f32_32x32x16_bf16 v[144:159], v[204:207], v[60:63], v[144:159]
    ds_read_b64_tr_b16 v[196:197], v227 offset:49152
    ds_read_b64_tr_b16 v[198:199], v227 offset:51200
    v_exp_f32 v142, v142
    v_add_f32 v229, v229, v141
    v_cvt_pk_bf16_f32 v166, v140, v141
    s_waitcnt lgkmcnt(6)
    v_mfma_f32_32x32x16_bf16 v[64:79], v[208:211], v[160:163], v[64:79]
    ds_read_b64_tr_b16 v[200:201], v224 offset:53248
    ds_read_b64_tr_b16 v[202:203], v224 offset:55296
    v_exp_f32 v143, v143
    v_add_f32 v228, v228, v142
    s_waitcnt lgkmcnt(6)
    v_mfma_f32_32x32x16_bf16 v[80:95], v[212:215], v[160:163], v[80:95]
    ds_read_b64_tr_b16 v[204:205], v225 offset:53248
    ds_read_b64_tr_b16 v[206:207], v225 offset:55296
    v_add_f32 v229, v229, v143
    v_cvt_pk_bf16_f32 v167, v142, v143
    s_waitcnt lgkmcnt(6)
    v_mfma_f32_32x32x16_bf16 v[96:111], v[192:195], v[160:163], v[96:111]
    ds_read_b64_tr_b16 v[208:209], v226 offset:53248
    ds_read_b64_tr_b16 v[210:211], v226 offset:55296
    s_waitcnt lgkmcnt(6)
    v_mfma_f32_32x32x16_bf16 v[112:127], v[196:199], v[160:163], v[112:127]
    ds_read_b64_tr_b16 v[212:213], v227 offset:53248
    ds_read_b64_tr_b16 v[214:215], v227 offset:55296
    v_exp_f32 v144, v144
    v_exp_f32 v145, v145
    v_exp_f32 v146, v146
    s_waitcnt lgkmcnt(6)
    v_mfma_f32_32x32x16_bf16 v[64:79], v[200:203], v[164:167], v[64:79]
    ds_read_b64_tr_b16 v[192:193], v224 offset:57344
    ds_read_b64_tr_b16 v[194:195], v224 offset:59392
    v_exp_f32 v147, v147
    v_exp_f32 v148, v148
    v_exp_f32 v149, v149
    v_add_f32 v228, v228, v144
    v_add_f32 v229, v229, v145
    v_cvt_pk_bf16_f32 v168, v144, v145
    v_add_f32 v228, v228, v146
    s_waitcnt lgkmcnt(6)
    v_mfma_f32_32x32x16_bf16 v[80:95], v[204:207], v[164:167], v[80:95]
    ds_read_b64_tr_b16 v[196:197], v225 offset:57344
    ds_read_b64_tr_b16 v[198:199], v225 offset:59392
    v_exp_f32 v150, v150
    v_exp_f32 v151, v151
    v_add_f32 v229, v229, v147
    v_cvt_pk_bf16_f32 v169, v146, v147
    v_add_f32 v228, v228, v148
    v_add_f32 v229, v229, v149
    v_cvt_pk_bf16_f32 v170, v148, v149
    s_waitcnt lgkmcnt(6)
    v_mfma_f32_32x32x16_bf16 v[96:111], v[208:211], v[164:167], v[96:111]
    ds_read_b64_tr_b16 v[200:201], v226 offset:57344
    ds_read_b64_tr_b16 v[202:203], v226 offset:59392
    v_exp_f32 v152, v152
    v_exp_f32 v153, v153
    v_exp_f32 v154, v154
    v_add_f32 v228, v228, v150
    v_add_f32 v229, v229, v151
    v_cvt_pk_bf16_f32 v171, v150, v151
    s_waitcnt lgkmcnt(6)
    v_mfma_f32_32x32x16_bf16 v[112:127], v[212:215], v[164:167], v[112:127]
    ds_read_b64_tr_b16 v[204:205], v227 offset:57344
    ds_read_b64_tr_b16 v[206:207], v227 offset:59392
    v_exp_f32 v155, v155
    v_exp_f32 v156, v156
    v_exp_f32 v157, v157
    v_add_f32 v228, v228, v152
    v_add_f32 v229, v229, v153
    v_cvt_pk_bf16_f32 v172, v152, v153
    v_add_f32 v228, v228, v154
    s_waitcnt lgkmcnt(6)
    v_mfma_f32_32x32x16_bf16 v[64:79], v[192:195], v[168:171], v[64:79]
    ds_read_b64_tr_b16 v[208:209], v224 offset:61440
    ds_read_b64_tr_b16 v[210:211], v224 offset:63488
    v_exp_f32 v158, v158
    v_exp_f32 v159, v159
    v_add_f32 v229, v229, v155
    v_cvt_pk_bf16_f32 v173, v154, v155
    v_add_f32 v228, v228, v156
    v_add_f32 v229, v229, v157
    v_cvt_pk_bf16_f32 v174, v156, v157
    s_waitcnt lgkmcnt(6)
    v_mfma_f32_32x32x16_bf16 v[80:95], v[196:199], v[168:171], v[80:95]
    ds_read_b64_tr_b16 v[212:213], v225 offset:61440
    ds_read_b64_tr_b16 v[214:215], v225 offset:63488
    v_add_f32 v228, v228, v158
    v_add_f32 v229, v229, v159
    v_cvt_pk_bf16_f32 v175, v158, v159
    s_waitcnt lgkmcnt(6)
    v_mfma_f32_32x32x16_bf16 v[96:111], v[200:203], v[168:171], v[96:111]
    ds_read_b64_tr_b16 v[192:193], v226 offset:61440
    ds_read_b64_tr_b16 v[194:195], v226 offset:63488
    s_waitcnt lgkmcnt(6)
    v_mfma_f32_32x32x16_bf16 v[112:127], v[204:207], v[168:171], v[112:127]
    ds_read_b64_tr_b16 v[196:197], v227 offset:61440
    ds_read_b64_tr_b16 v[198:199], v227 offset:63488
    s_waitcnt lgkmcnt(6)
    v_mfma_f32_32x32x16_bf16 v[64:79], v[208:211], v[172:175], v[64:79]
    s_waitcnt lgkmcnt(4)
    v_mfma_f32_32x32x16_bf16 v[80:95], v[212:215], v[172:175], v[80:95]
    s_waitcnt lgkmcnt(2)
    v_mfma_f32_32x32x16_bf16 v[96:111], v[192:195], v[172:175], v[96:111]
    s_waitcnt lgkmcnt(0)
    v_mfma_f32_32x32x16_bf16 v[112:127], v[196:199], v[172:175], v[112:127]
    s_cmp_lg_u32 s3, 0
    s_cbranch_scc1 L_w0_55
    s_waitcnt vmcnt(0)
    v_xor_b32 v240, s24, v240
    v_xor_b32 v241, s24, v241
    v_or_b32 v240, v240, v241
    v_xor_b32 v242, s24, v242
    v_or_b32 v240, v240, v242
    v_xor_b32 v243, s24, v243
    v_or_b32 v240, v240, v243
    v_and_b32 v245, -16, v244
    v_xor_b32 v245, s24, v245
    v_cmp_gt_u32 vcc, 32, v0
    s_nop 1
    v_cndmask_b32 v245, 0, v245, vcc
    v_or_b32 v240, v240, v245
    v_xor_b32 v246, s24, v246
    v_cmp_gt_u32 vcc, 40, v0
    s_nop 1
    v_cndmask_b32 v246, 0, v246, vcc
    v_or_b32 v240, v240, v246
    v_cmp_ne_u32 vcc, 0, v240
    v_mov_b32 v252, v244
    s_nop 1
    s_cmp_eq_u64 vcc, 0
    s_cbranch_scc1 L_relok_57
L_relslow_56:
    s_and_b32 s59, s2, 7
    s_lshl_b32 s59, s59, 8
    s_add_u32 s59, s59, 32848
    v_lshlrev_b32 v251, 2, v0
    s_mov_b32 s58, 0
    s_mov_b32 s60, 0xffffffff
    s_mov_b32 s61, 0xff
    s_mov_b64 exec, s[60:61]
L_poll_58:
    buffer_load_dword v252, v251, s[4:7], s59 offen sc1
    s_waitcnt vmcnt(0)
    v_cmp_ne_u32 vcc, s24, v252
    s_nop 1
    s_and_b64 vcc, vcc, s[60:61]
    s_cbranch_scc0 L_polld_59
    s_sleep 1
    s_add_u32 s58, s58, 1
    s_cmp_lt_u32 s58, 32768
    s_cbranch_scc1 L_poll_58
    s_load_dwordx2 s[20:21], s[0:1], 104
    s_waitcnt lgkmcnt(0)
    s_and_b32 s21, s21, 0xffff
    s_mov_b32 s22, 256
    s_mov_b32 s23, 0x20000
    v_mov_b32 v253, 0xdead0006
    v_mov_b32 v251, 28
    s_mov_b64 exec, 1
    buffer_store_dword v253, v251, s[20:23], 0 offen
L_polld_59:
    s_mov_b64 exec, -1
    s_and_b32 s59, s2, 7
    s_lshl_b32 s59, s59, 10
    s_add_u32 s59, s59, 73728
    v_lshlrev_b32 v251, 4, v0
    s_mov_b32 s58, 0
    s_mov_b32 s60, 0xffffffff
    s_mov_b32 s61, 0xffffffff
    s_mov_b64 exec, s[60:61]
L_poll_60:
    buffer_load_dwordx4 v[252:255], v251, s[4:7], s59 offen sc1
    s_waitcnt vmcnt(0)
    v_xor_b32 v252, s24, v252
    v_xor_b32 v253, s24, v253
    v_or_b32 v252, v252, v253
    v_xor_b32 v254, s24, v254
    v_or_b32 v252, v252, v254
    v_xor_b32 v255, s24, v255
    v_or_b32 v252, v252, v255
    v_cmp_ne_u32 vcc, 0, v252
    s_nop 1
    s_and_b64 vcc, vcc, s[60:61]
    s_cbranch_scc0 L_polld_61
    s_sleep 1
    s_add_u32 s58, s58, 1
    s_cmp_lt_u32 s58, 32768
    s_cbranch_scc1 L_poll_60
    s_load_dwordx2 s[20:21], s[0:1], 104
    s_waitcnt lgkmcnt(0)
    s_and_b32 s21, s21, 0xffff
    s_mov_b32 s22, 256
    s_mov_b32 s23, 0x20000
    v_mov_b32 v253, 0xdead0004
    v_mov_b32 v251, 20
    s_mov_b64 exec, 1
    buffer_store_dword v253, v251, s[20:23], 0 offen
L_polld_61:
    s_mov_b64 exec, -1
    s_and_b32 s59, s2, 7
    s_lshl_b32 s59, s59, 7
    s_add_u32 s59, s59, 34816
    v_lshlrev_b32 v251, 2, v0
    s_mov_b32 s58, 0
    s_mov_b32 s60, 0xffffffff
    s_mov_b32 s61, 0x0
    s_mov_b64 exec, s[60:61]
L_poll_62:
    buffer_load_dword v252, v251, s[4:7], s59 offen sc1
    s_waitcnt vmcnt(0)
    v_and_b32 v253, -16, v252
    v_cmp_ne_u32 vcc, s24, v253
    s_nop 1
    s_and_b64 vcc, vcc, s[60:61]
    s_cbranch_scc0 L_polld_63
    s_sleep 1
    s_add_u32 s58, s58, 1
    s_cmp_lt_u32 s58, 32768
    s_cbranch_scc1 L_poll_62
    s_load_dwordx2 s[20:21], s[0:1], 104
    s_waitcnt lgkmcnt(0)
    s_and_b32 s21, s21, 0xffff
    s_mov_b32 s22, 256
    s_mov_b32 s23, 0x20000
    v_mov_b32 v253, 0xdead0002
    v_mov_b32 v251, 12
    s_mov_b64 exec, 1
    buffer_store_dword v253, v251, s[20:23], 0 offen
L_polld_63:
    s_mov_b64 exec, -1
L_relok_57:
    s_mov_b32 exec_lo, -1
    s_mov_b32 exec_hi, 0
    v_and_b32 v252, 15, v252
    s_getreg_b32 s28, hwreg(HW_REG_XCC_ID, 0, 4)
    v_cmp_ne_u32 vcc, s28, v252
    s_mov_b64 exec, -1
    s_nop 1
    s_cmp_eq_u32 vcc_lo, 0
    s_cselect_b32 s28, 1, 0
    v_mov_b32 v250, s28
    v_mov_b32 v251, 140000
    ds_write_b32 v251, v250
L_w0_55:
    v_add_f32 v230, v228, v229
    v_mov_b32 v231, 0x4e800000
    v_cmp_nle_f32 vcc, v230, v231
    s_nop 1
    s_cmp_lg_u64 vcc, 0
    s_cselect_b32 s45, 1, 0
    s_lshl_b32 s46, s3, 2
    s_add_u32 s46, s46, 140032
    v_mov_b32 v230, s45
    v_mov_b32 v231, s46
    ds_write_b32 v231, v230
    v_add_f32 v228, v228, v229
    v_mov_b32 v229, v228
    s_nop 1
    v_permlane32_swap_b32 v228, v229
    v_add_f32 v228, v228, v229
    v_rcp_f32 v228, v228
    v_and_b32 v1, 31, v0
    s_lshl_b32 s45, s41, 8
    s_lshl_b32 s46, s3, 5
    s_add_u32 s45, s45, s46
    v_add_u32 v1, s45, v1
    v_lshrrev_b32 v2, 4, v1
    v_mul_u32_u24 v2, 131072, v2
    v_and_b32 v1, 15, v1
    v_lshlrev_b32 v1, 4, v1
    v_add_u32 v2, v2, v1
    v_lshrrev_b32 v1, 5, v0
    v_lshlrev_b32 v1, 8, v1
    v_add_u32 v2, v2, v1
    s_lshl_b32 s45, s40, 12
    s_add_u32 s45, s45, 33554432
    v_mov_b32 v229, v228
    v_pk_mul_f32 v[64:65], v[64:65], v[228:229]
    v_pk_mul_f32 v[66:67], v[66:67], v[228:229]
    v_pk_mul_f32 v[68:69], v[68:69], v[228:229]
    v_pk_mul_f32 v[70:71], v[70:71], v[228:229]
    v_pk_mul_f32 v[72:73], v[72:73], v[228:229]
    v_pk_mul_f32 v[74:75], v[74:75], v[228:229]
    v_pk_mul_f32 v[76:77], v[76:77], v[228:229]
    v_pk_mul_f32 v[78:79], v[78:79], v[228:229]
    v_cvt_pk_bf16_f32 v128, v64, v65
    v_cvt_pk_bf16_f32 v129, v66, v67
    v_cvt_pk_bf16_f32 v130, v68, v69
    v_cvt_pk_bf16_f32 v131, v70, v71
    v_cvt_pk_bf16_f32 v132, v72, v73
    v_cvt_pk_bf16_f32 v133, v74, v75
    v_cvt_pk_bf16_f32 v134, v76, v77
    v_cvt_pk_bf16_f32 v135, v78, v79
    v_permlane32_swap_b32 v128, v130
    v_permlane32_swap_b32 v129, v131
    buffer_store_dwordx4 v[128:131], v2, s[4:7], s45 offen offset:0 sc1
    v_permlane32_swap_b32 v132, v134
    v_permlane32_swap_b32 v133, v135
    buffer_store_dwordx4 v[132:135], v2, s[4:7], s45 offen offset:512 sc1
    v_pk_mul_f32 v[80:81], v[80:81], v[228:229]
    v_pk_mul_f32 v[82:83], v[82:83], v[228:229]
    v_pk_mul_f32 v[84:85], v[84:85], v[228:229]
    v_pk_mul_f32 v[86:87], v[86:87], v[228:229]
    v_pk_mul_f32 v[88:89], v[88:89], v[228:229]
    v_pk_mul_f32 v[90:91], v[90:91], v[228:229]
    v_pk_mul_f32 v[92:93], v[92:93], v[228:229]
    v_pk_mul_f32 v[94:95], v[94:95], v[228:229]
    v_cvt_pk_bf16_f32 v144, v80, v81
    v_cvt_pk_bf16_f32 v145, v82, v83
    v_cvt_pk_bf16_f32 v146, v84, v85
    v_cvt_pk_bf16_f32 v147, v86, v87
    v_cvt_pk_bf16_f32 v148, v88, v89
    v_cvt_pk_bf16_f32 v149, v90, v91
    v_cvt_pk_bf16_f32 v150, v92, v93
    v_cvt_pk_bf16_f32 v151, v94, v95
    v_permlane32_swap_b32 v144, v146
    v_permlane32_swap_b32 v145, v147
    buffer_store_dwordx4 v[144:147], v2, s[4:7], s45 offen offset:1024 sc1
    v_permlane32_swap_b32 v148, v150
    v_permlane32_swap_b32 v149, v151
    buffer_store_dwordx4 v[148:151], v2, s[4:7], s45 offen offset:1536 sc1
    v_pk_mul_f32 v[96:97], v[96:97], v[228:229]
    v_pk_mul_f32 v[98:99], v[98:99], v[228:229]
    v_pk_mul_f32 v[100:101], v[100:101], v[228:229]
    v_pk_mul_f32 v[102:103], v[102:103], v[228:229]
    v_pk_mul_f32 v[104:105], v[104:105], v[228:229]
    v_pk_mul_f32 v[106:107], v[106:107], v[228:229]
    v_pk_mul_f32 v[108:109], v[108:109], v[228:229]
    v_pk_mul_f32 v[110:111], v[110:111], v[228:229]
    v_cvt_pk_bf16_f32 v128, v96, v97
    v_cvt_pk_bf16_f32 v129, v98, v99
    v_cvt_pk_bf16_f32 v130, v100, v101
    v_cvt_pk_bf16_f32 v131, v102, v103
    v_cvt_pk_bf16_f32 v132, v104, v105
    v_cvt_pk_bf16_f32 v133, v106, v107
    v_cvt_pk_bf16_f32 v134, v108, v109
    v_cvt_pk_bf16_f32 v135, v110, v111
    v_permlane32_swap_b32 v128, v130
    v_permlane32_swap_b32 v129, v131
    buffer_store_dwordx4 v[128:131], v2, s[4:7], s45 offen offset:2048 sc1
    v_permlane32_swap_b32 v132, v134
    v_permlane32_swap_b32 v133, v135
    buffer_store_dwordx4 v[132:135], v2, s[4:7], s45 offen offset:2560 sc1
    v_pk_mul_f32 v[112:113], v[112:113], v[228:229]
    v_pk_mul_f32 v[114:115], v[114:115], v[228:229]
    v_pk_mul_f32 v[116:117], v[116:117], v[228:229]
    v_pk_mul_f32 v[118:119], v[118:119], v[228:229]
    v_pk_mul_f32 v[120:121], v[120:121], v[228:229]
    v_pk_mul_f32 v[122:123], v[122:123], v[228:229]
    v_pk_mul_f32 v[124:125], v[124:125], v[228:229]
    v_pk_mul_f32 v[126:127], v[126:127], v[228:229]
    v_cvt_pk_bf16_f32 v144, v112, v113
    v_cvt_pk_bf16_f32 v145, v114, v115
    v_cvt_pk_bf16_f32 v146, v116, v117
    v_cvt_pk_bf16_f32 v147, v118, v119
    v_cvt_pk_bf16_f32 v148, v120, v121
    v_cvt_pk_bf16_f32 v149, v122, v123
    v_cvt_pk_bf16_f32 v150, v124, v125
    v_cvt_pk_bf16_f32 v151, v126, v127
    v_permlane32_swap_b32 v144, v146
    v_permlane32_swap_b32 v145, v147
    buffer_store_dwordx4 v[144:147], v2, s[4:7], s45 offen offset:3072 sc1
    v_permlane32_swap_b32 v148, v150
    v_permlane32_swap_b32 v149, v151
    buffer_store_dwordx4 v[148:151], v2, s[4:7], s45 offen offset:3584 sc1
    s_waitcnt lgkmcnt(0)
    s_barrier
    v_mov_b32 v251, 140000
    ds_read_b32 v250, v251
    ds_read_b128 v[252:255], v251 offset:32
    ds_read_b128 v[240:243], v251 offset:48
    s_waitcnt lgkmcnt(0)
    v_readfirstlane_b32 s29, v250
    v_or3_b32 v252, v252, v253, v254
    v_or3_b32 v240, v240, v241, v242
    v_or3_b32 v252, v252, v255, v243
    v_or_b32 v252, v252, v240
    s_nop 0
    v_readfirstlane_b32 s45, v252
    s_nop 0
    s_cmp_lg_u32 s45, 0
    s_cbranch_scc1 L_safe_in_64
L_safe_back_65:
    s_and_b32 s89, s2, 7
    s_lshl_b32 s89, s89, 5
    s_lshr_b32 s58, s2, 3
    s_add_u32 s89, s89, s58
    s_lshl_b32 s89, s89, 2
    s_add_u32 s89, s89, 45056
    v_lshlrev_b32 v1, 4, v0
    s_bfe_u32 s25, s2, 0x20003
    s_mul_i32 s25, s25, 10
    s_and_b32 s26, s2, 3
    s_lshl_b32 s26, s26, 5
    s_add_u32 s27, s25, s3
    s_mul_i32 s27, s27, 128
    s_add_u32 s27, s27, s26
    s_lshl_b32 s27, s27, 10
    s_add_u32 s52, s27, 4194304
    s_lshr_b32 s27, s3, 2
    s_add_u32 s27, s27, 8
    s_add_u32 s28, s27, s25
    s_mul_i32 s28, s28, 128
    s_add_u32 s28, s28, s26
    s_and_b32 s26, s3, 3
    s_add_u32 s28, s28, s26
    s_lshl_b32 s28, s28, 10
    s_add_u32 s62, s28, 4194304
    s_lshl_b32 s53, s3, 12
    s_lshl_b32 s27, s27, 2
    s_add_u32 s27, s27, s26
    s_lshl_b32 s63, s27, 10
    s_and_b32 s45, s2, 7
    s_lshr_b32 s46, s2, 3
    s_and_b32 s40, s45, 3
    s_lshr_b32 s45, s45, 2
    s_lshl_b32 s45, s45, 3
    s_lshr_b32 s41, s46, 2
    s_add_u32 s41, s41, s45
    s_and_b32 s42, s46, 3
    s_and_b32 s43, s3, 3
    s_lshr_b32 s44, s3, 2
    v_lshlrev_b32 v1, 4, v0
    s_lshl_b32 s45, s44, 11
    v_add_u32 v2, s45, v1
    v_add_u32 v3, 0x10000, v2
    v_add_u32 v4, 0x20000, v2
    s_lshl_b32 s45, s41, 3
    s_lshl_b32 s46, s43, 1
    s_add_u32 s45, s45, s46
    s_lshl_b32 s47, s40, 5
    s_lshl_b32 s48, s44, 1
    s_add_u32 s47, s47, s48
    s_lshl_b32 s47, s47, 10
    s_add_u32 s47, s47, 33554432
    s_add_u32 s46, s45, s44
    s_mul_i32 s46, s46, 131072
    s_add_u32 s46, s46, s47
    v_add_u32 v5, s46, v1
    s_add_u32 s46, s45, 1
    s_sub_u32 s46, s46, s44
    s_mul_i32 s46, s46, 131072
    s_add_u32 s46, s46, s47
    v_add_u32 v6, s46, v1
    s_lshl_b32 s45, s43, 1
    s_add_u32 s46, s45, s44
    s_mul_i32 s46, s46, 10240
    v_add_u32 v8, s46, v1
    s_add_u32 s46, s45, 1
    s_sub_u32 s46, s46, s44
    s_mul_i32 s46, s46, 10240
    v_add_u32 v9, s46, v1
    s_lshl_b32 s49, s41, 3
    s_lshl_b32 s46, s43, 1
    s_add_u32 s49, s49, s46
    s_add_u32 s49, s49, s44
    v_lshrrev_b32 v10, 5, v0
    v_lshlrev_b32 v10, 8, v10
    v_and_b32 v30, 15, v0
    v_lshlrev_b32 v30, 4, v30
    v_add_u32 v10, v10, v30
    v_bfe_u32 v30, v0, 4, 1
    v_lshlrev_b32 v30, 3, v30
    v_add_u32 v10, v10, v30
    s_mul_i32 s45, s49, 20480
    v_add_u32 v10, s45, v10
    s_mul_i32 s45, s40, 2621440
    s_mul_i32 s46, s42, 5120
    s_add_u32 s45, s45, s46
    s_add_u32 s55, s45, 17825792
    s_cmp_eq_u32 s3, 0
    s_cbranch_scc1 L_be_66
    s_add_u32 s50, s52, 0
    s_add_u32 m0, s53, 0
    s_nop 0
    buffer_load_dwordx4 v1, s[4:7], s50 offen sc1 lds
    buffer_load_dwordx4 v1, s[4:7], s50 offen offset:1024 sc1 lds
    buffer_load_dwordx4 v1, s[4:7], s50 offen offset:2048 sc1 lds
    buffer_load_dwordx4 v1, s[4:7], s50 offen offset:3072 sc1 lds
    s_add_u32 s50, s62, 0
    s_add_u32 m0, s63, 0
    s_nop 0
    buffer_load_dwordx4 v1, s[4:7], s50 offen sc1 lds
    s_add_u32 s50, s52, 4096
    s_add_u32 m0, s53, 40960
    s_nop 0
    buffer_load_dwordx4 v1, s[4:7], s50 offen sc1 lds
    buffer_load_dwordx4 v1, s[4:7], s50 offen offset:1024 sc1 lds
    buffer_load_dwordx4 v1, s[4:7], s50 offen offset:2048 sc1 lds
    buffer_load_dwordx4 v1, s[4:7], s50 offen offset:3072 sc1 lds
    s_add_u32 s50, s62, 4096
    s_add_u32 m0, s63, 40960
    s_nop 0
    buffer_load_dwordx4 v1, s[4:7], s50 offen sc1 lds
    s_add_u32 s50, s52, 8192
    s_add_u32 m0, s53, 81920
    s_nop 0
    buffer_load_dwordx4 v1, s[4:7], s50 offen sc1 lds
    buffer_load_dwordx4 v1, s[4:7], s50 offen offset:1024 sc1 lds
    buffer_load_dwordx4 v1, s[4:7], s50 offen offset:2048 sc1 lds
    buffer_load_dwordx4 v1, s[4:7], s50 offen offset:3072 sc1 lds
    s_add_u32 s50, s62, 8192
    s_add_u32 m0, s63, 81920
    s_nop 0
    buffer_load_dwordx4 v1, s[4:7], s50 offen sc1 lds
    s_waitcnt vmcnt(15)
L_be_66:
    s_cmp_lg_u32 s3, 0
    s_cbranch_scc1 L_be2_67
    s_waitcnt vmcnt(0)
L_be2_67:
    s_barrier
    s_cmp_eq_u32 s3, 0
    s_cbranch_scc1 L_b0_68
    s_branch L_b1_69
L_b0_68:
    v_mov_b32 v250, s24
    v_mov_b32 v251, 0
    s_mov_b64 exec, 1
    s_cmp_eq_u32 s29, 0
    s_cbranch_scc1 L_fl_70
    buffer_store_dword v250, v251, s[4:7], s89 offen
    s_branch L_fj_71
L_fl_70:
    buffer_atomic_swap v250, v251, s[4:7], s89 offen
L_fj_71:
    s_mov_b64 exec, -1
    s_and_b32 s59, s2, 7
    s_lshl_b32 s59, s59, 10
    s_add_u32 s59, s59, 81920
    v_lshlrev_b32 v251, 4, v0
    s_mov_b32 s58, 0
    s_mov_b32 s60, 0xffffffff
    s_mov_b32 s61, 0xffffffff
    s_mov_b64 exec, s[60:61]
L_poll_72:
    buffer_load_dwordx4 v[252:255], v251, s[4:7], s59 offen sc1
    s_waitcnt vmcnt(0)
    v_xor_b32 v252, s24, v252
    v_xor_b32 v253, s24, v253
    v_or_b32 v252, v252, v253
    v_xor_b32 v254, s24, v254
    v_or_b32 v252, v252, v254
    v_xor_b32 v255, s24, v255
    v_or_b32 v252, v252, v255
    v_cmp_ne_u32 vcc, 0, v252
    s_nop 1
    s_and_b64 vcc, vcc, s[60:61]
    s_cbranch_scc0 L_polld_73
    s_sleep 1
    s_add_u32 s58, s58, 1
    s_cmp_lt_u32 s58, 32768
    s_cbranch_scc1 L_poll_72
    s_load_dwordx2 s[20:21], s[0:1], 104
    s_waitcnt lgkmcnt(0)
    s_and_b32 s21, s21, 0xffff
    s_mov_b32 s22, 256
    s_mov_b32 s23, 0x20000
    v_mov_b32 v253, 0xdead000d
    v_mov_b32 v251, 56
    s_mov_b64 exec, 1
    buffer_store_dword v253, v251, s[20:23], 0 offen
L_polld_73:
    s_mov_b64 exec, -1
    s_and_b32 s59, s2, 7
    s_lshl_b32 s59, s59, 7
    s_lshr_b32 s58, s2, 6
    s_lshl_b32 s58, s58, 5
    s_add_u32 s59, s59, s58
    s_add_u32 s59, s59, 45056
    v_lshlrev_b32 v251, 2, v0
    s_mov_b32 s58, 0
    s_mov_b32 s60, 0xff
    s_mov_b32 s61, 0x0
    s_mov_b64 exec, s[60:61]
L_poll_74:
    buffer_load_dword v252, v251, s[4:7], s59 offen sc1
    s_waitcnt vmcnt(0)
    v_cmp_ne_u32 vcc, s24, v252
    s_nop 1
    s_and_b64 vcc, vcc, s[60:61]
    s_cbranch_scc0 L_polld_75
    s_sleep 1
    s_add_u32 s58, s58, 1
    s_cmp_lt_u32 s58, 32768
    s_cbranch_scc1 L_poll_74
    s_load_dwordx2 s[20:21], s[0:1], 104
    s_waitcnt lgkmcnt(0)
    s_and_b32 s21, s21, 0xffff
    s_mov_b32 s22, 256
    s_mov_b32 s23, 0x20000
    v_mov_b32 v253, 0xdead0005
    v_mov_b32 v251, 24
    s_mov_b64 exec, 1
    buffer_store_dword v253, v251, s[20:23], 0 offen
L_polld_75:
    s_mov_b64 exec, -1
    s_add_u32 s50, s52, 0
    s_add_u32 m0, s53, 0
    s_nop 0
    buffer_load_dwordx4 v1, s[4:7], s50 offen sc1 lds
    buffer_load_dwordx4 v1, s[4:7], s50 offen offset:1024 sc1 lds
    buffer_load_dwordx4 v1, s[4:7], s50 offen offset:2048 sc1 lds
    buffer_load_dwordx4 v1, s[4:7], s50 offen offset:3072 sc1 lds
    s_add_u32 s50, s62, 0
    s_add_u32 m0, s63, 0
    s_nop 0
    buffer_load_dwordx4 v1, s[4:7], s50 offen sc1 lds
    s_add_u32 s50, s52, 4096
    s_add_u32 m0, s53, 40960
    s_nop 0
    buffer_load_dwordx4 v1, s[4:7], s50 offen sc1 lds
    buffer_load_dwordx4 v1, s[4:7], s50 offen offset:1024 sc1 lds
    buffer_load_dwordx4 v1, s[4:7], s50 offen offset:2048 sc1 lds
    buffer_load_dwordx4 v1, s[4:7], s50 offen offset:3072 sc1 lds
    s_add_u32 s50, s62, 4096
    s_add_u32 m0, s63, 40960
    s_nop 0
    buffer_load_dwordx4 v1, s[4:7], s50 offen sc1 lds
    s_add_u32 s50, s52, 8192
    s_add_u32 m0, s53, 81920
    s_nop 0
    buffer_load_dwordx4 v1, s[4:7], s50 offen sc1 lds
    buffer_load_dwordx4 v1, s[4:7], s50 offen offset:1024 sc1 lds
    buffer_load_dwordx4 v1, s[4:7], s50 offen offset:2048 sc1 lds
    buffer_load_dwordx4 v1, s[4:7], s50 offen offset:3072 sc1 lds
    s_add_u32 s50, s62, 8192
    s_add_u32 m0, s63, 81920
    s_nop 0
    buffer_load_dwordx4 v1, s[4:7], s50 offen sc1 lds
L_b1_69:
    s_waitcnt vmcnt(0)
    s_barrier
    s_mov_b32 s54, 0
    buffer_load_dwordx4 v[32:35], v5, s[4:7], s54 offen sc1
    buffer_load_dwordx4 v[36:39], v6, s[4:7], s54 offen sc1
    s_mov_b32 s54, 1024
    buffer_load_dwordx4 v[40:43], v5, s[4:7], s54 offen sc1
    buffer_load_dwordx4 v[44:47], v6, s[4:7], s54 offen sc1
    s_mov_b32 s54, 4096
    buffer_load_dwordx4 v[48:51], v5, s[4:7], s54 offen sc1
    buffer_load_dwordx4 v[52:55], v6, s[4:7], s54 offen sc1
    ds_read_b128 v[80:83], v2 offset:0
    ds_read_b128 v[84:87], v2 offset:4096
    ds_read_b128 v[88:91], v2 offset:8192
    ds_read_b128 v[92:95], v2 offset:12288
    ds_read_b128 v[96:99], v2 offset:16384
    s_mov_b32 s54, 5120
    buffer_load_dwordx4 v[56:59], v5, s[4:7], s54 offen sc1
    buffer_load_dwordx4 v[60:63], v6, s[4:7], s54 offen sc1
    s_waitcnt vmcnt(7)
    s_waitcnt vmcnt(6)
    s_waitcnt lgkmcnt(4)
    v_mfma_f32_16x16x32_bf16 v[128:131], v[80:83], v[32:35], 0
    v_mfma_f32_16x16x32_bf16 v[168:171], v[80:83], v[36:39], 0
    ds_read_b128 v[100:103], v2 offset:20480
    s_waitcnt lgkmcnt(4)
    v_mfma_f32_16x16x32_bf16 v[132:135], v[84:87], v[32:35], 0
    v_mfma_f32_16x16x32_bf16 v[172:175], v[84:87], v[36:39], 0
    ds_read_b128 v[104:107], v2 offset:24576
    s_waitcnt lgkmcnt(4)
    v_mfma_f32_16x16x32_bf16 v[136:139], v[88:91], v[32:35], 0
    v_mfma_f32_16x16x32_bf16 v[176:179], v[88:91], v[36:39], 0
    ds_read_b128 v[108:111], v2 offset:28672
    s_waitcnt lgkmcnt(4)
    v_mfma_f32_16x16x32_bf16 v[140:143], v[92:95], v[32:35], 0
    v_mfma_f32_16x16x32_bf16 v[180:183], v[92:95], v[36:39], 0
    ds_read_b128 v[80:83], v2 offset:32768
    s_waitcnt lgkmcnt(4)
    v_mfma_f32_16x16x32_bf16 v[144:147], v[96:99], v[32:35], 0
    v_mfma_f32_16x16x32_bf16 v[184:187], v[96:99], v[36:39], 0
    ds_read_b128 v[84:87], v2 offset:36864
    s_waitcnt lgkmcnt(4)
    v_mfma_f32_16x16x32_bf16 v[148:151], v[100:103], v[32:35], 0
    v_mfma_f32_16x16x32_bf16 v[188:191], v[100:103], v[36:39], 0
    ds_read_b128 v[88:91], v2 offset:1024
    s_waitcnt lgkmcnt(4)
    v_mfma_f32_16x16x32_bf16 v[152:155], v[104:107], v[32:35], 0
    v_mfma_f32_16x16x32_bf16 v[192:195], v[104:107], v[36:39], 0
    ds_read_b128 v[92:95], v2 offset:5120
    s_waitcnt lgkmcnt(4)
    v_mfma_f32_16x16x32_bf16 v[156:159], v[108:111], v[32:35], 0
    v_mfma_f32_16x16x32_bf16 v[196:199], v[108:111], v[36:39], 0
    ds_read_b128 v[96:99], v2 offset:9216
    s_waitcnt lgkmcnt(4)
    v_mfma_f32_16x16x32_bf16 v[160:163], v[80:83], v[32:35], 0
    v_mfma_f32_16x16x32_bf16 v[200:203], v[80:83], v[36:39], 0
    ds_read_b128 v[100:103], v2 offset:13312
    s_waitcnt lgkmcnt(4)
    v_mfma_f32_16x16x32_bf16 v[164:167], v[84:87], v[32:35], 0
    v_mfma_f32_16x16x32_bf16 v[204:207], v[84:87], v[36:39], 0
    ds_read_b128 v[104:107], v2 offset:17408
    s_mov_b32 s54, 8192
    buffer_load_dwordx4 v[64:67], v5, s[4:7], s54 offen sc1
    buffer_load_dwordx4 v[68:71], v6, s[4:7], s54 offen sc1
    s_waitcnt vmcnt(7)
    s_waitcnt vmcnt(6)
    s_waitcnt lgkmcnt(4)
    v_mfma_f32_16x16x32_bf16 v[128:131], v[88:91], v[40:43], v[128:131]
    v_mfma_f32_16x16x32_bf16 v[168:171], v[88:91], v[44:47], v[168:171]
    ds_read_b128 v[108:111], v2 offset:21504
    s_waitcnt lgkmcnt(4)
    v_mfma_f32_16x16x32_bf16 v[132:135], v[92:95], v[40:43], v[132:135]
    v_mfma_f32_16x16x32_bf16 v[172:175], v[92:95], v[44:47], v[172:175]
    ds_read_b128 v[80:83], v2 offset:25600
    s_waitcnt lgkmcnt(4)
    v_mfma_f32_16x16x32_bf16 v[136:139], v[96:99], v[40:43], v[136:139]
    v_mfma_f32_16x16x32_bf16 v[176:179], v[96:99], v[44:47], v[176:179]
    ds_read_b128 v[84:87], v2 offset:29696
    s_waitcnt lgkmcnt(4)
    v_mfma_f32_16x16x32_bf16 v[140:143], v[100:103], v[40:43], v[140:143]
    v_mfma_f32_16x16x32_bf16 v[180:183], v[100:103], v[44:47], v[180:183]
    ds_read_b128 v[88:91], v2 offset:33792
    s_waitcnt lgkmcnt(4)
    v_mfma_f32_16x16x32_bf16 v[144:147], v[104:107], v[40:43], v[144:147]
    v_mfma_f32_16x16x32_bf16 v[184:187], v[104:107], v[44:47], v[184:187]
    ds_read_b128 v[92:95], v2 offset:37888
    s_waitcnt lgkmcnt(4)
    v_mfma_f32_16x16x32_bf16 v[148:151], v[108:111], v[40:43], v[148:151]
    v_mfma_f32_16x16x32_bf16 v[188:191], v[108:111], v[44:47], v[188:191]
    s_barrier
    s_add_u32 s50, s52, 12288
    s_add_u32 m0, s53, 122880
    s_nop 0
    buffer_load_dwordx4 v1, s[4:7], s50 offen sc1 lds
    buffer_load_dwordx4 v1, s[4:7], s50 offen offset:1024 sc1 lds
    buffer_load_dwordx4 v1, s[4:7], s50 offen offset:2048 sc1 lds
    buffer_load_dwordx4 v1, s[4:7], s50 offen offset:3072 sc1 lds
    s_add_u32 s50, s62, 12288
    s_add_u32 m0, s63, 122880
    s_nop 0
    buffer_load_dwordx4 v1, s[4:7], s50 offen sc1 lds
    ds_read_b128 v[96:99], v2 offset:40960
    s_waitcnt lgkmcnt(4)
    v_mfma_f32_16x16x32_bf16 v[152:155], v[80:83], v[40:43], v[152:155]
    v_mfma_f32_16x16x32_bf16 v[192:195], v[80:83], v[44:47], v[192:195]
    ds_read_b128 v[100:103], v2 offset:45056
    s_waitcnt lgkmcnt(4)
    v_mfma_f32_16x16x32_bf16 v[156:159], v[84:87], v[40:43], v[156:159]
    v_mfma_f32_16x16x32_bf16 v[196:199], v[84:87], v[44:47], v[196:199]
    ds_read_b128 v[104:107], v2 offset:49152
    s_waitcnt lgkmcnt(4)
    v_mfma_f32_16x16x32_bf16 v[160:163], v[88:91], v[40:43], v[160:163]
    v_mfma_f32_16x16x32_bf16 v[200:203], v[88:91], v[44:47], v[200:203]
    ds_read_b128 v[108:111], v2 offset:53248
    s_waitcnt lgkmcnt(4)
    v_mfma_f32_16x16x32_bf16 v[164:167], v[92:95], v[40:43], v[164:167]
    v_mfma_f32_16x16x32_bf16 v[204:207], v[92:95], v[44:47], v[204:207]
    ds_read_b128 v[80:83], v2 offset:57344
    s_mov_b32 s54, 9216
    buffer_load_dwordx4 v[72:75], v5, s[4:7], s54 offen sc1
    buffer_load_dwordx4 v[76:79], v6, s[4:7], s54 offen sc1
    s_waitcnt vmcnt(12)
    s_waitcnt vmcnt(11)
    s_waitcnt lgkmcnt(4)
    v_mfma_f32_16x16x32_bf16 v[128:131], v[96:99], v[48:51], v[128:131]
    v_mfma_f32_16x16x32_bf16 v[168:171], v[96:99], v[52:55], v[168:171]
    ds_read_b128 v[84:87], v2 offset:61440
    s_waitcnt lgkmcnt(4)
    v_mfma_f32_16x16x32_bf16 v[132:135], v[100:103], v[48:51], v[132:135]
    v_mfma_f32_16x16x32_bf16 v[172:175], v[100:103], v[52:55], v[172:175]
    ds_read_b128 v[88:91], v3 offset:0
    s_waitcnt lgkmcnt(4)
    v_mfma_f32_16x16x32_bf16 v[136:139], v[104:107], v[48:51], v[136:139]
    v_mfma_f32_16x16x32_bf16 v[176:179], v[104:107], v[52:55], v[176:179]
    ds_read_b128 v[92:95], v3 offset:4096
    s_waitcnt lgkmcnt(4)
    v_mfma_f32_16x16x32_bf16 v[140:143], v[108:111], v[48:51], v[140:143]
    v_mfma_f32_16x16x32_bf16 v[180:183], v[108:111], v[52:55], v[180:183]
    ds_read_b128 v[96:99], v3 offset:8192
    s_waitcnt lgkmcnt(4)
    v_mfma_f32_16x16x32_bf16 v[144:147], v[80:83], v[48:51], v[144:147]
    v_mfma_f32_16x16x32_bf16 v[184:187], v[80:83], v[52:55], v[184:187]
    ds_read_b128 v[100:103], v3 offset:12288
    s_waitcnt lgkmcnt(4)
    v_mfma_f32_16x16x32_bf16 v[148:151], v[84:87], v[48:51], v[148:151]
    v_mfma_f32_16x16x32_bf16 v[188:191], v[84:87], v[52:55], v[188:191]
    ds_read_b128 v[104:107], v2 offset:41984
    s_waitcnt lgkmcnt(4)
    v_mfma_f32_16x16x32_bf16 v[152:155], v[88:91], v[48:51], v[152:155]
    v_mfma_f32_16x16x32_bf16 v[192:195], v[88:91], v[52:55], v[192:195]
    ds_read_b128 v[108:111], v2 offset:46080
    s_waitcnt lgkmcnt(4)
    v_mfma_f32_16x16x32_bf16 v[156:159], v[92:95], v[48:51], v[156:159]
    v_mfma_f32_16x16x32_bf16 v[196:199], v[92:95], v[52:55], v[196:199]
    ds_read_b128 v[80:83], v2 offset:50176
    s_waitcnt lgkmcnt(4)
    v_mfma_f32_16x16x32_bf16 v[160:163], v[96:99], v[48:51], v[160:163]
    v_mfma_f32_16x16x32_bf16 v[200:203], v[96:99], v[52:55], v[200:203]
    ds_read_b128 v[84:87], v2 offset:54272
    s_waitcnt lgkmcnt(4)
    v_mfma_f32_16x16x32_bf16 v[164:167], v[100:103], v[48:51], v[164:167]
    v_mfma_f32_16x16x32_bf16 v[204:207], v[100:103], v[52:55], v[204:207]
    ds_read_b128 v[88:91], v2 offset:58368
    s_mov_b32 s54, 12288
    buffer_load_dwordx4 v[32:35], v5, s[4:7], s54 offen sc1
    buffer_load_dwordx4 v[36:39], v6, s[4:7], s54 offen sc1
    s_waitcnt vmcnt(12)
    s_waitcnt vmcnt(11)
    s_waitcnt lgkmcnt(4)
    v_mfma_f32_16x16x32_bf16 v[128:131], v[104:107], v[56:59], v[128:131]
    v_mfma_f32_16x16x32_bf16 v[168:171], v[104:107], v[60:63], v[168:171]
    ds_read_b128 v[92:95], v2 offset:62464
    s_waitcnt lgkmcnt(4)
    v_mfma_f32_16x16x32_bf16 v[132:135], v[108:111], v[56:59], v[132:135]
    v_mfma_f32_16x16x32_bf16 v[172:175], v[108:111], v[60:63], v[172:175]
    ds_read_b128 v[96:99], v3 offset:1024
    s_waitcnt lgkmcnt(4)
    v_mfma_f32_16x16x32_bf16 v[136:139], v[80:83], v[56:59], v[136:139]
    v_mfma_f32_16x16x32_bf16 v[176:179], v[80:83], v[60:63], v[176:179]
    ds_read_b128 v[100:103], v3 offset:5120
    s_waitcnt lgkmcnt(4)
    v_mfma_f32_16x16x32_bf16 v[140:143], v[84:87], v[56:59], v[140:143]
    v_mfma_f32_16x16x32_bf16 v[180:183], v[84:87], v[60:63], v[180:183]
    ds_read_b128 v[104:107], v3 offset:9216
    s_waitcnt lgkmcnt(4)
    v_mfma_f32_16x16x32_bf16 v[144:147], v[88:91], v[56:59], v[144:147]
    v_mfma_f32_16x16x32_bf16 v[184:187], v[88:91], v[60:63], v[184:187]
    ds_read_b128 v[108:111], v3 offset:13312
    s_waitcnt lgkmcnt(4)
    v_mfma_f32_16x16x32_bf16 v[148:151], v[92:95], v[56:59], v[148:151]
    v_mfma_f32_16x16x32_bf16 v[188:191], v[92:95], v[60:63], v[188:191]
    s_barrier
    s_add_u32 s50, s52, 16384
    s_add_u32 m0, s53, 0
    s_nop 0
    buffer_load_dwordx4 v1, s[4:7], s50 offen sc1 lds
    buffer_load_dwordx4 v1, s[4:7], s50 offen offset:1024 sc1 lds
    buffer_load_dwordx4 v1, s[4:7], s50 offen offset:2048 sc1 lds
    buffer_load_dwordx4 v1, s[4:7], s50 offen offset:3072 sc1 lds
    s_add_u32 s50, s62, 16384
    s_add_u32 m0, s63, 0
    s_nop 0
    buffer_load_dwordx4 v1, s[4:7], s50 offen sc1 lds
    ds_read_b128 v[80:83], v3 offset:16384
    s_waitcnt lgkmcnt(4)
    v_mfma_f32_16x16x32_bf16 v[152:155], v[96:99], v[56:59], v[152:155]
    v_mfma_f32_16x16x32_bf16 v[192:195], v[96:99], v[60:63], v[192:195]
    ds_read_b128 v[84:87], v3 offset:20480
    s_waitcnt lgkmcnt(4)
    v_mfma_f32_16x16x32_bf16 v[156:159], v[100:103], v[56:59], v[156:159]
    v_mfma_f32_16x16x32_bf16 v[196:199], v[100:103], v[60:63], v[196:199]
    ds_read_b128 v[88:91], v3 offset:24576
    s_waitcnt lgkmcnt(4)
    v_mfma_f32_16x16x32_bf16 v[160:163], v[104:107], v[56:59], v[160:163]
    v_mfma_f32_16x16x32_bf16 v[200:203], v[104:107], v[60:63], v[200:203]
    ds_read_b128 v[92:95], v3 offset:28672
    s_waitcnt lgkmcnt(4)
    v_mfma_f32_16x16x32_bf16 v[164:167], v[108:111], v[56:59], v[164:167]
    v_mfma_f32_16x16x32_bf16 v[204:207], v[108:111], v[60:63], v[204:207]
    ds_read_b128 v[96:99], v3 offset:32768
    s_mov_b32 s54, 13312
    buffer_load_dwordx4 v[40:43], v5, s[4:7], s54 offen sc1
    buffer_load_dwordx4 v[44:47], v6, s[4:7], s54 offen sc1
    s_waitcnt vmcnt(17)
    s_waitcnt vmcnt(16)
    s_waitcnt lgkmcnt(4)
    v_mfma_f32_16x16x32_bf16 v[128:131], v[80:83], v[64:67], v[128:131]
    v_mfma_f32_16x16x32_bf16 v[168:171], v[80:83], v[68:71], v[168:171]
    ds_read_b128 v[100:103], v3 offset:36864
    s_waitcnt lgkmcnt(4)
    v_mfma_f32_16x16x32_bf16 v[132:135], v[84:87], v[64:67], v[132:135]
    v_mfma_f32_16x16x32_bf16 v[172:175], v[84:87], v[68:71], v[172:175]
    ds_read_b128 v[104:107], v3 offset:40960
    s_waitcnt lgkmcnt(4)
    v_mfma_f32_16x16x32_bf16 v[136:139], v[88:91], v[64:67], v[136:139]
    v_mfma_f32_16x16x32_bf16 v[176:179], v[88:91], v[68:71], v[176:179]
    ds_read_b128 v[108:111], v3 offset:45056
    s_waitcnt lgkmcnt(4)
    v_mfma_f32_16x16x32_bf16 v[140:143], v[92:95], v[64:67], v[140:143]
    v_mfma_f32_16x16x32_bf16 v[180:183], v[92:95], v[68:71], v[180:183]
    ds_read_b128 v[80:83], v3 offset:49152
    s_waitcnt lgkmcnt(4)
    v_mfma_f32_16x16x32_bf16 v[144:147], v[96:99], v[64:67], v[144:147]
    v_mfma_f32_16x16x32_bf16 v[184:187], v[96:99], v[68:71], v[184:187]
    ds_read_b128 v[84:87], v3 offset:53248
    s_waitcnt lgkmcnt(4)
    v_mfma_f32_16x16x32_bf16 v[148:151], v[100:103], v[64:67], v[148:151]
    v_mfma_f32_16x16x32_bf16 v[188:191], v[100:103], v[68:71], v[188:191]
    ds_read_b128 v[88:91], v3 offset:17408
    s_waitcnt lgkmcnt(4)
    v_mfma_f32_16x16x32_bf16 v[152:155], v[104:107], v[64:67], v[152:155]
    v_mfma_f32_16x16x32_bf16 v[192:195], v[104:107], v[68:71], v[192:195]
    ds_read_b128 v[92:95], v3 offset:21504
    s_waitcnt lgkmcnt(4)
    v_mfma_f32_16x16x32_bf16 v[156:159], v[108:111], v[64:67], v[156:159]
    v_mfma_f32_16x16x32_bf16 v[196:199], v[108:111], v[68:71], v[196:199]
    ds_read_b128 v[96:99], v3 offset:25600
    s_waitcnt lgkmcnt(4)
    v_mfma_f32_16x16x32_bf16 v[160:163], v[80:83], v[64:67], v[160:163]
    v_mfma_f32_16x16x32_bf16 v[200:203], v[80:83], v[68:71], v[200:203]
    ds_read_b128 v[100:103], v3 offset:29696
    s_waitcnt lgkmcnt(4)
    v_mfma_f32_16x16x32_bf16 v[164:167], v[84:87], v[64:67], v[164:167]
    v_mfma_f32_16x16x32_bf16 v[204:207], v[84:87], v[68:71], v[204:207]
    ds_read_b128 v[104:107], v3 offset:33792
    s_mov_b32 s54, 16384
    buffer_load_dwordx4 v[48:51], v5, s[4:7], s54 offen sc1
    buffer_load_dwordx4 v[52:55], v6, s[4:7], s54 offen sc1
    s_waitcnt vmcnt(12)
    s_waitcnt vmcnt(11)
    s_waitcnt lgkmcnt(4)
    v_mfma_f32_16x16x32_bf16 v[128:131], v[88:91], v[72:75], v[128:131]
    v_mfma_f32_16x16x32_bf16 v[168:171], v[88:91], v[76:79], v[168:171]
    ds_read_b128 v[108:111], v3 offset:37888
    s_waitcnt lgkmcnt(4)
    v_mfma_f32_16x16x32_bf16 v[132:135], v[92:95], v[72:75], v[132:135]
    v_mfma_f32_16x16x32_bf16 v[172:175], v[92:95], v[76:79], v[172:175]
    ds_read_b128 v[80:83], v3 offset:41984
    s_waitcnt lgkmcnt(4)
    v_mfma_f32_16x16x32_bf16 v[136:139], v[96:99], v[72:75], v[136:139]
    v_mfma_f32_16x16x32_bf16 v[176:179], v[96:99], v[76:79], v[176:179]
    ds_read_b128 v[84:87], v3 offset:46080
    s_waitcnt lgkmcnt(4)
    v_mfma_f32_16x16x32_bf16 v[140:143], v[100:103], v[72:75], v[140:143]
    v_mfma_f32_16x16x32_bf16 v[180:183], v[100:103], v[76:79], v[180:183]
    ds_read_b128 v[88:91], v3 offset:50176
    s_waitcnt lgkmcnt(4)
    v_mfma_f32_16x16x32_bf16 v[144:147], v[104:107], v[72:75], v[144:147]
    v_mfma_f32_16x16x32_bf16 v[184:187], v[104:107], v[76:79], v[184:187]
    ds_read_b128 v[92:95], v3 offset:54272
    s_waitcnt lgkmcnt(4)
    v_mfma_f32_16x16x32_bf16 v[148:151], v[108:111], v[72:75], v[148:151]
    v_mfma_f32_16x16x32_bf16 v[188:191], v[108:111], v[76:79], v[188:191]
    s_barrier
    s_add_u32 s50, s52, 20480
    s_add_u32 m0, s53, 40960
    s_nop 0
    buffer_load_dwordx4 v1, s[4:7], s50 offen sc1 lds
    buffer_load_dwordx4 v1, s[4:7], s50 offen offset:1024 sc1 lds
    buffer_load_dwordx4 v1, s[4:7], s50 offen offset:2048 sc1 lds
    buffer_load_dwordx4 v1, s[4:7], s50 offen offset:3072 sc1 lds
    s_add_u32 s50, s62, 20480
    s_add_u32 m0, s63, 40960
    s_nop 0
    buffer_load_dwordx4 v1, s[4:7], s50 offen sc1 lds
    ds_read_b128 v[96:99], v3 offset:57344
    s_waitcnt lgkmcnt(4)
    v_mfma_f32_16x16x32_bf16 v[152:155], v[80:83], v[72:75], v[152:155]
    v_mfma_f32_16x16x32_bf16 v[192:195], v[80:83], v[76:79], v[192:195]
    ds_read_b128 v[100:103], v3 offset:61440
    s_waitcnt lgkmcnt(4)
    v_mfma_f32_16x16x32_bf16 v[156:159], v[84:87], v[72:75], v[156:159]
    v_mfma_f32_16x16x32_bf16 v[196:199], v[84:87], v[76:79], v[196:199]
    ds_read_b128 v[104:107], v4 offset:0
    s_waitcnt lgkmcnt(4)
    v_mfma_f32_16x16x32_bf16 v[160:163], v[88:91], v[72:75], v[160:163]
    v_mfma_f32_16x16x32_bf16 v[200:203], v[88:91], v[76:79], v[200:203]
    ds_read_b128 v[108:111], v4 offset:4096
    s_waitcnt lgkmcnt(4)
    v_mfma_f32_16x16x32_bf16 v[164:167], v[92:95], v[72:75], v[164:167]
    v_mfma_f32_16x16x32_bf16 v[204:207], v[92:95], v[76:79], v[204:207]
    ds_read_b128 v[80:83], v4 offset:8192
    s_mov_b32 s54, 17408
    buffer_load_dwordx4 v[56:59], v5, s[4:7], s54 offen sc1
    buffer_load_dwordx4 v[60:63], v6, s[4:7], s54 offen sc1
    s_waitcnt vmcnt(17)
    s_waitcnt vmcnt(16)
    s_waitcnt lgkmcnt(4)
    v_mfma_f32_16x16x32_bf16 v[128:131], v[96:99], v[32:35], v[128:131]
    v_mfma_f32_16x16x32_bf16 v[168:171], v[96:99], v[36:39], v[168:171]
    ds_read_b128 v[84:87], v4 offset:12288
    s_waitcnt lgkmcnt(4)
    v_mfma_f32_16x16x32_bf16 v[132:135], v[100:103], v[32:35], v[132:135]
    v_mfma_f32_16x16x32_bf16 v[172:175], v[100:103], v[36:39], v[172:175]
    ds_read_b128 v[88:91], v4 offset:16384
    s_waitcnt lgkmcnt(4)
    v_mfma_f32_16x16x32_bf16 v[136:139], v[104:107], v[32:35], v[136:139]
    v_mfma_f32_16x16x32_bf16 v[176:179], v[104:107], v[36:39], v[176:179]
    ds_read_b128 v[92:95], v4 offset:20480
    s_waitcnt lgkmcnt(4)
    v_mfma_f32_16x16x32_bf16 v[140:143], v[108:111], v[32:35], v[140:143]
    v_mfma_f32_16x16x32_bf16 v[180:183], v[108:111], v[36:39], v[180:183]
    ds_read_b128 v[96:99], v4 offset:24576
    s_waitcnt lgkmcnt(4)
    v_mfma_f32_16x16x32_bf16 v[144:147], v[80:83], v[32:35], v[144:147]
    v_mfma_f32_16x16x32_bf16 v[184:187], v[80:83], v[36:39], v[184:187]
    ds_read_b128 v[100:103], v4 offset:28672
    s_waitcnt lgkmcnt(4)
    v_mfma_f32_16x16x32_bf16 v[148:151], v[84:87], v[32:35], v[148:151]
    v_mfma_f32_16x16x32_bf16 v[188:191], v[84:87], v[36:39], v[188:191]
    ds_read_b128 v[104:107], v3 offset:58368
    s_waitcnt lgkmcnt(4)
    v_mfma_f32_16x16x32_bf16 v[152:155], v[88:91], v[32:35], v[152:155]
    v_mfma_f32_16x16x32_bf16 v[192:195], v[88:91], v[36:39], v[192:195]
    ds_read_b128 v[108:111], v3 offset:62464
    s_waitcnt lgkmcnt(4)
    v_mfma_f32_16x16x32_bf16 v[156:159], v[92:95], v[32:35], v[156:159]
    v_mfma_f32_16x16x32_bf16 v[196:199], v[92:95], v[36:39], v[196:199]
    ds_read_b128 v[80:83], v4 offset:1024
    s_waitcnt lgkmcnt(4)
    v_mfma_f32_16x16x32_bf16 v[160:163], v[96:99], v[32:35], v[160:163]
    v_mfma_f32_16x16x32_bf16 v[200:203], v[96:99], v[36:39], v[200:203]
    ds_read_b128 v[84:87], v4 offset:5120
    s_waitcnt lgkmcnt(4)
    v_mfma_f32_16x16x32_bf16 v[164:167], v[100:103], v[32:35], v[164:167]
    v_mfma_f32_16x16x32_bf16 v[204:207], v[100:103], v[36:39], v[204:207]
    ds_read_b128 v[88:91], v4 offset:9216
    s_mov_b32 s54, 20480
    buffer_load_dwordx4 v[64:67], v5, s[4:7], s54 offen sc1
    buffer_load_dwordx4 v[68:71], v6, s[4:7], s54 offen sc1
    s_waitcnt vmcnt(12)
    s_waitcnt vmcnt(11)
    s_waitcnt lgkmcnt(4)
    v_mfma_f32_16x16x32_bf16 v[128:131], v[104:107], v[40:43], v[128:131]
    v_mfma_f32_16x16x32_bf16 v[168:171], v[104:107], v[44:47], v[168:171]
    ds_read_b128 v[92:95], v4 offset:13312
    s_waitcnt lgkmcnt(4)
    v_mfma_f32_16x16x32_bf16 v[132:135], v[108:111], v[40:43], v[132:135]
    v_mfma_f32_16x16x32_bf16 v[172:175], v[108:111], v[44:47], v[172:175]
    ds_read_b128 v[96:99], v4 offset:17408
    s_waitcnt lgkmcnt(4)
    v_mfma_f32_16x16x32_bf16 v[136:139], v[80:83], v[40:43], v[136:139]
    v_mfma_f32_16x16x32_bf16 v[176:179], v[80:83], v[44:47], v[176:179]
    ds_read_b128 v[100:103], v4 offset:21504
    s_waitcnt lgkmcnt(4)
    v_mfma_f32_16x16x32_bf16 v[140:143], v[84:87], v[40:43], v[140:143]
    v_mfma_f32_16x16x32_bf16 v[180:183], v[84:87], v[44:47], v[180:183]
    ds_read_b128 v[104:107], v4 offset:25600
    s_waitcnt lgkmcnt(4)
    v_mfma_f32_16x16x32_bf16 v[144:147], v[88:91], v[40:43], v[144:147]
    v_mfma_f32_16x16x32_bf16 v[184:187], v[88:91], v[44:47], v[184:187]
    ds_read_b128 v[108:111], v4 offset:29696
    s_waitcnt lgkmcnt(4)
    v_mfma_f32_16x16x32_bf16 v[148:151], v[92:95], v[40:43], v[148:151]
    v_mfma_f32_16x16x32_bf16 v[188:191], v[92:95], v[44:47], v[188:191]
    s_barrier
    s_add_u32 s50, s52, 24576
    s_add_u32 m0, s53, 81920
    s_nop 0
    buffer_load_dwordx4 v1, s[4:7], s50 offen sc1 lds
    buffer_load_dwordx4 v1, s[4:7], s50 offen offset:1024 sc1 lds
    buffer_load_dwordx4 v1, s[4:7], s50 offen offset:2048 sc1 lds
    buffer_load_dwordx4 v1, s[4:7], s50 offen offset:3072 sc1 lds
    s_add_u32 s50, s62, 24576
    s_add_u32 m0, s63, 81920
    s_nop 0
    buffer_load_dwordx4 v1, s[4:7], s50 offen sc1 lds
    ds_read_b128 v[80:83], v2 offset:0
    s_waitcnt lgkmcnt(4)
    v_mfma_f32_16x16x32_bf16 v[152:155], v[96:99], v[40:43], v[152:155]
    v_mfma_f32_16x16x32_bf16 v[192:195], v[96:99], v[44:47], v[192:195]
    ds_read_b128 v[84:87], v2 offset:4096
    s_waitcnt lgkmcnt(4)
    v_mfma_f32_16x16x32_bf16 v[156:159], v[100:103], v[40:43], v[156:159]
    v_mfma_f32_16x16x32_bf16 v[196:199], v[100:103], v[44:47], v[196:199]
    ds_read_b128 v[88:91], v2 offset:8192
    s_waitcnt lgkmcnt(4)
    v_mfma_f32_16x16x32_bf16 v[160:163], v[104:107], v[40:43], v[160:163]
    v_mfma_f32_16x16x32_bf16 v[200:203], v[104:107], v[44:47], v[200:203]
    ds_read_b128 v[92:95], v2 offset:12288
    s_waitcnt lgkmcnt(4)
    v_mfma_f32_16x16x32_bf16 v[164:167], v[108:111], v[40:43], v[164:167]
    v_mfma_f32_16x16x32_bf16 v[204:207], v[108:111], v[44:47], v[204:207]
    ds_read_b128 v[96:99], v2 offset:16384
    s_mov_b32 s54, 21504
    buffer_load_dwordx4 v[72:75], v5, s[4:7], s54 offen sc1
    buffer_load_dwordx4 v[76:79], v6, s[4:7], s54 offen sc1
    s_waitcnt vmcnt(17)
    s_waitcnt vmcnt(16)
    s_waitcnt lgkmcnt(4)
    v_mfma_f32_16x16x32_bf16 v[128:131], v[80:83], v[48:51], v[128:131]
    v_mfma_f32_16x16x32_bf16 v[168:171], v[80:83], v[52:55], v[168:171]
    ds_read_b128 v[100:103], v2 offset:20480
    s_waitcnt lgkmcnt(4)
    v_mfma_f32_16x16x32_bf16 v[132:135], v[84:87], v[48:51], v[132:135]
    v_mfma_f32_16x16x32_bf16 v[172:175], v[84:87], v[52:55], v[172:175]
    ds_read_b128 v[104:107], v2 offset:24576
    s_waitcnt lgkmcnt(4)
    v_mfma_f32_16x16x32_bf16 v[136:139], v[88:91], v[48:51], v[136:139]
    v_mfma_f32_16x16x32_bf16 v[176:179], v[88:91], v[52:55], v[176:179]
    ds_read_b128 v[108:111], v2 offset:28672
    s_waitcnt lgkmcnt(4)
    v_mfma_f32_16x16x32_bf16 v[140:143], v[92:95], v[48:51], v[140:143]
    v_mfma_f32_16x16x32_bf16 v[180:183], v[92:95], v[52:55], v[180:183]
    ds_read_b128 v[80:83], v2 offset:32768
    s_waitcnt lgkmcnt(4)
    v_mfma_f32_16x16x32_bf16 v[144:147], v[96:99], v[48:51], v[144:147]
    v_mfma_f32_16x16x32_bf16 v[184:187], v[96:99], v[52:55], v[184:187]
    ds_read_b128 v[84:87], v2 offset:36864
    s_waitcnt lgkmcnt(4)
    v_mfma_f32_16x16x32_bf16 v[148:151], v[100:103], v[48:51], v[148:151]
    v_mfma_f32_16x16x32_bf16 v[188:191], v[100:103], v[52:55], v[188:191]
    ds_read_b128 v[88:91], v2 offset:1024
    s_waitcnt lgkmcnt(4)
    v_mfma_f32_16x16x32_bf16 v[152:155], v[104:107], v[48:51], v[152:155]
    v_mfma_f32_16x16x32_bf16 v[192:195], v[104:107], v[52:55], v[192:195]
    ds_read_b128 v[92:95], v2 offset:5120
    s_waitcnt lgkmcnt(4)
    v_mfma_f32_16x16x32_bf16 v[156:159], v[108:111], v[48:51], v[156:159]
    v_mfma_f32_16x16x32_bf16 v[196:199], v[108:111], v[52:55], v[196:199]
    ds_read_b128 v[96:99], v2 offset:9216
    s_waitcnt lgkmcnt(4)
    v_mfma_f32_16x16x32_bf16 v[160:163], v[80:83], v[48:51], v[160:163]
    v_mfma_f32_16x16x32_bf16 v[200:203], v[80:83], v[52:55], v[200:203]
    ds_read_b128 v[100:103], v2 offset:13312
    s_waitcnt lgkmcnt(4)
    v_mfma_f32_16x16x32_bf16 v[164:167], v[84:87], v[48:51], v[164:167]
    v_mfma_f32_16x16x32_bf16 v[204:207], v[84:87], v[52:55], v[204:207]
    ds_read_b128 v[104:107], v2 offset:17408
    s_mov_b32 s54, 24576
    buffer_load_dwordx4 v[32:35], v5, s[4:7], s54 offen sc1
    buffer_load_dwordx4 v[36:39], v6, s[4:7], s54 offen sc1
    s_waitcnt vmcnt(12)
    s_waitcnt vmcnt(11)
    s_waitcnt lgkmcnt(4)
    v_mfma_f32_16x16x32_bf16 v[128:131], v[88:91], v[56:59], v[128:131]
    v_mfma_f32_16x16x32_bf16 v[168:171], v[88:91], v[60:63], v[168:171]
    ds_read_b128 v[108:111], v2 offset:21504
    s_waitcnt lgkmcnt(4)
    v_mfma_f32_16x16x32_bf16 v[132:135], v[92:95], v[56:59], v[132:135]
    v_mfma_f32_16x16x32_bf16 v[172:175], v[92:95], v[60:63], v[172:175]
    ds_read_b128 v[80:83], v2 offset:25600
    s_waitcnt lgkmcnt(4)
    v_mfma_f32_16x16x32_bf16 v[136:139], v[96:99], v[56:59], v[136:139]
    v_mfma_f32_16x16x32_bf16 v[176:179], v[96:99], v[60:63], v[176:179]
    ds_read_b128 v[84:87], v2 offset:29696
    s_waitcnt lgkmcnt(4)
    v_mfma_f32_16x16x32_bf16 v[140:143], v[100:103], v[56:59], v[140:143]
    v_mfma_f32_16x16x32_bf16 v[180:183], v[100:103], v[60:63], v[180:183]
    ds_read_b128 v[88:91], v2 offset:33792
    s_waitcnt lgkmcnt(4)
    v_mfma_f32_16x16x32_bf16 v[144:147], v[104:107], v[56:59], v[144:147]
    v_mfma_f32_16x16x32_bf16 v[184:187], v[104:107], v[60:63], v[184:187]
    ds_read_b128 v[92:95], v2 offset:37888
    s_waitcnt lgkmcnt(4)
    v_mfma_f32_16x16x32_bf16 v[148:151], v[108:111], v[56:59], v[148:151]
    v_mfma_f32_16x16x32_bf16 v[188:191], v[108:111], v[60:63], v[188:191]
    s_barrier
    s_add_u32 s50, s52, 28672
    s_add_u32 m0, s53, 122880
    s_nop 0
    buffer_load_dwordx4 v1, s[4:7], s50 offen sc1 lds
    buffer_load_dwordx4 v1, s[4:7], s50 offen offset:1024 sc1 lds
    buffer_load_dwordx4 v1, s[4:7], s50 offen offset:2048 sc1 lds
    buffer_load_dwordx4 v1, s[4:7], s50 offen offset:3072 sc1 lds
    s_add_u32 s50, s62, 28672
    s_add_u32 m0, s63, 122880
    s_nop 0
    buffer_load_dwordx4 v1, s[4:7], s50 offen sc1 lds
    ds_read_b128 v[96:99], v2 offset:40960
    s_waitcnt lgkmcnt(4)
    v_mfma_f32_16x16x32_bf16 v[152:155], v[80:83], v[56:59], v[152:155]
    v_mfma_f32_16x16x32_bf16 v[192:195], v[80:83], v[60:63], v[192:195]
    ds_read_b128 v[100:103], v2 offset:45056
    s_waitcnt lgkmcnt(4)
    v_mfma_f32_16x16x32_bf16 v[156:159], v[84:87], v[56:59], v[156:159]
    v_mfma_f32_16x16x32_bf16 v[196:199], v[84:87], v[60:63], v[196:199]
    ds_read_b128 v[104:107], v2 offset:49152
    s_waitcnt lgkmcnt(4)
    v_mfma_f32_16x16x32_bf16 v[160:163], v[88:91], v[56:59], v[160:163]
    v_mfma_f32_16x16x32_bf16 v[200:203], v[88:91], v[60:63], v[200:203]
    ds_read_b128 v[108:111], v2 offset:53248
    s_waitcnt lgkmcnt(4)
    v_mfma_f32_16x16x32_bf16 v[164:167], v[92:95], v[56:59], v[164:167]
    v_mfma_f32_16x16x32_bf16 v[204:207], v[92:95], v[60:63], v[204:207]
    ds_read_b128 v[80:83], v2 offset:57344
    s_mov_b32 s54, 25600
    buffer_load_dwordx4 v[40:43], v5, s[4:7], s54 offen sc1
    buffer_load_dwordx4 v[44:47], v6, s[4:7], s54 offen sc1
    s_waitcnt vmcnt(17)
    s_waitcnt vmcnt(16)
    s_waitcnt lgkmcnt(4)
    v_mfma_f32_16x16x32_bf16 v[128:131], v[96:99], v[64:67], v[128:131]
    v_mfma_f32_16x16x32_bf16 v[168:171], v[96:99], v[68:71], v[168:171]
    ds_read_b128 v[84:87], v2 offset:61440
    s_waitcnt lgkmcnt(4)
    v_mfma_f32_16x16x32_bf16 v[132:135], v[100:103], v[64:67], v[132:135]
    v_mfma_f32_16x16x32_bf16 v[172:175], v[100:103], v[68:71], v[172:175]
    ds_read_b128 v[88:91], v3 offset:0
    s_waitcnt lgkmcnt(4)
    v_mfma_f32_16x16x32_bf16 v[136:139], v[104:107], v[64:67], v[136:139]
    v_mfma_f32_16x16x32_bf16 v[176:179], v[104:107], v[68:71], v[176:179]
    ds_read_b128 v[92:95], v3 offset:4096
    s_waitcnt lgkmcnt(4)
    v_mfma_f32_16x16x32_bf16 v[140:143], v[108:111], v[64:67], v[140:143]
    v_mfma_f32_16x16x32_bf16 v[180:183], v[108:111], v[68:71], v[180:183]
    ds_read_b128 v[96:99], v3 offset:8192
    s_waitcnt lgkmcnt(4)
    v_mfma_f32_16x16x32_bf16 v[144:147], v[80:83], v[64:67], v[144:147]
    v_mfma_f32_16x16x32_bf16 v[184:187], v[80:83], v[68:71], v[184:187]
    ds_read_b128 v[100:103], v3 offset:12288
    s_waitcnt lgkmcnt(4)
    v_mfma_f32_16x16x32_bf16 v[148:151], v[84:87], v[64:67], v[148:151]
    v_mfma_f32_16x16x32_bf16 v[188:191], v[84:87], v[68:71], v[188:191]
    ds_read_b128 v[104:107], v2 offset:41984
    s_waitcnt lgkmcnt(4)
    v_mfma_f32_16x16x32_bf16 v[152:155], v[88:91], v[64:67], v[152:155]
    v_mfma_f32_16x16x32_bf16 v[192:195], v[88:91], v[68:71], v[192:195]
    ds_read_b128 v[108:111], v2 offset:46080
    s_waitcnt lgkmcnt(4)
    v_mfma_f32_16x16x32_bf16 v[156:159], v[92:95], v[64:67], v[156:159]
    v_mfma_f32_16x16x32_bf16 v[196:199], v[92:95], v[68:71], v[196:199]
    ds_read_b128 v[80:83], v2 offset:50176
    s_waitcnt lgkmcnt(4)
    v_mfma_f32_16x16x32_bf16 v[160:163], v[96:99], v[64:67], v[160:163]
    v_mfma_f32_16x16x32_bf16 v[200:203], v[96:99], v[68:71], v[200:203]
    ds_read_b128 v[84:87], v2 offset:54272
    s_waitcnt lgkmcnt(4)
    v_mfma_f32_16x16x32_bf16 v[164:167], v[100:103], v[64:67], v[164:167]
    v_mfma_f32_16x16x32_bf16 v[204:207], v[100:103], v[68:71], v[204:207]
    ds_read_b128 v[88:91], v2 offset:58368
    s_mov_b32 s54, 28672
    buffer_load_dwordx4 v[48:51], v5, s[4:7], s54 offen sc1
    buffer_load_dwordx4 v[52:55], v6, s[4:7], s54 offen sc1
    s_waitcnt vmcnt(12)
    s_waitcnt vmcnt(11)
    s_waitcnt lgkmcnt(4)
    v_mfma_f32_16x16x32_bf16 v[128:131], v[104:107], v[72:75], v[128:131]
    v_mfma_f32_16x16x32_bf16 v[168:171], v[104:107], v[76:79], v[168:171]
    ds_read_b128 v[92:95], v2 offset:62464
    s_waitcnt lgkmcnt(4)
    v_mfma_f32_16x16x32_bf16 v[132:135], v[108:111], v[72:75], v[132:135]
    v_mfma_f32_16x16x32_bf16 v[172:175], v[108:111], v[76:79], v[172:175]
    ds_read_b128 v[96:99], v3 offset:1024
    s_waitcnt lgkmcnt(4)
    v_mfma_f32_16x16x32_bf16 v[136:139], v[80:83], v[72:75], v[136:139]
    v_mfma_f32_16x16x32_bf16 v[176:179], v[80:83], v[76:79], v[176:179]
    ds_read_b128 v[100:103], v3 offset:5120
    s_waitcnt lgkmcnt(4)
    v_mfma_f32_16x16x32_bf16 v[140:143], v[84:87], v[72:75], v[140:143]
    v_mfma_f32_16x16x32_bf16 v[180:183], v[84:87], v[76:79], v[180:183]
    ds_read_b128 v[104:107], v3 offset:9216
    s_waitcnt lgkmcnt(4)
    v_mfma_f32_16x16x32_bf16 v[144:147], v[88:91], v[72:75], v[144:147]
    v_mfma_f32_16x16x32_bf16 v[184:187], v[88:91], v[76:79], v[184:187]
    ds_read_b128 v[108:111], v3 offset:13312
    s_waitcnt lgkmcnt(4)
    v_mfma_f32_16x16x32_bf16 v[148:151], v[92:95], v[72:75], v[148:151]
    v_mfma_f32_16x16x32_bf16 v[188:191], v[92:95], v[76:79], v[188:191]
    s_barrier
    ds_read_b128 v[80:83], v3 offset:16384
    s_waitcnt lgkmcnt(4)
    v_mfma_f32_16x16x32_bf16 v[152:155], v[96:99], v[72:75], v[152:155]
    v_mfma_f32_16x16x32_bf16 v[192:195], v[96:99], v[76:79], v[192:195]
    ds_read_b128 v[84:87], v3 offset:20480
    s_waitcnt lgkmcnt(4)
    v_mfma_f32_16x16x32_bf16 v[156:159], v[100:103], v[72:75], v[156:159]
    v_mfma_f32_16x16x32_bf16 v[196:199], v[100:103], v[76:79], v[196:199]
    ds_read_b128 v[88:91], v3 offset:24576
    s_waitcnt lgkmcnt(4)
    v_mfma_f32_16x16x32_bf16 v[160:163], v[104:107], v[72:75], v[160:163]
    v_mfma_f32_16x16x32_bf16 v[200:203], v[104:107], v[76:79], v[200:203]
    ds_read_b128 v[92:95], v3 offset:28672
    s_waitcnt lgkmcnt(4)
    v_mfma_f32_16x16x32_bf16 v[164:167], v[108:111], v[72:75], v[164:167]
    v_mfma_f32_16x16x32_bf16 v[204:207], v[108:111], v[76:79], v[204:207]
    ds_read_b128 v[96:99], v3 offset:32768
    s_mov_b32 s54, 29696
    buffer_load_dwordx4 v[56:59], v5, s[4:7], s54 offen sc1
    buffer_load_dwordx4 v[60:63], v6, s[4:7], s54 offen sc1
    s_waitcnt vmcnt(12)
    s_waitcnt vmcnt(11)
    s_waitcnt lgkmcnt(4)
    v_mfma_f32_16x16x32_bf16 v[128:131], v[80:83], v[32:35], v[128:131]
    v_mfma_f32_16x16x32_bf16 v[168:171], v[80:83], v[36:39], v[168:171]
    ds_read_b128 v[100:103], v3 offset:36864
    s_waitcnt lgkmcnt(4)
    v_mfma_f32_16x16x32_bf16 v[132:135], v[84:87], v[32:35], v[132:135]
    v_mfma_f32_16x16x32_bf16 v[172:175], v[84:87], v[36:39], v[172:175]
    ds_read_b128 v[104:107], v3 offset:40960
    s_waitcnt lgkmcnt(4)
    v_mfma_f32_16x16x32_bf16 v[136:139], v[88:91], v[32:35], v[136:139]
    v_mfma_f32_16x16x32_bf16 v[176:179], v[88:91], v[36:39], v[176:179]
    ds_read_b128 v[108:111], v3 offset:45056
    s_waitcnt lgkmcnt(4)
    v_mfma_f32_16x16x32_bf16 v[140:143], v[92:95], v[32:35], v[140:143]
    v_mfma_f32_16x16x32_bf16 v[180:183], v[92:95], v[36:39], v[180:183]
    ds_read_b128 v[80:83], v3 offset:49152
    s_waitcnt lgkmcnt(4)
    v_mfma_f32_16x16x32_bf16 v[144:147], v[96:99], v[32:35], v[144:147]
    v_mfma_f32_16x16x32_bf16 v[184:187], v[96:99], v[36:39], v[184:187]
    ds_read_b128 v[84:87], v3 offset:53248
    s_waitcnt lgkmcnt(4)
    v_mfma_f32_16x16x32_bf16 v[148:151], v[100:103], v[32:35], v[148:151]
    v_mfma_f32_16x16x32_bf16 v[188:191], v[100:103], v[36:39], v[188:191]
    ds_read_b128 v[88:91], v3 offset:17408
    s_waitcnt lgkmcnt(4)
    v_mfma_f32_16x16x32_bf16 v[152:155], v[104:107], v[32:35], v[152:155]
    v_mfma_f32_16x16x32_bf16 v[192:195], v[104:107], v[36:39], v[192:195]
    ds_read_b128 v[92:95], v3 offset:21504
    s_waitcnt lgkmcnt(4)
    v_mfma_f32_16x16x32_bf16 v[156:159], v[108:111], v[32:35], v[156:159]
    v_mfma_f32_16x16x32_bf16 v[196:199], v[108:111], v[36:39], v[196:199]
    ds_read_b128 v[96:99], v3 offset:25600
    s_waitcnt lgkmcnt(4)
    v_mfma_f32_16x16x32_bf16 v[160:163], v[80:83], v[32:35], v[160:163]
    v_mfma_f32_16x16x32_bf16 v[200:203], v[80:83], v[36:39], v[200:203]
    ds_read_b128 v[100:103], v3 offset:29696
    s_waitcnt lgkmcnt(4)
    v_mfma_f32_16x16x32_bf16 v[164:167], v[84:87], v[32:35], v[164:167]
    v_mfma_f32_16x16x32_bf16 v[204:207], v[84:87], v[36:39], v[204:207]
    ds_read_b128 v[104:107], v3 offset:33792
    s_waitcnt vmcnt(5)
    s_waitcnt vmcnt(4)
    s_waitcnt lgkmcnt(4)
    v_mfma_f32_16x16x32_bf16 v[128:131], v[88:91], v[40:43], v[128:131]
    v_mfma_f32_16x16x32_bf16 v[168:171], v[88:91], v[44:47], v[168:171]
    ds_read_b128 v[108:111], v3 offset:37888
    s_waitcnt lgkmcnt(4)
    v_mfma_f32_16x16x32_bf16 v[132:135], v[92:95], v[40:43], v[132:135]
    v_mfma_f32_16x16x32_bf16 v[172:175], v[92:95], v[44:47], v[172:175]
    ds_read_b128 v[80:83], v3 offset:41984
    s_waitcnt lgkmcnt(4)
    v_mfma_f32_16x16x32_bf16 v[136:139], v[96:99], v[40:43], v[136:139]
    v_mfma_f32_16x16x32_bf16 v[176:179], v[96:99], v[44:47], v[176:179]
    ds_read_b128 v[84:87], v3 offset:46080
    s_waitcnt lgkmcnt(4)
    v_mfma_f32_16x16x32_bf16 v[140:143], v[100:103], v[40:43], v[140:143]
    v_mfma_f32_16x16x32_bf16 v[180:183], v[100:103], v[44:47], v[180:183]
    ds_read_b128 v[88:91], v3 offset:50176
    s_waitcnt lgkmcnt(4)
    v_mfma_f32_16x16x32_bf16 v[144:147], v[104:107], v[40:43], v[144:147]
    v_mfma_f32_16x16x32_bf16 v[184:187], v[104:107], v[44:47], v[184:187]
    ds_read_b128 v[92:95], v3 offset:54272
    s_waitcnt lgkmcnt(4)
    v_mfma_f32_16x16x32_bf16 v[148:151], v[108:111], v[40:43], v[148:151]
    v_mfma_f32_16x16x32_bf16 v[188:191], v[108:111], v[44:47], v[188:191]
    s_barrier
    ds_read_b128 v[96:99], v3 offset:57344
    s_waitcnt lgkmcnt(4)
    v_mfma_f32_16x16x32_bf16 v[152:155], v[80:83], v[40:43], v[152:155]
    v_mfma_f32_16x16x32_bf16 v[192:195], v[80:83], v[44:47], v[192:195]
    ds_read_b128 v[100:103], v3 offset:61440
    s_waitcnt lgkmcnt(4)
    v_mfma_f32_16x16x32_bf16 v[156:159], v[84:87], v[40:43], v[156:159]
    v_mfma_f32_16x16x32_bf16 v[196:199], v[84:87], v[44:47], v[196:199]
    ds_read_b128 v[104:107], v4 offset:0
    s_waitcnt lgkmcnt(4)
    v_mfma_f32_16x16x32_bf16 v[160:163], v[88:91], v[40:43], v[160:163]
    v_mfma_f32_16x16x32_bf16 v[200:203], v[88:91], v[44:47], v[200:203]
    ds_read_b128 v[108:111], v4 offset:4096
    s_waitcnt lgkmcnt(4)
    v_mfma_f32_16x16x32_bf16 v[164:167], v[92:95], v[40:43], v[164:167]
    v_mfma_f32_16x16x32_bf16 v[204:207], v[92:95], v[44:47], v[204:207]
    ds_read_b128 v[80:83], v4 offset:8192
    s_waitcnt vmcnt(3)
    s_waitcnt vmcnt(2)
    s_waitcnt lgkmcnt(4)
    v_mfma_f32_16x16x32_bf16 v[128:131], v[96:99], v[48:51], v[128:131]
    v_mfma_f32_16x16x32_bf16 v[168:171], v[96:99], v[52:55], v[168:171]
    ds_read_b128 v[84:87], v4 offset:12288
    s_waitcnt lgkmcnt(4)
    v_mfma_f32_16x16x32_bf16 v[132:135], v[100:103], v[48:51], v[132:135]
    v_mfma_f32_16x16x32_bf16 v[172:175], v[100:103], v[52:55], v[172:175]
    ds_read_b128 v[88:91], v4 offset:16384
    s_waitcnt lgkmcnt(4)
    v_mfma_f32_16x16x32_bf16 v[136:139], v[104:107], v[48:51], v[136:139]
    v_mfma_f32_16x16x32_bf16 v[176:179], v[104:107], v[52:55], v[176:179]
    ds_read_b128 v[92:95], v4 offset:20480
    s_waitcnt lgkmcnt(4)
    v_mfma_f32_16x16x32_bf16 v[140:143], v[108:111], v[48:51], v[140:143]
    v_mfma_f32_16x16x32_bf16 v[180:183], v[108:111], v[52:55], v[180:183]
    ds_read_b128 v[96:99], v4 offset:24576
    s_waitcnt lgkmcnt(4)
    v_mfma_f32_16x16x32_bf16 v[144:147], v[80:83], v[48:51], v[144:147]
    v_mfma_f32_16x16x32_bf16 v[184:187], v[80:83], v[52:55], v[184:187]
    ds_read_b128 v[100:103], v4 offset:28672
    s_waitcnt lgkmcnt(4)
    v_mfma_f32_16x16x32_bf16 v[148:151], v[84:87], v[48:51], v[148:151]
    v_mfma_f32_16x16x32_bf16 v[188:191], v[84:87], v[52:55], v[188:191]
    ds_read_b128 v[104:107], v3 offset:58368
    s_waitcnt lgkmcnt(4)
    v_mfma_f32_16x16x32_bf16 v[152:155], v[88:91], v[48:51], v[152:155]
    v_mfma_f32_16x16x32_bf16 v[192:195], v[88:91], v[52:55], v[192:195]
    ds_read_b128 v[108:111], v3 offset:62464
    s_waitcnt lgkmcnt(4)
    v_mfma_f32_16x16x32_bf16 v[156:159], v[92:95], v[48:51], v[156:159]
    v_mfma_f32_16x16x32_bf16 v[196:199], v[92:95], v[52:55], v[196:199]
    ds_read_b128 v[80:83], v4 offset:1024
    s_waitcnt lgkmcnt(4)
    v_mfma_f32_16x16x32_bf16 v[160:163], v[96:99], v[48:51], v[160:163]
    v_mfma_f32_16x16x32_bf16 v[200:203], v[96:99], v[52:55], v[200:203]
    ds_read_b128 v[84:87], v4 offset:5120
    s_waitcnt lgkmcnt(4)
    v_mfma_f32_16x16x32_bf16 v[164:167], v[100:103], v[48:51], v[164:167]
    v_mfma_f32_16x16x32_bf16 v[204:207], v[100:103], v[52:55], v[204:207]
    ds_read_b128 v[88:91], v4 offset:9216
    s_waitcnt vmcnt(1)
    s_waitcnt vmcnt(0)
    s_waitcnt lgkmcnt(4)
    v_mfma_f32_16x16x32_bf16 v[128:131], v[104:107], v[56:59], v[128:131]
    v_mfma_f32_16x16x32_bf16 v[168:171], v[104:107], v[60:63], v[168:171]
    ds_read_b128 v[92:95], v4 offset:13312
    s_waitcnt lgkmcnt(4)
    v_mfma_f32_16x16x32_bf16 v[132:135], v[108:111], v[56:59], v[132:135]
    v_mfma_f32_16x16x32_bf16 v[172:175], v[108:111], v[60:63], v[172:175]
    ds_read_b128 v[96:99], v4 offset:17408
    s_waitcnt lgkmcnt(4)
    v_mfma_f32_16x16x32_bf16 v[136:139], v[80:83], v[56:59], v[136:139]
    v_mfma_f32_16x16x32_bf16 v[176:179], v[80:83], v[60:63], v[176:179]
    ds_read_b128 v[100:103], v4 offset:21504
    s_waitcnt lgkmcnt(4)
    v_mfma_f32_16x16x32_bf16 v[140:143], v[84:87], v[56:59], v[140:143]
    v_mfma_f32_16x16x32_bf16 v[180:183], v[84:87], v[60:63], v[180:183]
    ds_read_b128 v[104:107], v4 offset:25600
    s_waitcnt lgkmcnt(4)
    v_mfma_f32_16x16x32_bf16 v[144:147], v[88:91], v[56:59], v[144:147]
    v_mfma_f32_16x16x32_bf16 v[184:187], v[88:91], v[60:63], v[184:187]
    ds_read_b128 v[108:111], v4 offset:29696
    s_waitcnt lgkmcnt(4)
    v_mfma_f32_16x16x32_bf16 v[148:151], v[92:95], v[56:59], v[148:151]
    v_mfma_f32_16x16x32_bf16 v[188:191], v[92:95], v[60:63], v[188:191]
    s_waitcnt lgkmcnt(3)
    v_mfma_f32_16x16x32_bf16 v[152:155], v[96:99], v[56:59], v[152:155]
    v_mfma_f32_16x16x32_bf16 v[192:195], v[96:99], v[60:63], v[192:195]
    s_waitcnt lgkmcnt(2)
    v_mfma_f32_16x16x32_bf16 v[156:159], v[100:103], v[56:59], v[156:159]
    v_mfma_f32_16x16x32_bf16 v[196:199], v[100:103], v[60:63], v[196:199]
    s_waitcnt lgkmcnt(1)
    v_mfma_f32_16x16x32_bf16 v[160:163], v[104:107], v[56:59], v[160:163]
    v_mfma_f32_16x16x32_bf16 v[200:203], v[104:107], v[60:63], v[200:203]
    s_waitcnt lgkmcnt(0)
    v_mfma_f32_16x16x32_bf16 v[164:167], v[108:111], v[56:59], v[164:167]
    v_mfma_f32_16x16x32_bf16 v[204:207], v[108:111], v[60:63], v[204:207]
    s_barrier
    ds_write_b128 v8, v[168:171] offset:0
    ds_write_b128 v8, v[172:175] offset:1024
    ds_write_b128 v8, v[176:179] offset:2048
    ds_write_b128 v8, v[180:183] offset:3072
    ds_write_b128 v8, v[184:187] offset:4096
    ds_write_b128 v8, v[188:191] offset:5120
    ds_write_b128 v8, v[192:195] offset:6144
    ds_write_b128 v8, v[196:199] offset:7168
    ds_write_b128 v8, v[200:203] offset:8192
    ds_write_b128 v8, v[204:207] offset:9216
    s_waitcnt lgkmcnt(0)
    s_barrier
    ds_read_b128 v[32:35], v9 offset:0
    ds_read_b128 v[36:39], v9 offset:1024
    ds_read_b128 v[40:43], v9 offset:2048
    ds_read_b128 v[44:47], v9 offset:3072
    ds_read_b128 v[48:51], v9 offset:4096
    ds_read_b128 v[52:55], v9 offset:5120
    ds_read_b128 v[56:59], v9 offset:6144
    ds_read_b128 v[60:63], v9 offset:7168
    ds_read_b128 v[64:67], v9 offset:8192
    ds_read_b128 v[68:71], v9 offset:9216
    s_waitcnt lgkmcnt(0)
    v_pk_add_f32 v[128:129], v[128:129], v[32:33]
    v_pk_add_f32 v[130:131], v[130:131], v[34:35]
    v_cvt_pk_bf16_f32 v16, v128, v129
    v_cvt_pk_bf16_f32 v17, v130, v131
    buffer_store_dwordx2 v[16:17], v10, s[4:7], s55 offen offset:0 sc1
    v_pk_add_f32 v[132:133], v[132:133], v[36:37]
    v_pk_add_f32 v[134:135], v[134:135], v[38:39]
    v_cvt_pk_bf16_f32 v18, v132, v133
    v_cvt_pk_bf16_f32 v19, v134, v135
    buffer_store_dwordx2 v[18:19], v10, s[4:7], s55 offen offset:512 sc1
    v_pk_add_f32 v[136:137], v[136:137], v[40:41]
    v_pk_add_f32 v[138:139], v[138:139], v[42:43]
    v_cvt_pk_bf16_f32 v20, v136, v137
    v_cvt_pk_bf16_f32 v21, v138, v139
    buffer_store_dwordx2 v[20:21], v10, s[4:7], s55 offen offset:1024 sc1
    v_pk_add_f32 v[140:141], v[140:141], v[44:45]
    v_pk_add_f32 v[142:143], v[142:143], v[46:47]
    v_cvt_pk_bf16_f32 v22, v140, v141
    v_cvt_pk_bf16_f32 v23, v142, v143
    buffer_store_dwordx2 v[22:23], v10, s[4:7], s55 offen offset:1536 sc1
    v_pk_add_f32 v[144:145], v[144:145], v[48:49]
    v_pk_add_f32 v[146:147], v[146:147], v[50:51]
    v_cvt_pk_bf16_f32 v16, v144, v145
    v_cvt_pk_bf16_f32 v17, v146, v147
    buffer_store_dwordx2 v[16:17], v10, s[4:7], s55 offen offset:2048 sc1
    v_pk_add_f32 v[148:149], v[148:149], v[52:53]
    v_pk_add_f32 v[150:151], v[150:151], v[54:55]
    v_cvt_pk_bf16_f32 v18, v148, v149
    v_cvt_pk_bf16_f32 v19, v150, v151
    buffer_store_dwordx2 v[18:19], v10, s[4:7], s55 offen offset:2560 sc1
    v_pk_add_f32 v[152:153], v[152:153], v[56:57]
    v_pk_add_f32 v[154:155], v[154:155], v[58:59]
    v_cvt_pk_bf16_f32 v20, v152, v153
    v_cvt_pk_bf16_f32 v21, v154, v155
    buffer_store_dwordx2 v[20:21], v10, s[4:7], s55 offen offset:3072 sc1
    v_pk_add_f32 v[156:157], v[156:157], v[60:61]
    v_pk_add_f32 v[158:159], v[158:159], v[62:63]
    v_cvt_pk_bf16_f32 v22, v156, v157
    v_cvt_pk_bf16_f32 v23, v158, v159
    buffer_store_dwordx2 v[22:23], v10, s[4:7], s55 offen offset:3584 sc1
    v_pk_add_f32 v[160:161], v[160:161], v[64:65]
    v_pk_add_f32 v[162:163], v[162:163], v[66:67]
    s_add_u32 s55, s55, 4096
    v_cvt_pk_bf16_f32 v16, v160, v161
    v_cvt_pk_bf16_f32 v17, v162, v163
    buffer_store_dwordx2 v[16:17], v10, s[4:7], s55 offen offset:0 sc1
    v_pk_add_f32 v[164:165], v[164:165], v[68:69]
    v_pk_add_f32 v[166:167], v[166:167], v[70:71]
    v_cvt_pk_bf16_f32 v18, v164, v165
    v_cvt_pk_bf16_f32 v19, v166, v167
    buffer_store_dwordx2 v[18:19], v10, s[4:7], s55 offen offset:512 sc1
    s_lshl_b32 s89, s41, 4
    s_lshl_b32 s58, s42, 2
    s_add_u32 s89, s89, s58
    s_add_u32 s89, s89, s40
    s_lshl_b32 s89, s89, 2
    s_add_u32 s89, s89, 46080
    s_and_b32 s30, s2, 7
    s_lshl_b32 s30, s30, 5
    s_lshr_b32 s31, s2, 3
    s_add_u32 s34, s30, s31
    s_load_dwordx2 s[16:17], s[0:1], 0
    s_waitcnt lgkmcnt(0)
    s_and_b32 s17, s17, 0xffff
    s_mov_b32 s18, 2621440
    s_mov_b32 s19, 0x20000
    s_lshl_b32 s30, s3, 6
    v_add_u32 v88, s30, v0
    v_lshrrev_b32 v89, 3, v88
    v_and_b32 v90, 7, v0
    s_lshl_b32 s30, s34, 3
    v_add_u32 v91, s30, v90
    s_movk_i32 s31, 1280
    v_mul_lo_u32 v91, v91, s31
    v_lshl_add_u32 v91, v89, 4, v91
    v_lshlrev_b32 v87, 5, v89
    v_lshlrev_b32 v119, 8, v89
    v_lshl_add_u32 v119, v90, 4, v119
    s_lshr_b32 s30, s34, 1
    s_mul_i32 s30, s30, 20480
    s_and_b32 s31, s34, 1
    s_lshl_b32 s31, s31, 7
    s_add_u32 s30, s30, s31
    v_add_u32 v119, s30, v119
    v_lshlrev_b32 v86, 8, v89
    v_lshl_add_u32 v86, v90, 4, v86
    s_lshr_b32 s30, s34, 1
    s_mul_i32 s30, s30, 20480
    s_and_b32 s31, s34, 1
    s_lshl_b32 s31, s31, 7
    s_add_u32 s30, s30, s31
    v_add_u32 v86, s30, v86
    s_waitcnt vmcnt(0)
    s_barrier
    s_cmp_eq_u32 s3, 0
    s_cbranch_scc1 L_b0_76
    buffer_load_dwordx4 v[92:95], v91, s[16:19], 0 offen
    s_cmp_ge_u32 s3, 2
    s_cbranch_scc1 L_two_78
    buffer_load_dwordx4 v[96:99], v91, s[16:19], 0 offen offset:1024
    s_nop 1
L_two_78:
    s_sub_u32 s30, s3, 1
    s_lshl_b32 s30, s30, 6
    v_add_u32 v80, s30, v0
    v_lshlrev_b32 v80, 4, v80
    v_add_u32 v81, 7168, v80
    v_mov_b32 v82, 0x7fff0000
    v_cmp_gt_u32 vcc, 7680, v81
    s_nop 0
    s_nop 0
    v_cndmask_b32 v82, v82, v81, vcc
    s_movk_i32 s30, 5120
    buffer_load_dwordx4 v[128:131], v80, s[4:7], s30 offen sc1
    buffer_load_dwordx4 v[132:135], v82, s[4:7], s30 offen sc1
    s_waitcnt vmcnt(0)
    v_add_f32 v136, 1.0, v128
    v_add_f32 v137, 1.0, v129
    v_add_f32 v138, 1.0, v130
    v_add_f32 v139, 1.0, v131
    v_cvt_pk_bf16_f32 v140, v136, v137
    v_lshlrev_b32 v136, 16, v140
    v_and_b32 v137, 0xffff0000, v140
    v_cvt_pk_bf16_f32 v140, v138, v139
    v_lshlrev_b32 v138, 16, v140
    v_and_b32 v139, 0xffff0000, v140
    v_cmp_le_u32 vcc, 5120, v80
    s_nop 1
    v_cndmask_b32 v128, v128, v136, vcc
    v_cndmask_b32 v129, v129, v137, vcc
    v_cndmask_b32 v130, v130, v138, vcc
    v_cndmask_b32 v131, v131, v139, vcc
    v_add_f32 v136, 1.0, v132
    v_add_f32 v137, 1.0, v133
    v_add_f32 v138, 1.0, v134
    v_add_f32 v139, 1.0, v135
    v_cvt_pk_bf16_f32 v140, v136, v137
    v_lshlrev_b32 v136, 16, v140
    v_and_b32 v137, 0xffff0000, v140
    v_cvt_pk_bf16_f32 v140, v138, v139
    v_lshlrev_b32 v138, 16, v140
    v_and_b32 v139, 0xffff0000, v140
    v_cmp_le_u32 vcc, 5120, v81
    s_nop 1
    v_cndmask_b32 v132, v132, v136, vcc
    v_cndmask_b32 v133, v133, v137, vcc
    v_cndmask_b32 v134, v134, v138, vcc
    v_cndmask_b32 v135, v135, v139, vcc
    v_add_u32 v80, 147456, v80
    ds_write_b128 v80, v[128:131]
    v_cmp_gt_u32 vcc, 7680, v81
    s_nop 0
    s_and_saveexec_b64 s[30:31], vcc
    v_add_u32 v81, 147456, v81
    ds_write_b128 v81, v[132:135]
    s_mov_b64 exec, -1
    s_waitcnt lgkmcnt(0)
    s_branch L_b1_77
L_b0_76:
    v_mov_b32 v250, s24
    v_mov_b32 v251, 0
    s_mov_b64 exec, 1
    buffer_atomic_swap v250, v251, s[4:7], s89 offen
    s_mov_b64 exec, -1
    s_lshr_b32 s59, s34, 4
    s_lshl_b32 s59, s59, 6
    s_add_u32 s59, s59, 46080
    v_lshlrev_b32 v251, 2, v0
    s_mov_b32 s58, 0
    s_mov_b32 s60, 0xffff
    s_mov_b32 s61, 0x0
    s_mov_b64 exec, s[60:61]
L_poll_79:
    buffer_load_dword v252, v251, s[4:7], s59 offen sc1
    s_waitcnt vmcnt(0)
    v_cmp_ne_u32 vcc, s24, v252
    s_nop 1
    s_and_b64 vcc, vcc, s[60:61]
    s_cbranch_scc0 L_polld_80
    s_sleep 1
    s_add_u32 s58, s58, 1
    s_cmp_lt_u32 s58, 32768
    s_cbranch_scc1 L_poll_79
    s_load_dwordx2 s[20:21], s[0:1], 104
    s_waitcnt lgkmcnt(0)
    s_and_b32 s21, s21, 0xffff
    s_mov_b32 s22, 256
    s_mov_b32 s23, 0x20000
    v_mov_b32 v253, 0xdead0007
    v_mov_b32 v251, 32
    s_mov_b64 exec, 1
    buffer_store_dword v253, v251, s[20:23], 0 offen
L_polld_80:
    s_mov_b64 exec, -1
    buffer_load_dwordx4 v[92:95], v91, s[16:19], 0 offen
    s_cmp_ge_u32 s3, 2
    s_cbranch_scc1 L_two_81
    buffer_load_dwordx4 v[96:99], v91, s[16:19], 0 offen offset:1024
    s_nop 1
L_two_81:
L_b1_77:
    s_barrier
    s_mov_b32 s36, 17825792
    buffer_load_dwordx4 v[176:179], v119, s[4:7], s36 offen sc1
    s_mov_b32 s36, 20447232
    buffer_load_dwordx4 v[180:183], v119, s[4:7], s36 offen sc1
    s_mov_b32 s36, 23068672
    buffer_load_dwordx4 v[184:187], v119, s[4:7], s36 offen sc1
    s_mov_b32 s36, 25690112
    buffer_load_dwordx4 v[188:191], v119, s[4:7], s36 offen sc1
    s_cmp_ge_u32 s3, 2
    s_cbranch_scc1 L_two_82
    s_mov_b32 s36, 17842176
    buffer_load_dwordx4 v[192:195], v119, s[4:7], s36 offen sc1
    s_mov_b32 s36, 20463616
    buffer_load_dwordx4 v[196:199], v119, s[4:7], s36 offen sc1
    s_mov_b32 s36, 23085056
    buffer_load_dwordx4 v[200:203], v119, s[4:7], s36 offen sc1
    s_mov_b32 s36, 25706496
    buffer_load_dwordx4 v[204:207], v119, s[4:7], s36 offen sc1
    s_nop 1
L_two_82:
    v_add_u32 v87, 147456, v87
    ds_read_b128 v[128:131], v87 offset:0
    ds_read_b128 v[132:135], v87 offset:16
    ds_read_b128 v[144:147], v87 offset:2560
    ds_read_b128 v[148:151], v87 offset:2576
    ds_read_b128 v[160:163], v87 offset:5120
    ds_read_b128 v[164:167], v87 offset:5136
    s_cmp_ge_u32 s3, 2
    s_cbranch_scc1 L_two_83
    ds_read_b128 v[136:139], v87 offset:2048
    ds_read_b128 v[140:143], v87 offset:2064
    ds_read_b128 v[152:155], v87 offset:4608
    ds_read_b128 v[156:159], v87 offset:4624
    ds_read_b128 v[168:171], v87 offset:7168
    ds_read_b128 v[172:175], v87 offset:7184
    s_nop 1
L_two_83:
    s_waitcnt vmcnt(0)
    s_waitcnt lgkmcnt(0)
    v_lshlrev_b32 v1, 4, v0
    s_bfe_u32 s25, s2, 0x30003
    s_mul_i32 s25, s25, 102400
    s_add_u32 s25, s25, 9437184
    s_mul_i32 s50, s3, 13312
    s_add_u32 s51, s25, s50
    s_mov_b32 m0, s50
    s_nop 0
    buffer_load_dwordx4 v1, s[4:7], s51 offen offset:0 sc1 lds
    v_lshlrev_b32 v100, 16, v92
    v_and_b32 v101, 0xffff0000, v92
    v_lshlrev_b32 v102, 16, v93
    v_and_b32 v103, 0xffff0000, v93
    v_lshlrev_b32 v104, 16, v94
    v_and_b32 v105, 0xffff0000, v94
    buffer_load_dwordx4 v1, s[4:7], s51 offen offset:1024 sc1 lds
    v_lshlrev_b32 v106, 16, v95
    v_and_b32 v107, 0xffff0000, v95
    v_lshlrev_b32 v208, 16, v176
    v_and_b32 v209, 0xffff0000, v176
    v_lshlrev_b32 v210, 16, v177
    v_and_b32 v211, 0xffff0000, v177
    buffer_load_dwordx4 v1, s[4:7], s51 offen offset:2048 sc1 lds
    v_lshlrev_b32 v212, 16, v178
    v_and_b32 v213, 0xffff0000, v178
    v_lshlrev_b32 v214, 16, v179
    v_and_b32 v215, 0xffff0000, v179
    v_lshlrev_b32 v216, 16, v180
    v_and_b32 v217, 0xffff0000, v180
    buffer_load_dwordx4 v1, s[4:7], s51 offen offset:3072 sc1 lds
    s_add_u32 s50, s50, 4096
    s_add_u32 s51, s51, 4096
    v_lshlrev_b32 v218, 16, v181
    v_and_b32 v219, 0xffff0000, v181
    v_lshlrev_b32 v220, 16, v182
    v_and_b32 v221, 0xffff0000, v182
    v_lshlrev_b32 v222, 16, v183
    s_mov_b32 m0, s50
    s_nop 0
    buffer_load_dwordx4 v1, s[4:7], s51 offen offset:0 sc1 lds
    v_and_b32 v223, 0xffff0000, v183
    v_pk_add_f32 v[208:209], v[208:209], v[216:217]
    v_pk_add_f32 v[210:211], v[210:211], v[218:219]
    v_pk_add_f32 v[212:213], v[212:213], v[220:221]
    v_pk_add_f32 v[214:215], v[214:215], v[222:223]
    v_lshlrev_b32 v216, 16, v184
    buffer_load_dwordx4 v1, s[4:7], s51 offen offset:1024 sc1 lds
    v_and_b32 v217, 0xffff0000, v184
    v_lshlrev_b32 v218, 16, v185
    v_and_b32 v219, 0xffff0000, v185
    v_lshlrev_b32 v220, 16, v186
    v_and_b32 v221, 0xffff0000, v186
    v_lshlrev_b32 v222, 16, v187
    buffer_load_dwordx4 v1, s[4:7], s51 offen offset:2048 sc1 lds
    v_and_b32 v223, 0xffff0000, v187
    v_lshlrev_b32 v224, 16, v188
    v_and_b32 v225, 0xffff0000, v188
    v_lshlrev_b32 v226, 16, v189
    v_and_b32 v227, 0xffff0000, v189
    buffer_load_dwordx4 v1, s[4:7], s51 offen offset:3072 sc1 lds
    s_add_u32 s50, s50, 4096
    s_add_u32 s51, s51, 4096
    v_lshlrev_b32 v228, 16, v190
    v_and_b32 v229, 0xffff0000, v190
    v_lshlrev_b32 v230, 16, v191
    v_and_b32 v231, 0xffff0000, v191
    v_pk_add_f32 v[216:217], v[216:217], v[224:225]
    v_pk_add_f32 v[218:219], v[218:219], v[226:227]
    s_mov_b32 m0, s50
    s_nop 0
    buffer_load_dwordx4 v1, s[4:7], s51 offen offset:0 sc1 lds
    v_pk_add_f32 v[220:221], v[220:221], v[228:229]
    v_pk_add_f32 v[222:223], v[222:223], v[230:231]
    v_pk_add_f32 v[208:209], v[208:209], v[216:217]
    v_pk_add_f32 v[210:211], v[210:211], v[218:219]
    v_pk_add_f32 v[212:213], v[212:213], v[220:221]
    v_pk_add_f32 v[214:215], v[214:215], v[222:223]
    buffer_load_dwordx4 v1, s[4:7], s51 offen offset:1024 sc1 lds
    v_fmac_f32 v100, v128, v208
    v_fmac_f32 v101, v129, v209
    v_fmac_f32 v102, v130, v210
    v_fmac_f32 v103, v131, v211
    v_fmac_f32 v104, v132, v212
    buffer_load_dwordx4 v1, s[4:7], s51 offen offset:2048 sc1 lds
    v_fmac_f32 v105, v133, v213
    v_fmac_f32 v106, v134, v214
    v_fmac_f32 v107, v135, v215
    v_cvt_pk_bf16_f32 v92, v100, v101
    v_cvt_pk_bf16_f32 v93, v102, v103
    v_cvt_pk_bf16_f32 v94, v104, v105
    buffer_load_dwordx4 v1, s[4:7], s51 offen offset:3072 sc1 lds
    s_add_u32 s50, s50, 4096
    s_add_u32 s51, s51, 4096
    v_cvt_pk_bf16_f32 v95, v106, v107
    s_mov_b32 s36, 50331648
    buffer_store_dwordx4 v[92:95], v86, s[4:7], s36 offen sc1
    v_lshlrev_b32 v100, 16, v92
    v_and_b32 v101, 0xffff0000, v92
    v_lshlrev_b32 v102, 16, v93
    s_mov_b32 m0, s50
    s_nop 0
    buffer_load_dwordx4 v1, s[4:7], s51 offen offset:0 sc1 lds
    s_add_u32 s50, s50, 1024
    s_add_u32 s51, s51, 1024
    v_and_b32 v103, 0xffff0000, v93
    v_lshlrev_b32 v104, 16, v94
    v_and_b32 v105, 0xffff0000, v94
    v_lshlrev_b32 v106, 16, v95
    v_and_b32 v107, 0xffff0000, v95
    s_cmp_ge_u32 s3, 2
    s_cbranch_scc1 L_two_84
    v_lshlrev_b32 v108, 16, v96
    v_and_b32 v109, 0xffff0000, v96
    v_lshlrev_b32 v110, 16, v97
    v_and_b32 v111, 0xffff0000, v97
    v_lshlrev_b32 v112, 16, v98
    v_and_b32 v113, 0xffff0000, v98
    v_lshlrev_b32 v114, 16, v99
    v_and_b32 v115, 0xffff0000, v99
    v_lshlrev_b32 v208, 16, v192
    v_and_b32 v209, 0xffff0000, v192
    v_lshlrev_b32 v210, 16, v193
    v_and_b32 v211, 0xffff0000, v193
    v_lshlrev_b32 v212, 16, v194
    v_and_b32 v213, 0xffff0000, v194
    v_lshlrev_b32 v214, 16, v195
    v_and_b32 v215, 0xffff0000, v195
    v_lshlrev_b32 v216, 16, v196
    v_and_b32 v217, 0xffff0000, v196
    v_lshlrev_b32 v218, 16, v197
    v_and_b32 v219, 0xffff0000, v197
    v_lshlrev_b32 v220, 16, v198
    v_and_b32 v221, 0xffff0000, v198
    v_lshlrev_b32 v222, 16, v199
    v_and_b32 v223, 0xffff0000, v199
    v_pk_add_f32 v[208:209], v[208:209], v[216:217]
    v_pk_add_f32 v[210:211], v[210:211], v[218:219]
    v_pk_add_f32 v[212:213], v[212:213], v[220:221]
    v_pk_add_f32 v[214:215], v[214:215], v[222:223]
    v_lshlrev_b32 v216, 16, v200
    v_and_b32 v217, 0xffff0000, v200
    v_lshlrev_b32 v218, 16, v201
    v_and_b32 v219, 0xffff0000, v201
    v_lshlrev_b32 v220, 16, v202
    v_and_b32 v221, 0xffff0000, v202
    v_lshlrev_b32 v222, 16, v203
    v_and_b32 v223, 0xffff0000, v203
    v_lshlrev_b32 v224, 16, v204
    v_and_b32 v225, 0xffff0000, v204
    v_lshlrev_b32 v226, 16, v205
    v_and_b32 v227, 0xffff0000, v205
    v_lshlrev_b32 v228, 16, v206
    v_and_b32 v229, 0xffff0000, v206
    v_lshlrev_b32 v230, 16, v207
    v_and_b32 v231, 0xffff0000, v207
    v_pk_add_f32 v[216:217], v[216:217], v[224:225]
    v_pk_add_f32 v[218:219], v[218:219], v[226:227]
    v_pk_add_f32 v[220:221], v[220:221], v[228:229]
    v_pk_add_f32 v[222:223], v[222:223], v[230:231]
    v_pk_add_f32 v[208:209], v[208:209], v[216:217]
    v_pk_add_f32 v[210:211], v[210:211], v[218:219]
    v_pk_add_f32 v[212:213], v[212:213], v[220:221]
    v_pk_add_f32 v[214:215], v[214:215], v[222:223]
    v_fmac_f32 v108, v136, v208
    v_fmac_f32 v109, v137, v209
    v_fmac_f32 v110, v138, v210
    v_fmac_f32 v111, v139, v211
    v_fmac_f32 v112, v140, v212
    v_fmac_f32 v113, v141, v213
    v_fmac_f32 v114, v142, v214
    v_fmac_f32 v115, v143, v215
    v_cvt_pk_bf16_f32 v96, v108, v109
    v_cvt_pk_bf16_f32 v97, v110, v111
    v_cvt_pk_bf16_f32 v98, v112, v113
    v_cvt_pk_bf16_f32 v99, v114, v115
    s_mov_b32 s36, 50348032
    buffer_store_dwordx4 v[96:99], v86, s[4:7], s36 offen sc1
    v_lshlrev_b32 v108, 16, v96
    v_and_b32 v109, 0xffff0000, v96
    v_lshlrev_b32 v110, 16, v97
    v_and_b32 v111, 0xffff0000, v97
    v_lshlrev_b32 v112, 16, v98
    v_and_b32 v113, 0xffff0000, v98
    v_lshlrev_b32 v114, 16, v99
    v_and_b32 v115, 0xffff0000, v99
    s_nop 1
L_two_84:
    v_add_f32 v232, v100, v101
    v_mul_f32 v233, v100, v100
    v_fmac_f32 v233, v101, v101
    v_add_f32 v232, v232, v102
    v_fmac_f32 v233, v102, v102
    v_add_f32 v232, v232, v103
    v_fmac_f32 v233, v103, v103
    v_add_f32 v232, v232, v104
    v_fmac_f32 v233, v104, v104
    v_add_f32 v232, v232, v105
    v_fmac_f32 v233, v105, v105
    v_add_f32 v232, v232, v106
    v_fmac_f32 v233, v106, v106
    v_add_f32 v232, v232, v107
    v_fmac_f32 v233, v107, v107
    s_cmp_ge_u32 s3, 2
    s_cbranch_scc1 L_two_85
    v_add_f32 v232, v232, v108
    v_fmac_f32 v233, v108, v108
    v_add_f32 v232, v232, v109
    v_fmac_f32 v233, v109, v109
    v_add_f32 v232, v232, v110
    v_fmac_f32 v233, v110, v110
    v_add_f32 v232, v232, v111
    v_fmac_f32 v233, v111, v111
    v_add_f32 v232, v232, v112
    v_fmac_f32 v233, v112, v112
    v_add_f32 v232, v232, v113
    v_fmac_f32 v233, v113, v113
    v_add_f32 v232, v232, v114
    v_fmac_f32 v233, v114, v114
    v_add_f32 v232, v232, v115
    v_fmac_f32 v233, v115, v115
    s_nop 1
L_two_85:
    v_add_f32_dpp v232, v232, v232 row_ror:8 row_mask:0xf bank_mask:0xf
    v_add_f32_dpp v233, v233, v233 row_ror:8 row_mask:0xf bank_mask:0xf
    v_mov_b32 v234, v232
    s_nop 1
    v_permlane16_swap_b32 v232, v234
    v_add_f32 v232, v232, v234
    v_mov_b32 v234, v232
    s_nop 1
    v_permlane32_swap_b32 v232, v234
    v_add_f32 v232, v232, v234
    v_mov_b32 v235, v233
    s_nop 1
    v_permlane16_swap_b32 v233, v235
    v_add_f32 v233, v233, v235
    v_mov_b32 v235, v233
    s_nop 1
    v_permlane32_swap_b32 v233, v235
    v_add_f32 v233, v233, v235
    v_lshlrev_b32 v234, 6, v0
    s_lshl_b32 s30, s3, 3
    s_add_u32 s30, s30, 161792
    v_add_u32 v234, s30, v234
    s_mov_b64 exec, 0xff
    ds_write_b64 v234, v[232:233]
    s_mov_b64 exec, -1
    s_waitcnt lgkmcnt(0)
    s_barrier
    v_and_b32 v234, 7, v0
    v_lshlrev_b32 v234, 6, v234
    v_add_u32 v234, 161792, v234
    ds_read_b128 v[236:239], v234 offset:0
    ds_read_b128 v[240:243], v234 offset:16
    s_waitcnt lgkmcnt(0)
    v_add_f32 v232, v236, v238
    v_add_f32 v233, v237, v239
    v_add_f32 v232, v232, v240
    v_add_f32 v233, v233, v241
    v_add_f32 v232, v232, v242
    v_add_f32 v233, v233, v243
    ds_read_b128 v[236:239], v234 offset:32
    ds_read_b128 v[240:243], v234 offset:48
    s_waitcnt lgkmcnt(0)
    v_add_f32 v232, v232, v236
    v_add_f32 v233, v233, v237
    v_add_f32 v232, v232, v238
    v_add_f32 v233, v233, v239
    v_add_f32 v232, v232, v240
    v_add_f32 v233, v233, v241
    v_add_f32 v232, v232, v242
    v_add_f32 v233, v233, v243
    v_mul_f32 v232, 0x3acccccd, v232
    v_mul_f32 v233, 0x3acccccd, v233
    v_fma_f32 v233, -v232, v232, v233
    v_max_f32 v233, 0, v233
    v_add_f32 v233, 0x3727c5ac, v233
    v_rsq_f32 v233, v233
    v_sub_f32 v100, v100, v232
    v_mul_f32 v100, v100, v233
    v_sub_f32 v101, v101, v232
    v_mul_f32 v101, v101, v233
    v_sub_f32 v102, v102, v232
    v_mul_f32 v102, v102, v233
    v_sub_f32 v103, v103, v232
    v_mul_f32 v103, v103, v233
    v_sub_f32 v104, v104, v232
    v_mul_f32 v104, v104, v233
    v_sub_f32 v105, v105, v232
    v_mul_f32 v105, v105, v233
    v_sub_f32 v106, v106, v232
    v_mul_f32 v106, v106, v233
    v_sub_f32 v107, v107, v232
    v_mul_f32 v107, v107, v233
    v_cvt_pk_bf16_f32 v118, v100, v101
    v_lshlrev_b32 v100, 16, v118
    v_and_b32 v101, 0xffff0000, v118
    v_cvt_pk_bf16_f32 v118, v102, v103
    v_lshlrev_b32 v102, 16, v118
    v_and_b32 v103, 0xffff0000, v118
    v_cvt_pk_bf16_f32 v118, v104, v105
    v_lshlrev_b32 v104, 16, v118
    v_and_b32 v105, 0xffff0000, v118
    v_cvt_pk_bf16_f32 v118, v106, v107
    v_lshlrev_b32 v106, 16, v118
    v_and_b32 v107, 0xffff0000, v118
    v_fma_f32 v100, v100, v160, v144
    v_fma_f32 v101, v101, v161, v145
    v_fma_f32 v102, v102, v162, v146
    v_fma_f32 v103, v103, v163, v147
    v_fma_f32 v104, v104, v164, v148
    v_fma_f32 v105, v105, v165, v149
    v_fma_f32 v106, v106, v166, v150
    v_fma_f32 v107, v107, v167, v151
    v_cvt_pk_bf16_f32 v176, v100, v101
    v_cvt_pk_bf16_f32 v177, v102, v103
    v_cvt_pk_bf16_f32 v178, v104, v105
    v_cvt_pk_bf16_f32 v179, v106, v107
    s_mov_b32 s36, 52953088
    buffer_store_dwordx4 v[176:179], v86, s[4:7], s36 offen sc1
    v_lshlrev_b32 v100, 16, v176
    v_and_b32 v101, 0xffff0000, v176
    v_lshlrev_b32 v102, 16, v177
    v_and_b32 v103, 0xffff0000, v177
    v_lshlrev_b32 v104, 16, v178
    v_and_b32 v105, 0xffff0000, v178
    v_lshlrev_b32 v106, 16, v179
    v_and_b32 v107, 0xffff0000, v179
    s_cmp_ge_u32 s3, 2
    s_cbranch_scc1 L_two_86
    v_sub_f32 v108, v108, v232
    v_mul_f32 v108, v108, v233
    v_sub_f32 v109, v109, v232
    v_mul_f32 v109, v109, v233
    v_sub_f32 v110, v110, v232
    v_mul_f32 v110, v110, v233
    v_sub_f32 v111, v111, v232
    v_mul_f32 v111, v111, v233
    v_sub_f32 v112, v112, v232
    v_mul_f32 v112, v112, v233
    v_sub_f32 v113, v113, v232
    v_mul_f32 v113, v113, v233
    v_sub_f32 v114, v114, v232
    v_mul_f32 v114, v114, v233
    v_sub_f32 v115, v115, v232
    v_mul_f32 v115, v115, v233
    v_cvt_pk_bf16_f32 v118, v108, v109
    v_lshlrev_b32 v108, 16, v118
    v_and_b32 v109, 0xffff0000, v118
    v_cvt_pk_bf16_f32 v118, v110, v111
    v_lshlrev_b32 v110, 16, v118
    v_and_b32 v111, 0xffff0000, v118
    v_cvt_pk_bf16_f32 v118, v112, v113
    v_lshlrev_b32 v112, 16, v118
    v_and_b32 v113, 0xffff0000, v118
    v_cvt_pk_bf16_f32 v118, v114, v115
    v_lshlrev_b32 v114, 16, v118
    v_and_b32 v115, 0xffff0000, v118
    v_fma_f32 v108, v108, v168, v152
    v_fma_f32 v109, v109, v169, v153
    v_fma_f32 v110, v110, v170, v154
    v_fma_f32 v111, v111, v171, v155
    v_fma_f32 v112, v112, v172, v156
    v_fma_f32 v113, v113, v173, v157
    v_fma_f32 v114, v114, v174, v158
    v_fma_f32 v115, v115, v175, v159
    v_cvt_pk_bf16_f32 v180, v108, v109
    v_cvt_pk_bf16_f32 v181, v110, v111
    v_cvt_pk_bf16_f32 v182, v112, v113
    v_cvt_pk_bf16_f32 v183, v114, v115
    s_mov_b32 s36, 52969472
    buffer_store_dwordx4 v[180:183], v86, s[4:7], s36 offen sc1
    v_lshlrev_b32 v108, 16, v180
    v_and_b32 v109, 0xffff0000, v180
    v_lshlrev_b32 v110, 16, v181
    v_and_b32 v111, 0xffff0000, v181
    v_lshlrev_b32 v112, 16, v182
    v_and_b32 v113, 0xffff0000, v182
    v_lshlrev_b32 v114, 16, v183
    v_and_b32 v115, 0xffff0000, v183
    s_nop 1
L_two_86:
    v_add_f32 v232, v100, v101
    v_mul_f32 v233, v100, v100
    v_fmac_f32 v233, v101, v101
    v_add_f32 v232, v232, v102
    v_fmac_f32 v233, v102, v102
    v_add_f32 v232, v232, v103
    v_fmac_f32 v233, v103, v103
    v_add_f32 v232, v232, v104
    v_fmac_f32 v233, v104, v104
    v_add_f32 v232, v232, v105
    v_fmac_f32 v233, v105, v105
    v_add_f32 v232, v232, v106
    v_fmac_f32 v233, v106, v106
    v_add_f32 v232, v232, v107
    v_fmac_f32 v233, v107, v107
    s_cmp_ge_u32 s3, 2
    s_cbranch_scc1 L_two_87
    v_add_f32 v232, v232, v108
    v_fmac_f32 v233, v108, v108
    v_add_f32 v232, v232, v109
    v_fmac_f32 v233, v109, v109
    v_add_f32 v232, v232, v110
    v_fmac_f32 v233, v110, v110
    v_add_f32 v232, v232, v111
    v_fmac_f32 v233, v111, v111
    v_add_f32 v232, v232, v112
    v_fmac_f32 v233, v112, v112
    v_add_f32 v232, v232, v113
    v_fmac_f32 v233, v113, v113
    v_add_f32 v232, v232, v114
    v_fmac_f32 v233, v114, v114
    v_add_f32 v232, v232, v115
    v_fmac_f32 v233, v115, v115
    s_nop 1
L_two_87:
    v_add_f32_dpp v232, v232, v232 row_ror:8 row_mask:0xf bank_mask:0xf
    v_add_f32_dpp v233, v233, v233 row_ror:8 row_mask:0xf bank_mask:0xf
    v_mov_b32 v234, v232
    s_nop 1
    v_permlane16_swap_b32 v232, v234
    v_add_f32 v232, v232, v234
    v_mov_b32 v234, v232
    s_nop 1
    v_permlane32_swap_b32 v232, v234
    v_add_f32 v232, v232, v234
    v_mov_b32 v235, v233
    s_nop 1
    v_permlane16_swap_b32 v233, v235
    v_add_f32 v233, v233, v235
    v_mov_b32 v235, v233
    s_nop 1
    v_permlane32_swap_b32 v233, v235
    v_add_f32 v233, v233, v235
    v_lshlrev_b32 v234, 6, v0
    s_lshl_b32 s30, s3, 3
    s_add_u32 s30, s30, 162304
    v_add_u32 v234, s30, v234
    s_mov_b64 exec, 0xff
    ds_write_b64 v234, v[232:233]
    s_mov_b64 exec, -1
    s_waitcnt lgkmcnt(0)
    s_barrier
    v_and_b32 v234, 7, v0
    v_lshlrev_b32 v234, 6, v234
    v_add_u32 v234, 162304, v234
    ds_read_b128 v[236:239], v234 offset:0
    ds_read_b128 v[240:243], v234 offset:16
    s_waitcnt lgkmcnt(0)
    v_add_f32 v232, v236, v238
    v_add_f32 v233, v237, v239
    v_add_f32 v232, v232, v240
    v_add_f32 v233, v233, v241
    v_add_f32 v232, v232, v242
    v_add_f32 v233, v233, v243
    ds_read_b128 v[236:239], v234 offset:32
    ds_read_b128 v[240:243], v234 offset:48
    s_waitcnt lgkmcnt(0)
    v_add_f32 v232, v232, v236
    v_add_f32 v233, v233, v237
    v_add_f32 v232, v232, v238
    v_add_f32 v233, v233, v239
    v_add_f32 v232, v232, v240
    v_add_f32 v233, v233, v241
    v_add_f32 v232, v232, v242
    v_add_f32 v233, v233, v243
    v_mul_f32 v232, 0x3acccccd, v232
    v_mul_f32 v233, 0x3acccccd, v233
    v_fma_f32 v233, -v232, v232, v233
    v_max_f32 v233, 0, v233
    v_add_f32 v233, 0x3727c5ac, v233
    v_rsq_f32 v233, v233
    v_sub_f32 v100, v100, v232
    v_mul_f32 v100, v100, v233
    v_sub_f32 v101, v101, v232
    v_mul_f32 v101, v101, v233
    v_sub_f32 v102, v102, v232
    v_mul_f32 v102, v102, v233
    v_sub_f32 v103, v103, v232
    v_mul_f32 v103, v103, v233
    v_sub_f32 v104, v104, v232
    v_mul_f32 v104, v104, v233
    v_sub_f32 v105, v105, v232
    v_mul_f32 v105, v105, v233
    v_sub_f32 v106, v106, v232
    v_mul_f32 v106, v106, v233
    v_sub_f32 v107, v107, v232
    v_mul_f32 v107, v107, v233
    v_cvt_pk_bf16_f32 v184, v100, v101
    v_cvt_pk_bf16_f32 v185, v102, v103
    v_cvt_pk_bf16_f32 v186, v104, v105
    v_cvt_pk_bf16_f32 v187, v106, v107
    s_mov_b32 s36, 55574528
    buffer_store_dwordx4 v[184:187], v86, s[4:7], s36 offen sc1
    s_cmp_ge_u32 s3, 2
    s_cbranch_scc1 L_two_88
    v_sub_f32 v108, v108, v232
    v_mul_f32 v108, v108, v233
    v_sub_f32 v109, v109, v232
    v_mul_f32 v109, v109, v233
    v_sub_f32 v110, v110, v232
    v_mul_f32 v110, v110, v233
    v_sub_f32 v111, v111, v232
    v_mul_f32 v111, v111, v233
    v_sub_f32 v112, v112, v232
    v_mul_f32 v112, v112, v233
    v_sub_f32 v113, v113, v232
    v_mul_f32 v113, v113, v233
    v_sub_f32 v114, v114, v232
    v_mul_f32 v114, v114, v233
    v_sub_f32 v115, v115, v232
    v_mul_f32 v115, v115, v233
    v_cvt_pk_bf16_f32 v188, v108, v109
    v_cvt_pk_bf16_f32 v189, v110, v111
    v_cvt_pk_bf16_f32 v190, v112, v113
    v_cvt_pk_bf16_f32 v191, v114, v115
    s_mov_b32 s36, 55590912
    buffer_store_dwordx4 v[188:191], v86, s[4:7], s36 offen sc1
    s_nop 1
L_two_88:
    s_and_b32 s89, s2, 7
    s_lshl_b32 s89, s89, 5
    s_lshr_b32 s58, s2, 3
    s_add_u32 s89, s89, s58
    s_lshl_b32 s89, s89, 2
    s_add_u32 s89, s89, 47104
    s_and_b32 s45, s2, 7
    s_lshr_b32 s46, s2, 3
    s_lshl_b32 s45, s45, 2
    s_lshr_b32 s41, s46, 3
    s_add_u32 s41, s41, s45
    s_and_b32 s42, s46, 7
    s_and_b32 s43, s3, 3
    s_lshr_b32 s44, s3, 2
    s_lshl_b32 s49, s41, 2
    s_add_u32 s49, s49, s43
    v_lshlrev_b32 v1, 4, v0
    s_mul_i32 s45, s44, 10240
    v_add_u32 v2, s45, v1
    v_add_u32 v3, 0x10000, v2
    v_add_u32 v4, 0x20000, v2
    v_lshrrev_b32 v7, 5, v0
    v_lshlrev_b32 v7, 8, v7
    v_and_b32 v30, 15, v0
    v_lshlrev_b32 v30, 4, v30
    v_add_u32 v7, v7, v30
    v_bfe_u32 v30, v0, 4, 1
    v_lshlrev_b32 v30, 3, v30
    v_add_u32 v7, v7, v30
    s_mul_i32 s45, s49, 20480
    v_add_u32 v7, s45, v7
    s_mul_i32 s45, s49, 20480
    s_mul_i32 s46, s44, 10240
    s_add_u32 s45, s45, s46
    s_add_u32 s45, s45, 55574528
    v_add_u32 v5, s45, v1
    v_mov_b32 v28, 0xc0135761
    v_mov_b32 v29, 0xbdd2d3e8
    s_mul_i32 s55, s42, 2560
    s_add_u32 s55, s55, 58195968
    s_add_u32 s56, s49, 1
    s_and_b32 s56, s56, 14
    s_cmp_eq_u32 s56, 0
    s_cselect_b32 s56, 0, s29
    s_waitcnt vmcnt(0)
    s_barrier
    s_cmp_eq_u32 s3, 0
    s_cbranch_scc1 L_b0_89
    s_branch L_b1_90
L_b0_89:
    v_mov_b32 v250, s24
    v_mov_b32 v251, 0
    s_mov_b64 exec, 1
    s_cmp_eq_u32 s29, 0
    s_cbranch_scc1 L_fl_91
    buffer_store_dword v250, v251, s[4:7], s89 offen
    s_branch L_fj_92
L_fl_91:
    buffer_atomic_swap v250, v251, s[4:7], s89 offen
L_fj_92:
    s_mov_b64 exec, -1
    s_lshl_b32 s59, s41, 5
    s_add_u32 s59, s59, 47104
    v_lshlrev_b32 v251, 2, v0
    s_mov_b32 s58, 0
    s_mov_b32 s60, 0xff
    s_mov_b32 s61, 0x0
    s_mov_b64 exec, s[60:61]
L_poll_93:
    buffer_load_dword v252, v251, s[4:7], s59 offen sc1
    s_waitcnt vmcnt(0)
    v_cmp_ne_u32 vcc, s24, v252
    s_nop 1
    s_and_b64 vcc, vcc, s[60:61]
    s_cbranch_scc0 L_polld_94
    s_sleep 1
    s_add_u32 s58, s58, 1
    s_cmp_lt_u32 s58, 32768
    s_cbranch_scc1 L_poll_93
    s_load_dwordx2 s[20:21], s[0:1], 104
    s_waitcnt lgkmcnt(0)
    s_and_b32 s21, s21, 0xffff
    s_mov_b32 s22, 256
    s_mov_b32 s23, 0x20000
    v_mov_b32 v253, 0xdead0008
    v_mov_b32 v251, 36
    s_mov_b64 exec, 1
    buffer_store_dword v253, v251, s[20:23], 0 offen
L_polld_94:
    s_mov_b64 exec, -1
L_b1_90:
    s_waitcnt vmcnt(0)
    s_barrier
    s_mov_b32 s54, 0
    buffer_load_dwordx4 v[32:35], v5, s[4:7], s54 offen sc1
    s_mov_b32 s54, 1024
    buffer_load_dwordx4 v[36:39], v5, s[4:7], s54 offen sc1
    s_mov_b32 s54, 2048
    buffer_load_dwordx4 v[40:43], v5, s[4:7], s54 offen sc1
    s_mov_b32 s54, 3072
    buffer_load_dwordx4 v[44:47], v5, s[4:7], s54 offen sc1
    s_mov_b32 s54, 4096
    buffer_load_dwordx4 v[48:51], v5, s[4:7], s54 offen sc1
    ds_read_b128 v[80:83], v2 offset:0
    ds_read_b128 v[84:87], v2 offset:20480
    ds_read_b128 v[88:91], v2 offset:40960
    ds_read_b128 v[92:95], v2 offset:61440
    ds_read_b128 v[96:99], v3 offset:16384
    s_mov_b32 s54, 5120
    buffer_load_dwordx4 v[52:55], v5, s[4:7], s54 offen sc1
    s_waitcnt vmcnt(5)
    s_waitcnt lgkmcnt(4)
    v_mfma_f32_16x16x32_bf16 v[128:131], v[80:83], v[32:35], 0
    ds_read_b128 v[100:103], v2 offset:1024
    s_waitcnt lgkmcnt(4)
    v_mfma_f32_16x16x32_bf16 v[132:135], v[84:87], v[32:35], 0
    ds_read_b128 v[104:107], v2 offset:21504
    s_waitcnt lgkmcnt(4)
    v_mfma_f32_16x16x32_bf16 v[136:139], v[88:91], v[32:35], 0
    ds_read_b128 v[108:111], v2 offset:41984
    s_waitcnt lgkmcnt(4)
    v_mfma_f32_16x16x32_bf16 v[140:143], v[92:95], v[32:35], 0
    ds_read_b128 v[80:83], v2 offset:62464
    s_waitcnt lgkmcnt(4)
    v_mfma_f32_16x16x32_bf16 v[144:147], v[96:99], v[32:35], 0
    ds_read_b128 v[84:87], v3 offset:17408
    s_mov_b32 s54, 6144
    buffer_load_dwordx4 v[56:59], v5, s[4:7], s54 offen sc1
    s_waitcnt vmcnt(5)
    s_waitcnt lgkmcnt(4)
    v_mfma_f32_16x16x32_bf16 v[128:131], v[100:103], v[36:39], v[128:131]
    ds_read_b128 v[88:91], v2 offset:2048
    s_waitcnt lgkmcnt(4)
    v_mfma_f32_16x16x32_bf16 v[132:135], v[104:107], v[36:39], v[132:135]
    ds_read_b128 v[92:95], v2 offset:22528
    s_waitcnt lgkmcnt(4)
    v_mfma_f32_16x16x32_bf16 v[136:139], v[108:111], v[36:39], v[136:139]
    ds_read_b128 v[96:99], v2 offset:43008
    s_waitcnt lgkmcnt(4)
    v_mfma_f32_16x16x32_bf16 v[140:143], v[80:83], v[36:39], v[140:143]
    ds_read_b128 v[100:103], v2 offset:63488
    s_waitcnt lgkmcnt(4)
    v_mfma_f32_16x16x32_bf16 v[144:147], v[84:87], v[36:39], v[144:147]
    ds_read_b128 v[104:107], v3 offset:18432
    s_mov_b32 s54, 7168
    buffer_load_dwordx4 v[60:63], v5, s[4:7], s54 offen sc1
    s_waitcnt vmcnt(5)
    s_waitcnt lgkmcnt(4)
    v_mfma_f32_16x16x32_bf16 v[128:131], v[88:91], v[40:43], v[128:131]
    ds_read_b128 v[108:111], v2 offset:3072
    s_waitcnt lgkmcnt(4)
    v_mfma_f32_16x16x32_bf16 v[132:135], v[92:95], v[40:43], v[132:135]
    ds_read_b128 v[80:83], v2 offset:23552
    s_waitcnt lgkmcnt(4)
    v_mfma_f32_16x16x32_bf16 v[136:139], v[96:99], v[40:43], v[136:139]
    ds_read_b128 v[84:87], v2 offset:44032
    s_waitcnt lgkmcnt(4)
    v_mfma_f32_16x16x32_bf16 v[140:143], v[100:103], v[40:43], v[140:143]
    ds_read_b128 v[88:91], v2 offset:64512
    s_waitcnt lgkmcnt(4)
    v_mfma_f32_16x16x32_bf16 v[144:147], v[104:107], v[40:43], v[144:147]
    ds_read_b128 v[92:95], v3 offset:19456
    s_mov_b32 s54, 8192
    buffer_load_dwordx4 v[64:67], v5, s[4:7], s54 offen sc1
    s_waitcnt vmcnt(5)
    s_waitcnt lgkmcnt(4)
    v_mfma_f32_16x16x32_bf16 v[128:131], v[108:111], v[44:47], v[128:131]
    ds_read_b128 v[96:99], v2 offset:4096
    s_waitcnt lgkmcnt(4)
    v_mfma_f32_16x16x32_bf16 v[132:135], v[80:83], v[44:47], v[132:135]
    ds_read_b128 v[100:103], v2 offset:24576
    s_waitcnt lgkmcnt(4)
    v_mfma_f32_16x16x32_bf16 v[136:139], v[84:87], v[44:47], v[136:139]
    ds_read_b128 v[104:107], v2 offset:45056
    s_waitcnt lgkmcnt(4)
    v_mfma_f32_16x16x32_bf16 v[140:143], v[88:91], v[44:47], v[140:143]
    ds_read_b128 v[108:111], v3 offset:0
    s_waitcnt lgkmcnt(4)
    v_mfma_f32_16x16x32_bf16 v[144:147], v[92:95], v[44:47], v[144:147]
    ds_read_b128 v[80:83], v3 offset:20480
    s_mov_b32 s54, 9216
    buffer_load_dwordx4 v[68:71], v5, s[4:7], s54 offen sc1
    s_waitcnt vmcnt(5)
    s_waitcnt lgkmcnt(4)
    v_mfma_f32_16x16x32_bf16 v[128:131], v[96:99], v[48:51], v[128:131]
    ds_read_b128 v[84:87], v2 offset:5120
    s_waitcnt lgkmcnt(4)
    v_mfma_f32_16x16x32_bf16 v[132:135], v[100:103], v[48:51], v[132:135]
    ds_read_b128 v[88:91], v2 offset:25600
    s_waitcnt lgkmcnt(4)
    v_mfma_f32_16x16x32_bf16 v[136:139], v[104:107], v[48:51], v[136:139]
    ds_read_b128 v[92:95], v2 offset:46080
    s_bfe_u32 s25, s2, 0x30003
    s_mul_i32 s25, s25, 102400
    s_add_u32 s25, s25, 10485760
    s_mul_i32 s60, s3, 1147
    s_lshr_b32 s60, s60, 8
    s_min_u32 s60, s60, 31
    s_add_u32 s60, s60, 64
    s_lshl_b32 s60, s60, 10
    s_add_u32 s61, s25, s60
    s_add_u32 s60, s60, 40960
    s_mov_b32 m0, s60
    s_nop 0
    buffer_load_dwordx4 v1, s[4:7], s61 offen offset:0 sc1 lds
    s_waitcnt lgkmcnt(4)
    v_mfma_f32_16x16x32_bf16 v[140:143], v[108:111], v[48:51], v[140:143]
    ds_read_b128 v[96:99], v3 offset:1024
    s_waitcnt lgkmcnt(4)
    v_mfma_f32_16x16x32_bf16 v[144:147], v[80:83], v[48:51], v[144:147]
    ds_read_b128 v[100:103], v3 offset:21504
    s_waitcnt vmcnt(5)
    s_waitcnt lgkmcnt(4)
    v_mfma_f32_16x16x32_bf16 v[128:131], v[84:87], v[52:55], v[128:131]
    ds_read_b128 v[104:107], v2 offset:6144
    s_waitcnt lgkmcnt(4)
    v_mfma_f32_16x16x32_bf16 v[132:135], v[88:91], v[52:55], v[132:135]
    ds_read_b128 v[108:111], v2 offset:26624
    s_waitcnt lgkmcnt(4)
    v_mfma_f32_16x16x32_bf16 v[136:139], v[92:95], v[52:55], v[136:139]
    ds_read_b128 v[80:83], v2 offset:47104
    buffer_load_dwordx4 v1, s[4:7], s61 offen offset:1024 sc1 lds
    s_waitcnt lgkmcnt(4)
    v_mfma_f32_16x16x32_bf16 v[140:143], v[96:99], v[52:55], v[140:143]
    ds_read_b128 v[84:87], v3 offset:2048
    s_waitcnt lgkmcnt(4)
    v_mfma_f32_16x16x32_bf16 v[144:147], v[100:103], v[52:55], v[144:147]
    ds_read_b128 v[88:91], v3 offset:22528
    s_waitcnt vmcnt(5)
    s_waitcnt lgkmcnt(4)
    v_mfma_f32_16x16x32_bf16 v[128:131], v[104:107], v[56:59], v[128:131]
    ds_read_b128 v[92:95], v2 offset:7168
    s_waitcnt lgkmcnt(4)
    v_mfma_f32_16x16x32_bf16 v[132:135], v[108:111], v[56:59], v[132:135]
    ds_read_b128 v[96:99], v2 offset:27648
    s_waitcnt lgkmcnt(4)
    v_mfma_f32_16x16x32_bf16 v[136:139], v[80:83], v[56:59], v[136:139]
    ds_read_b128 v[100:103], v2 offset:48128
    buffer_load_dwordx4 v1, s[4:7], s61 offen offset:2048 sc1 lds
    s_waitcnt lgkmcnt(4)
    v_mfma_f32_16x16x32_bf16 v[140:143], v[84:87], v[56:59], v[140:143]
    ds_read_b128 v[104:107], v3 offset:3072
    s_waitcnt lgkmcnt(4)
    v_mfma_f32_16x16x32_bf16 v[144:147], v[88:91], v[56:59], v[144:147]
    ds_read_b128 v[108:111], v3 offset:23552
    s_waitcnt vmcnt(5)
    s_waitcnt lgkmcnt(4)
    v_mfma_f32_16x16x32_bf16 v[128:131], v[92:95], v[60:63], v[128:131]
    ds_read_b128 v[80:83], v2 offset:8192
    s_waitcnt lgkmcnt(4)
    v_mfma_f32_16x16x32_bf16 v[132:135], v[96:99], v[60:63], v[132:135]
    ds_read_b128 v[84:87], v2 offset:28672
    s_waitcnt lgkmcnt(4)
    v_mfma_f32_16x16x32_bf16 v[136:139], v[100:103], v[60:63], v[136:139]
    ds_read_b128 v[88:91], v2 offset:49152
    buffer_load_dwordx4 v1, s[4:7], s61 offen offset:3072 sc1 lds
    s_add_u32 s60, s60, 4096
    s_add_u32 s61, s61, 4096
    s_waitcnt lgkmcnt(4)
    v_mfma_f32_16x16x32_bf16 v[140:143], v[104:107], v[60:63], v[140:143]
    ds_read_b128 v[92:95], v3 offset:4096
    s_waitcnt lgkmcnt(4)
    v_mfma_f32_16x16x32_bf16 v[144:147], v[108:111], v[60:63], v[144:147]
    ds_read_b128 v[96:99], v3 offset:24576
    s_waitcnt vmcnt(5)
    s_waitcnt lgkmcnt(4)
    v_mfma_f32_16x16x32_bf16 v[128:131], v[80:83], v[64:67], v[128:131]
    ds_read_b128 v[100:103], v2 offset:9216
    s_waitcnt lgkmcnt(4)
    v_mfma_f32_16x16x32_bf16 v[132:135], v[84:87], v[64:67], v[132:135]
    ds_read_b128 v[104:107], v2 offset:29696
    s_waitcnt lgkmcnt(4)
    v_mfma_f32_16x16x32_bf16 v[136:139], v[88:91], v[64:67], v[136:139]
    ds_read_b128 v[108:111], v2 offset:50176
    s_mov_b32 m0, s60
    s_nop 0
    buffer_load_dwordx4 v1, s[4:7], s61 offen offset:0 sc1 lds
    s_add_u32 s60, s60, 1024
    s_add_u32 s61, s61, 1024
    s_waitcnt lgkmcnt(4)
    v_mfma_f32_16x16x32_bf16 v[140:143], v[92:95], v[64:67], v[140:143]
    ds_read_b128 v[80:83], v3 offset:5120
    s_waitcnt lgkmcnt(4)
    v_mfma_f32_16x16x32_bf16 v[144:147], v[96:99], v[64:67], v[144:147]
    ds_read_b128 v[84:87], v3 offset:25600
    s_waitcnt vmcnt(5)
    s_waitcnt lgkmcnt(4)
    v_mfma_f32_16x16x32_bf16 v[128:131], v[100:103], v[68:71], v[128:131]
    s_waitcnt lgkmcnt(3)
    v_mfma_f32_16x16x32_bf16 v[132:135], v[104:107], v[68:71], v[132:135]
    s_waitcnt lgkmcnt(2)
    v_mfma_f32_16x16x32_bf16 v[136:139], v[108:111], v[68:71], v[136:139]
    s_waitcnt lgkmcnt(1)
    v_mfma_f32_16x16x32_bf16 v[140:143], v[80:83], v[68:71], v[140:143]
    s_waitcnt lgkmcnt(0)
    v_mfma_f32_16x16x32_bf16 v[144:147], v[84:87], v[68:71], v[144:147]
    s_mul_i32 s45, s43, 5120
    s_add_u32 s45, s45, 143360
    v_add_u32 v8, s45, v1
    s_cmp_lg_u32 s44, 0
    s_cbranch_scc1 L_kh1_95
    s_nop 0
    ds_write_b128 v8, v[140:143] offset:3072
    s_nop 0
    ds_write_b128 v8, v[144:147] offset:4096
    s_branch L_khj_96
L_kh1_95:
    s_nop 7
    ds_write_b128 v8, v[128:131] offset:0
    ds_write_b128 v8, v[132:135] offset:1024
    ds_write_b128 v8, v[136:139] offset:2048
L_khj_96:
    s_bfe_u32 s25, s2, 0x30003
    s_mul_i32 s25, s25, 102400
    s_add_u32 s25, s25, 10485760
    s_mul_i32 s50, s3, 8
    s_add_u32 s50, s50, 0
    s_lshl_b32 s50, s50, 10
    s_add_u32 s51, s25, s50
    s_add_u32 s50, s50, 40960
    s_waitcnt lgkmcnt(0)
    s_barrier
    s_cmp_lg_u32 s44, 0
    s_cbranch_scc1 L_kh1b_97
    s_mov_b32 m0, s50
    s_nop 0
    buffer_load_dwordx4 v1, s[4:7], s51 offen offset:0 sc1 lds
    ds_read_b128 v[80:83], v8 offset:0
    ds_read_b128 v[84:87], v8 offset:1024
    ds_read_b128 v[88:91], v8 offset:2048
    s_waitcnt lgkmcnt(0)
    v_pk_add_f32 v[128:129], v[128:129], v[80:81]
    v_pk_add_f32 v[130:131], v[130:131], v[82:83]
    v_pk_add_f32 v[132:133], v[132:133], v[84:85]
    v_pk_add_f32 v[134:135], v[134:135], v[86:87]
    v_pk_add_f32 v[136:137], v[136:137], v[88:89]
    buffer_load_dwordx4 v1, s[4:7], s51 offen offset:1024 sc1 lds
    v_pk_add_f32 v[138:139], v[138:139], v[90:91]
    v_pk_mul_f32 v[12:13], v[128:129], v[128:129]
    v_pk_mul_f32 v[14:15], v[130:131], v[130:131]
    v_pk_fma_f32 v[12:13], v[12:13], v[28:29], v[28:29] op_sel:[0,1,0] op_sel_hi:[1,1,0]
    v_pk_fma_f32 v[14:15], v[14:15], v[28:29], v[28:29] op_sel:[0,1,0] op_sel_hi:[1,1,0]
    v_pk_mul_f32 v[12:13], v[12:13], v[128:129]
    v_pk_mul_f32 v[14:15], v[14:15], v[130:131]
    v_exp_f32 v12, v12
    buffer_load_dwordx4 v1, s[4:7], s51 offen offset:2048 sc1 lds
    v_exp_f32 v13, v13
    v_exp_f32 v14, v14
    v_exp_f32 v15, v15
    v_pk_add_f32 v[12:13], v[12:13], 1.0 op_sel_hi:[1,0]
    v_pk_add_f32 v[14:15], v[14:15], 1.0 op_sel_hi:[1,0]
    v_rcp_f32 v12, v12
    v_rcp_f32 v13, v13
    v_rcp_f32 v14, v14
    buffer_load_dwordx4 v1, s[4:7], s51 offen offset:3072 sc1 lds
    s_add_u32 s50, s50, 4096
    s_add_u32 s51, s51, 4096
    v_rcp_f32 v15, v15
    v_pk_mul_f32 v[128:129], v[128:129], v[12:13]
    v_pk_mul_f32 v[130:131], v[130:131], v[14:15]
    v_pk_mul_f32 v[12:13], v[132:133], v[132:133]
    v_pk_mul_f32 v[14:15], v[134:135], v[134:135]
    v_pk_fma_f32 v[12:13], v[12:13], v[28:29], v[28:29] op_sel:[0,1,0] op_sel_hi:[1,1,0]
    v_pk_fma_f32 v[14:15], v[14:15], v[28:29], v[28:29] op_sel:[0,1,0] op_sel_hi:[1,1,0]
    v_pk_mul_f32 v[12:13], v[12:13], v[132:133]
    s_mov_b32 m0, s50
    s_nop 0
    buffer_load_dwordx4 v1, s[4:7], s51 offen offset:0 sc1 lds
    v_pk_mul_f32 v[14:15], v[14:15], v[134:135]
    v_exp_f32 v12, v12
    v_exp_f32 v13, v13
    v_exp_f32 v14, v14
    v_exp_f32 v15, v15
    v_pk_add_f32 v[12:13], v[12:13], 1.0 op_sel_hi:[1,0]
    v_pk_add_f32 v[14:15], v[14:15], 1.0 op_sel_hi:[1,0]
    v_rcp_f32 v12, v12
    v_rcp_f32 v13, v13
    buffer_load_dwordx4 v1, s[4:7], s51 offen offset:1024 sc1 lds
    v_rcp_f32 v14, v14
    v_rcp_f32 v15, v15
    v_pk_mul_f32 v[132:133], v[132:133], v[12:13]
    v_pk_mul_f32 v[134:135], v[134:135], v[14:15]
    v_pk_mul_f32 v[12:13], v[136:137], v[136:137]
    v_pk_mul_f32 v[14:15], v[138:139], v[138:139]
    v_pk_fma_f32 v[12:13], v[12:13], v[28:29], v[28:29] op_sel:[0,1,0] op_sel_hi:[1,1,0]
    v_pk_fma_f32 v[14:15], v[14:15], v[28:29], v[28:29] op_sel:[0,1,0] op_sel_hi:[1,1,0]
    buffer_load_dwordx4 v1, s[4:7], s51 offen offset:2048 sc1 lds
    v_pk_mul_f32 v[12:13], v[12:13], v[136:137]
    v_pk_mul_f32 v[14:15], v[14:15], v[138:139]
    v_exp_f32 v12, v12
    v_exp_f32 v13, v13
    v_exp_f32 v14, v14
    v_exp_f32 v15, v15
    v_pk_add_f32 v[12:13], v[12:13], 1.0 op_sel_hi:[1,0]
    v_pk_add_f32 v[14:15], v[14:15], 1.0 op_sel_hi:[1,0]
    buffer_load_dwordx4 v1, s[4:7], s51 offen offset:3072 sc1 lds
    s_add_u32 s50, s50, 4096
    s_add_u32 s51, s51, 4096
    v_rcp_f32 v12, v12
    v_rcp_f32 v13, v13
    v_rcp_f32 v14, v14
    v_rcp_f32 v15, v15
    v_pk_mul_f32 v[136:137], v[136:137], v[12:13]
    v_pk_mul_f32 v[138:139], v[138:139], v[14:15]
    v_cvt_pk_bf16_f32 v16, v128, v129
    v_cvt_pk_bf16_f32 v17, v130, v131
    buffer_store_dwordx2 v[16:17], v7, s[4:7], s55 offen offset:0 sc1
    v_cvt_pk_bf16_f32 v18, v132, v133
    v_cvt_pk_bf16_f32 v19, v134, v135
    buffer_store_dwordx2 v[18:19], v7, s[4:7], s55 offen offset:512 sc1
    v_cvt_pk_bf16_f32 v20, v136, v137
    v_cvt_pk_bf16_f32 v21, v138, v139
    buffer_store_dwordx2 v[20:21], v7, s[4:7], s55 offen offset:1024 sc1
    s_branch L_khe_98
L_kh1b_97:
    s_mov_b32 m0, s50
    s_nop 0
    buffer_load_dwordx4 v1, s[4:7], s51 offen offset:0 sc1 lds
    ds_read_b128 v[92:95], v8 offset:3072
    ds_read_b128 v[96:99], v8 offset:4096
    s_waitcnt lgkmcnt(0)
    v_pk_add_f32 v[140:141], v[140:141], v[92:93]
    v_pk_add_f32 v[142:143], v[142:143], v[94:95]
    v_pk_add_f32 v[144:145], v[144:145], v[96:97]
    buffer_load_dwordx4 v1, s[4:7], s51 offen offset:1024 sc1 lds
    v_pk_add_f32 v[146:147], v[146:147], v[98:99]
    v_pk_mul_f32 v[12:13], v[140:141], v[140:141]
    v_pk_mul_f32 v[14:15], v[142:143], v[142:143]
    v_pk_fma_f32 v[12:13], v[12:13], v[28:29], v[28:29] op_sel:[0,1,0] op_sel_hi:[1,1,0]
    v_pk_fma_f32 v[14:15], v[14:15], v[28:29], v[28:29] op_sel:[0,1,0] op_sel_hi:[1,1,0]
    v_pk_mul_f32 v[12:13], v[12:13], v[140:141]
    buffer_load_dwordx4 v1, s[4:7], s51 offen offset:2048 sc1 lds
    v_pk_mul_f32 v[14:15], v[14:15], v[142:143]
    v_exp_f32 v12, v12
    v_exp_f32 v13, v13
    v_exp_f32 v14, v14
    v_exp_f32 v15, v15
    buffer_load_dwordx4 v1, s[4:7], s51 offen offset:3072 sc1 lds
    s_add_u32 s50, s50, 4096
    s_add_u32 s51, s51, 4096
    v_pk_add_f32 v[12:13], v[12:13], 1.0 op_sel_hi:[1,0]
    v_pk_add_f32 v[14:15], v[14:15], 1.0 op_sel_hi:[1,0]
    v_rcp_f32 v12, v12
    v_rcp_f32 v13, v13
    v_rcp_f32 v14, v14
    v_rcp_f32 v15, v15
    s_mov_b32 m0, s50
    s_nop 0
    buffer_load_dwordx4 v1, s[4:7], s51 offen offset:0 sc1 lds
    v_pk_mul_f32 v[140:141], v[140:141], v[12:13]
    v_pk_mul_f32 v[142:143], v[142:143], v[14:15]
    v_pk_mul_f32 v[12:13], v[144:145], v[144:145]
    v_pk_mul_f32 v[14:15], v[146:147], v[146:147]
    v_pk_fma_f32 v[12:13], v[12:13], v[28:29], v[28:29] op_sel:[0,1,0] op_sel_hi:[1,1,0]
    v_pk_fma_f32 v[14:15], v[14:15], v[28:29], v[28:29] op_sel:[0,1,0] op_sel_hi:[1,1,0]
    buffer_load_dwordx4 v1, s[4:7], s51 offen offset:1024 sc1 lds
    v_pk_mul_f32 v[12:13], v[12:13], v[144:145]
    v_pk_mul_f32 v[14:15], v[14:15], v[146:147]
    v_exp_f32 v12, v12
    v_exp_f32 v13, v13
    v_exp_f32 v14, v14
    buffer_load_dwordx4 v1, s[4:7], s51 offen offset:2048 sc1 lds
    v_exp_f32 v15, v15
    v_pk_add_f32 v[12:13], v[12:13], 1.0 op_sel_hi:[1,0]
    v_pk_add_f32 v[14:15], v[14:15], 1.0 op_sel_hi:[1,0]
    v_rcp_f32 v12, v12
    v_rcp_f32 v13, v13
    v_rcp_f32 v14, v14
    buffer_load_dwordx4 v1, s[4:7], s51 offen offset:3072 sc1 lds
    s_add_u32 s50, s50, 4096
    s_add_u32 s51, s51, 4096
    v_rcp_f32 v15, v15
    v_pk_mul_f32 v[144:145], v[144:145], v[12:13]
    v_pk_mul_f32 v[146:147], v[146:147], v[14:15]
    v_cvt_pk_bf16_f32 v22, v140, v141
    v_cvt_pk_bf16_f32 v23, v142, v143
    buffer_store_dwordx2 v[22:23], v7, s[4:7], s55 offen offset:1536 sc1
    v_cvt_pk_bf16_f32 v24, v144, v145
    v_cvt_pk_bf16_f32 v25, v146, v147
    buffer_store_dwordx2 v[24:25], v7, s[4:7], s55 offen offset:2048 sc1
L_khe_98:
    s_lshl_b32 s89, s41, 3
    s_add_u32 s89, s89, s42
    s_lshl_b32 s89, s89, 2
    s_add_u32 s90, s89, 49152
    s_add_u32 s89, s89, 48128
    s_and_b32 s45, s2, 7
    s_lshr_b32 s46, s2, 3
    s_lshl_b32 s45, s45, 2
    s_lshr_b32 s41, s46, 3
    s_add_u32 s41, s41, s45
    s_and_b32 s42, s46, 7
    s_and_b32 s43, s3, 3
    s_lshr_b32 s44, s3, 2
    s_lshl_b32 s49, s41, 2
    s_add_u32 s49, s49, s43
    v_lshlrev_b32 v1, 4, v0
    s_mul_i32 s45, s44, 10240
    v_add_u32 v2, s45, v1
    v_add_u32 v3, 0x10000, v2
    v_add_u32 v4, 0x20000, v2
    v_lshrrev_b32 v7, 5, v0
    v_lshlrev_b32 v7, 8, v7
    v_and_b32 v30, 15, v0
    v_lshlrev_b32 v30, 4, v30
    v_add_u32 v7, v7, v30
    v_bfe_u32 v30, v0, 4, 1
    v_lshlrev_b32 v30, 3, v30
    v_add_u32 v7, v7, v30
    s_mul_i32 s45, s49, 20480
    v_add_u32 v7, s45, v7
    s_add_u32 s46, s44, 1
    s_lshl_b32 s45, s49, 4
    v_and_b32 v8, 15, v0
    v_add_u32 v8, s45, v8
    v_lshrrev_b32 v9, 4, v0
    v_lshlrev_b32 v9, 8, v9
    s_mul_i32 s47, s44, 10240
    s_add_u32 s47, s47, 58195968
    v_subrev_u32 v10, s46, v8
    v_lshrrev_b32 v11, 4, v10
    v_mul_u32_u24 v11, 20480, v11
    v_and_b32 v12, 15, v10
    v_lshlrev_b32 v12, 4, v12
    v_add_u32 v11, v11, v12
    v_add_u32 v11, v11, v9
    v_add_u32 v11, s47, v11
    v_mov_b32 v12, 0x7fff0000
    v_cmp_gt_u32 vcc, 2048, v10
    s_nop 1
    v_cndmask_b32 v5, v12, v11, vcc
    v_add_u32 v10, s46, v8
    v_lshrrev_b32 v11, 4, v10
    v_mul_u32_u24 v11, 20480, v11
    v_and_b32 v12, 15, v10
    v_lshlrev_b32 v12, 4, v12
    v_add_u32 v11, v11, v12
    v_add_u32 v11, v11, v9
    v_add_u32 v11, s47, v11
    v_mov_b32 v12, 0x7fff0000
    v_cmp_gt_u32 vcc, 2048, v10
    s_nop 1
    v_cndmask_b32 v6, v12, v11, vcc
    s_mul_i32 s55, s42, 2560
    s_add_u32 s56, s55, 52953088
    s_add_u32 s55, s55, 60817408
    v_lshlrev_b32 v26, 3, v0
    s_lshl_b32 s45, s42, 1
    s_add_u32 s45, s45, s44
    s_lshl_b32 s45, s45, 7
    s_mul_i32 s46, s49, 2048
    s_add_u32 s45, s45, s46
    s_add_u32 s57, s45, 70516736
    s_waitcnt vmcnt(0)
    s_barrier
    s_cmp_eq_u32 s3, 0
    s_cbranch_scc1 L_b0_99
    s_mul_i32 s58, s44, 1536
    s_add_u32 s58, s58, s56
    buffer_load_dwordx2 v[112:113], v7, s[4:7], s58 offen offset:0 sc1
    buffer_load_dwordx2 v[114:115], v7, s[4:7], s58 offen offset:512 sc1
    buffer_load_dwordx2 v[116:117], v7, s[4:7], s58 offen offset:1024 sc1
    s_branch L_b1_100
L_b0_99:
    v_mov_b32 v250, s24
    v_mov_b32 v251, 0
    s_mov_b64 exec, 1
    s_cmp_eq_u32 s29, 0
    s_cbranch_scc1 L_fl_101
    buffer_store_dword v250, v251, s[4:7], s89 offen
    s_branch L_fj_102
L_fl_101:
    buffer_atomic_swap v250, v251, s[4:7], s89 offen
L_fj_102:
    s_mov_b64 exec, -1
    s_add_u32 s58, s41, 1
    s_and_b32 s58, s58, 2
    s_cmp_lg_u32 s58, 0
    s_cbranch_scc1 L_g2_103
    v_mov_b32 v250, s24
    v_mov_b32 v251, 0
    s_mov_b64 exec, 1
    buffer_atomic_swap v250, v251, s[4:7], s90 offen
    s_mov_b64 exec, -1
L_g2_103:
    s_lshl_b32 s59, s41, 5
    s_sub_u32 s59, s59, 32
    v_lshlrev_b32 v251, 2, v0
    v_add_u32 v251, s59, v251
    v_lshrrev_b32 v252, 7, v251
    s_lshr_b32 s58, s41, 2
    v_cmp_eq_u32 vcc, s58, v252
    v_mov_b32 v252, 49152
    v_mov_b32 v253, 48128
    s_nop 0
    v_cndmask_b32 v252, v252, v253, vcc
    v_add_u32 v251, v251, v252
    s_mov_b32 s60, 0xffffff
    s_mov_b32 s61, 0
    s_cmp_eq_u32 s41, 0
    s_cselect_b32 s60, 0xffff00, s60
    s_cmp_eq_u32 s41, 31
    s_cselect_b32 s60, 0xffff, s60
    s_mov_b32 s59, 0
    s_mov_b32 s58, 0
    s_mov_b64 exec, s[60:61]
L_poll_104:
    buffer_load_dword v252, v251, s[4:7], s59 offen sc1
    s_waitcnt vmcnt(0)
    v_cmp_ne_u32 vcc, s24, v252
    s_nop 1
    s_and_b64 vcc, vcc, s[60:61]
    s_cbranch_scc0 L_polld_105
    s_sleep 1
    s_add_u32 s58, s58, 1
    s_cmp_lt_u32 s58, 32768
    s_cbranch_scc1 L_poll_104
    s_load_dwordx2 s[20:21], s[0:1], 104
    s_waitcnt lgkmcnt(0)
    s_and_b32 s21, s21, 0xffff
    s_mov_b32 s22, 256
    s_mov_b32 s23, 0x20000
    v_mov_b32 v253, 0xdead0009
    v_mov_b32 v251, 40
    s_mov_b64 exec, 1
    buffer_store_dword v253, v251, s[20:23], 0 offen
L_polld_105:
    s_mov_b64 exec, -1
    s_mul_i32 s58, s44, 1536
    s_add_u32 s58, s58, s56
    buffer_load_dwordx2 v[112:113], v7, s[4:7], s58 offen offset:0 sc1
    buffer_load_dwordx2 v[114:115], v7, s[4:7], s58 offen offset:512 sc1
    buffer_load_dwordx2 v[116:117], v7, s[4:7], s58 offen offset:1024 sc1
L_b1_100:
    s_barrier
    s_mov_b32 s54, 0
    buffer_load_dwordx4 v[32:35], v5, s[4:7], s54 offen sc1
    s_mov_b32 s54, 1024
    buffer_load_dwordx4 v[36:39], v5, s[4:7], s54 offen sc1
    s_mov_b32 s54, 2048
    buffer_load_dwordx4 v[40:43], v5, s[4:7], s54 offen sc1
    s_mov_b32 s54, 3072
    buffer_load_dwordx4 v[44:47], v5, s[4:7], s54 offen sc1
    s_mov_b32 s54, 4096
    buffer_load_dwordx4 v[48:51], v5, s[4:7], s54 offen sc1
    ds_read_b128 v[80:83], v2 offset:40960
    ds_read_b128 v[84:87], v2 offset:61440
    ds_read_b128 v[88:91], v3 offset:16384
    ds_read_b128 v[92:95], v3 offset:36864
    ds_read_b128 v[96:99], v3 offset:57344
    s_mov_b32 s54, 5120
    buffer_load_dwordx4 v[52:55], v6, s[4:7], s54 offen sc1
    s_waitcnt vmcnt(5)
    s_waitcnt lgkmcnt(4)
    v_mfma_f32_16x16x32_bf16 v[128:131], v[80:83], v[32:35], 0
    ds_read_b128 v[100:103], v2 offset:41984
    s_waitcnt lgkmcnt(4)
    v_mfma_f32_16x16x32_bf16 v[132:135], v[84:87], v[32:35], 0
    ds_read_b128 v[104:107], v2 offset:62464
    s_waitcnt lgkmcnt(4)
    v_mfma_f32_16x16x32_bf16 v[136:139], v[88:91], v[32:35], 0
    ds_read_b128 v[108:111], v3 offset:17408
    s_waitcnt lgkmcnt(4)
    v_mfma_f32_16x16x32_bf16 v[140:143], v[92:95], v[32:35], 0
    ds_read_b128 v[80:83], v3 offset:37888
    s_waitcnt lgkmcnt(4)
    v_mfma_f32_16x16x32_bf16 v[144:147], v[96:99], v[32:35], 0
    ds_read_b128 v[84:87], v3 offset:58368
    s_mov_b32 s54, 6144
    buffer_load_dwordx4 v[56:59], v6, s[4:7], s54 offen sc1
    s_waitcnt vmcnt(5)
    s_waitcnt lgkmcnt(4)
    v_mfma_f32_16x16x32_bf16 v[128:131], v[100:103], v[36:39], v[128:131]
    ds_read_b128 v[88:91], v2 offset:43008
    s_waitcnt lgkmcnt(4)
    v_mfma_f32_16x16x32_bf16 v[132:135], v[104:107], v[36:39], v[132:135]
    ds_read_b128 v[92:95], v2 offset:63488
    s_waitcnt lgkmcnt(4)
    v_mfma_f32_16x16x32_bf16 v[136:139], v[108:111], v[36:39], v[136:139]
    ds_read_b128 v[96:99], v3 offset:18432
    s_waitcnt lgkmcnt(4)
    v_mfma_f32_16x16x32_bf16 v[140:143], v[80:83], v[36:39], v[140:143]
    ds_read_b128 v[100:103], v3 offset:38912
    s_waitcnt lgkmcnt(4)
    v_mfma_f32_16x16x32_bf16 v[144:147], v[84:87], v[36:39], v[144:147]
    ds_read_b128 v[104:107], v3 offset:59392
    s_mov_b32 s54, 7168
    buffer_load_dwordx4 v[60:63], v6, s[4:7], s54 offen sc1
    s_waitcnt vmcnt(5)
    s_waitcnt lgkmcnt(4)
    v_mfma_f32_16x16x32_bf16 v[128:131], v[88:91], v[40:43], v[128:131]
    ds_read_b128 v[108:111], v2 offset:44032
    s_waitcnt lgkmcnt(4)
    v_mfma_f32_16x16x32_bf16 v[132:135], v[92:95], v[40:43], v[132:135]
    ds_read_b128 v[80:83], v2 offset:64512
    s_waitcnt lgkmcnt(4)
    v_mfma_f32_16x16x32_bf16 v[136:139], v[96:99], v[40:43], v[136:139]
    ds_read_b128 v[84:87], v3 offset:19456
    s_waitcnt lgkmcnt(4)
    v_mfma_f32_16x16x32_bf16 v[140:143], v[100:103], v[40:43], v[140:143]
    ds_read_b128 v[88:91], v3 offset:39936
    s_waitcnt lgkmcnt(4)
    v_mfma_f32_16x16x32_bf16 v[144:147], v[104:107], v[40:43], v[144:147]
    ds_read_b128 v[92:95], v3 offset:60416
    s_mov_b32 s54, 8192
    buffer_load_dwordx4 v[64:67], v6, s[4:7], s54 offen sc1
    s_waitcnt vmcnt(5)
    s_waitcnt lgkmcnt(4)
    v_mfma_f32_16x16x32_bf16 v[128:131], v[108:111], v[44:47], v[128:131]
    ds_read_b128 v[96:99], v2 offset:45056
    s_waitcnt lgkmcnt(4)
    v_mfma_f32_16x16x32_bf16 v[132:135], v[80:83], v[44:47], v[132:135]
    ds_read_b128 v[100:103], v3 offset:0
    s_waitcnt lgkmcnt(4)
    v_mfma_f32_16x16x32_bf16 v[136:139], v[84:87], v[44:47], v[136:139]
    ds_read_b128 v[104:107], v3 offset:20480
    s_waitcnt lgkmcnt(4)
    v_mfma_f32_16x16x32_bf16 v[140:143], v[88:91], v[44:47], v[140:143]
    ds_read_b128 v[108:111], v3 offset:40960
    s_waitcnt lgkmcnt(4)
    v_mfma_f32_16x16x32_bf16 v[144:147], v[92:95], v[44:47], v[144:147]
    ds_read_b128 v[80:83], v3 offset:61440
    s_mov_b32 s54, 9216
    buffer_load_dwordx4 v[68:71], v6, s[4:7], s54 offen sc1
    s_waitcnt vmcnt(5)
    s_waitcnt lgkmcnt(4)
    v_mfma_f32_16x16x32_bf16 v[128:131], v[96:99], v[48:51], v[128:131]
    ds_read_b128 v[84:87], v2 offset:46080
    s_waitcnt lgkmcnt(4)
    v_mfma_f32_16x16x32_bf16 v[132:135], v[100:103], v[48:51], v[132:135]
    ds_read_b128 v[88:91], v3 offset:1024
    s_waitcnt lgkmcnt(4)
    v_mfma_f32_16x16x32_bf16 v[136:139], v[104:107], v[48:51], v[136:139]
    ds_read_b128 v[92:95], v3 offset:21504
    s_bfe_u32 s25, s2, 0x40003
    s_mul_i32 s26, s25, 7
    s_mul_i32 s27, s25, 6
    s_add_u32 s27, s27, 12
    s_cmp_lt_u32 s25, 12
    s_cselect_b32 s25, s26, s27
    s_mul_i32 s25, s25, 20480
    s_add_u32 s25, s25, 11534336
    s_mul_i32 s60, s3, 5
    s_add_u32 s60, s60, 0
    s_lshl_b32 s60, s60, 10
    s_add_u32 s61, s25, s60
    s_mov_b32 m0, s60
    s_nop 0
    buffer_load_dwordx4 v1, s[4:7], s61 offen offset:0 sc1 lds
    s_waitcnt lgkmcnt(4)
    v_mfma_f32_16x16x32_bf16 v[140:143], v[108:111], v[48:51], v[140:143]
    ds_read_b128 v[96:99], v3 offset:41984
    s_waitcnt lgkmcnt(4)
    v_mfma_f32_16x16x32_bf16 v[144:147], v[80:83], v[48:51], v[144:147]
    ds_read_b128 v[100:103], v3 offset:62464
    s_waitcnt vmcnt(5)
    s_waitcnt lgkmcnt(4)
    v_mfma_f32_16x16x32_bf16 v[128:131], v[84:87], v[52:55], v[128:131]
    ds_read_b128 v[104:107], v2 offset:47104
    s_waitcnt lgkmcnt(4)
    v_mfma_f32_16x16x32_bf16 v[132:135], v[88:91], v[52:55], v[132:135]
    ds_read_b128 v[108:111], v3 offset:2048
    s_waitcnt lgkmcnt(4)
    v_mfma_f32_16x16x32_bf16 v[136:139], v[92:95], v[52:55], v[136:139]
    ds_read_b128 v[80:83], v3 offset:22528
    buffer_load_dwordx4 v1, s[4:7], s61 offen offset:1024 sc1 lds
    s_waitcnt lgkmcnt(4)
    v_mfma_f32_16x16x32_bf16 v[140:143], v[96:99], v[52:55], v[140:143]
    ds_read_b128 v[84:87], v3 offset:43008
    s_waitcnt lgkmcnt(4)
    v_mfma_f32_16x16x32_bf16 v[144:147], v[100:103], v[52:55], v[144:147]
    ds_read_b128 v[88:91], v3 offset:63488
    s_waitcnt vmcnt(5)
    s_waitcnt lgkmcnt(4)
    v_mfma_f32_16x16x32_bf16 v[128:131], v[104:107], v[56:59], v[128:131]
    ds_read_b128 v[92:95], v2 offset:48128
    s_waitcnt lgkmcnt(4)
    v_mfma_f32_16x16x32_bf16 v[132:135], v[108:111], v[56:59], v[132:135]
    ds_read_b128 v[96:99], v3 offset:3072
    s_waitcnt lgkmcnt(4)
    v_mfma_f32_16x16x32_bf16 v[136:139], v[80:83], v[56:59], v[136:139]
    ds_read_b128 v[100:103], v3 offset:23552
    buffer_load_dwordx4 v1, s[4:7], s61 offen offset:2048 sc1 lds
    s_waitcnt lgkmcnt(4)
    v_mfma_f32_16x16x32_bf16 v[140:143], v[84:87], v[56:59], v[140:143]
    ds_read_b128 v[104:107], v3 offset:44032
    s_waitcnt lgkmcnt(4)
    v_mfma_f32_16x16x32_bf16 v[144:147], v[88:91], v[56:59], v[144:147]
    ds_read_b128 v[108:111], v3 offset:64512
    s_waitcnt vmcnt(5)
    s_waitcnt lgkmcnt(4)
    v_mfma_f32_16x16x32_bf16 v[128:131], v[92:95], v[60:63], v[128:131]
    ds_read_b128 v[80:83], v2 offset:49152
    s_waitcnt lgkmcnt(4)
    v_mfma_f32_16x16x32_bf16 v[132:135], v[96:99], v[60:63], v[132:135]
    ds_read_b128 v[84:87], v3 offset:4096
    s_waitcnt lgkmcnt(4)
    v_mfma_f32_16x16x32_bf16 v[136:139], v[100:103], v[60:63], v[136:139]
    ds_read_b128 v[88:91], v3 offset:24576
    buffer_load_dwordx4 v1, s[4:7], s61 offen offset:3072 sc1 lds
    s_add_u32 s60, s60, 4096
    s_add_u32 s61, s61, 4096
    s_waitcnt lgkmcnt(4)
    v_mfma_f32_16x16x32_bf16 v[140:143], v[104:107], v[60:63], v[140:143]
    ds_read_b128 v[92:95], v3 offset:45056
    s_waitcnt lgkmcnt(4)
    v_mfma_f32_16x16x32_bf16 v[144:147], v[108:111], v[60:63], v[144:147]
    ds_read_b128 v[96:99], v4 offset:0
    s_waitcnt vmcnt(5)
    s_waitcnt lgkmcnt(4)
    v_mfma_f32_16x16x32_bf16 v[128:131], v[80:83], v[64:67], v[128:131]
    ds_read_b128 v[100:103], v2 offset:50176
    s_waitcnt lgkmcnt(4)
    v_mfma_f32_16x16x32_bf16 v[132:135], v[84:87], v[64:67], v[132:135]
    ds_read_b128 v[104:107], v3 offset:5120
    s_waitcnt lgkmcnt(4)
    v_mfma_f32_16x16x32_bf16 v[136:139], v[88:91], v[64:67], v[136:139]
    ds_read_b128 v[108:111], v3 offset:25600
    s_mov_b32 m0, s60
    s_nop 0
    buffer_load_dwordx4 v1, s[4:7], s61 offen offset:0 sc1 lds
    s_add_u32 s60, s60, 1024
    s_add_u32 s61, s61, 1024
    s_waitcnt lgkmcnt(4)
    v_mfma_f32_16x16x32_bf16 v[140:143], v[92:95], v[64:67], v[140:143]
    ds_read_b128 v[80:83], v3 offset:46080
    s_waitcnt lgkmcnt(4)
    v_mfma_f32_16x16x32_bf16 v[144:147], v[96:99], v[64:67], v[144:147]
    ds_read_b128 v[84:87], v4 offset:1024
    s_waitcnt vmcnt(5)
    s_waitcnt lgkmcnt(4)
    v_mfma_f32_16x16x32_bf16 v[128:131], v[100:103], v[68:71], v[128:131]
    s_waitcnt lgkmcnt(3)
    v_mfma_f32_16x16x32_bf16 v[132:135], v[104:107], v[68:71], v[132:135]
    s_waitcnt lgkmcnt(2)
    v_mfma_f32_16x16x32_bf16 v[136:139], v[108:111], v[68:71], v[136:139]
    s_waitcnt lgkmcnt(1)
    v_mfma_f32_16x16x32_bf16 v[140:143], v[80:83], v[68:71], v[140:143]
    s_waitcnt lgkmcnt(0)
    v_mfma_f32_16x16x32_bf16 v[144:147], v[84:87], v[68:71], v[144:147]
    s_mul_i32 s45, s43, 5120
    s_add_u32 s45, s45, 143360
    v_add_u32 v8, s45, v1
    s_cmp_lg_u32 s44, 0
    s_cbranch_scc1 L_kh1_106
    s_nop 0
    ds_write_b128 v8, v[140:143] offset:3072
    s_nop 0
    ds_write_b128 v8, v[144:147] offset:4096
    s_branch L_khj_107
L_kh1_106:
    s_nop 7
    ds_write_b128 v8, v[128:131] offset:0
    ds_write_b128 v8, v[132:135] offset:1024
    ds_write_b128 v8, v[136:139] offset:2048
L_khj_107:
    s_bfe_u32 s25, s2, 0x40003
    s_mul_i32 s26, s25, 7
    s_mul_i32 s27, s25, 6
    s_add_u32 s27, s27, 12
    s_cmp_lt_u32 s25, 12
    s_cselect_b32 s25, s26, s27
    s_mul_i32 s25, s25, 20480
    s_add_u32 s25, s25, 11534336
    s_mul_i32 s50, s3, 3219
    s_lshr_b32 s50, s50, 8
    s_min_u32 s50, s50, 87
    s_add_u32 s50, s50, 40
    s_lshl_b32 s50, s50, 10
    s_add_u32 s51, s25, s50
    s_waitcnt lgkmcnt(0)
    s_barrier
    s_cmp_lg_u32 s44, 0
    s_cbranch_scc1 L_kh1b_108
    s_mov_b32 m0, s50
    s_nop 0
    buffer_load_dwordx4 v1, s[4:7], s51 offen offset:0 sc1 lds
    ds_read_b128 v[80:83], v8 offset:0
    ds_read_b128 v[84:87], v8 offset:1024
    ds_read_b128 v[88:91], v8 offset:2048
    buffer_load_dwordx4 v1, s[4:7], s51 offen offset:1024 sc1 lds
    s_waitcnt lgkmcnt(0)
    v_pk_add_f32 v[128:129], v[128:129], v[80:81]
    v_pk_add_f32 v[130:131], v[130:131], v[82:83]
    buffer_load_dwordx4 v1, s[4:7], s51 offen offset:2048 sc1 lds
    v_pk_add_f32 v[132:133], v[132:133], v[84:85]
    v_pk_add_f32 v[134:135], v[134:135], v[86:87]
    v_pk_add_f32 v[136:137], v[136:137], v[88:89]
    buffer_load_dwordx4 v1, s[4:7], s51 offen offset:3072 sc1 lds
    s_add_u32 s50, s50, 4096
    s_add_u32 s51, s51, 4096
    v_pk_add_f32 v[138:139], v[138:139], v[90:91]
    v_mov_b32 v24, 0
    v_mov_b32 v25, 0
    s_mov_b32 m0, s50
    s_nop 0
    buffer_load_dwordx4 v1, s[4:7], s51 offen offset:0 sc1 lds
    v_lshlrev_b32 v8, 16, v112
    v_and_b32 v9, 0xffff0000, v112
    v_add_f32 v128, v128, v8
    buffer_load_dwordx4 v1, s[4:7], s51 offen offset:1024 sc1 lds
    v_add_f32 v129, v129, v9
    v_lshlrev_b32 v8, 16, v113
    v_and_b32 v9, 0xffff0000, v113
    buffer_load_dwordx4 v1, s[4:7], s51 offen offset:2048 sc1 lds
    v_add_f32 v130, v130, v8
    v_add_f32 v131, v131, v9
    v_lshlrev_b32 v8, 16, v114
    buffer_load_dwordx4 v1, s[4:7], s51 offen offset:3072 sc1 lds
    s_add_u32 s50, s50, 4096
    s_add_u32 s51, s51, 4096
    v_and_b32 v9, 0xffff0000, v114
    v_add_f32 v132, v132, v8
    v_add_f32 v133, v133, v9
    s_mov_b32 m0, s50
    s_nop 0
    buffer_load_dwordx4 v1, s[4:7], s51 offen offset:0 sc1 lds
    v_lshlrev_b32 v8, 16, v115
    v_and_b32 v9, 0xffff0000, v115
    v_add_f32 v134, v134, v8
    buffer_load_dwordx4 v1, s[4:7], s51 offen offset:1024 sc1 lds
    v_add_f32 v135, v135, v9
    v_lshlrev_b32 v8, 16, v116
    v_and_b32 v9, 0xffff0000, v116
    buffer_load_dwordx4 v1, s[4:7], s51 offen offset:2048 sc1 lds
    v_add_f32 v136, v136, v8
    v_add_f32 v137, v137, v9
    v_lshlrev_b32 v8, 16, v117
    buffer_load_dwordx4 v1, s[4:7], s51 offen offset:3072 sc1 lds
    s_add_u32 s50, s50, 4096
    s_add_u32 s51, s51, 4096
    v_and_b32 v9, 0xffff0000, v117
    v_add_f32 v138, v138, v8
    v_add_f32 v139, v139, v9
    s_mov_b32 m0, s50
    s_nop 0
    buffer_load_dwordx4 v1, s[4:7], s51 offen offset:0 sc1 lds
    s_add_u32 s50, s50, 1024
    s_add_u32 s51, s51, 1024
    v_cvt_pk_bf16_f32 v16, v128, v129
    v_cvt_pk_bf16_f32 v17, v130, v131
    buffer_store_dwordx2 v[16:17], v7, s[4:7], s55 offen offset:0 sc1
    v_lshlrev_b32 v8, 16, v16
    v_and_b32 v9, 0xffff0000, v16
    v_add_f32 v24, v24, v8
    v_fmac_f32 v25, v8, v8
    v_add_f32 v24, v24, v9
    v_fmac_f32 v25, v9, v9
    v_lshlrev_b32 v8, 16, v17
    v_and_b32 v9, 0xffff0000, v17
    v_add_f32 v24, v24, v8
    v_fmac_f32 v25, v8, v8
    v_add_f32 v24, v24, v9
    v_fmac_f32 v25, v9, v9
    v_cvt_pk_bf16_f32 v18, v132, v133
    v_cvt_pk_bf16_f32 v19, v134, v135
    buffer_store_dwordx2 v[18:19], v7, s[4:7], s55 offen offset:512 sc1
    v_lshlrev_b32 v8, 16, v18
    v_and_b32 v9, 0xffff0000, v18
    v_add_f32 v24, v24, v8
    v_fmac_f32 v25, v8, v8
    v_add_f32 v24, v24, v9
    v_fmac_f32 v25, v9, v9
    v_lshlrev_b32 v8, 16, v19
    v_and_b32 v9, 0xffff0000, v19
    v_add_f32 v24, v24, v8
    v_fmac_f32 v25, v8, v8
    v_add_f32 v24, v24, v9
    v_fmac_f32 v25, v9, v9
    v_cvt_pk_bf16_f32 v20, v136, v137
    v_cvt_pk_bf16_f32 v21, v138, v139
    buffer_store_dwordx2 v[20:21], v7, s[4:7], s55 offen offset:1024 sc1
    v_lshlrev_b32 v8, 16, v20
    v_and_b32 v9, 0xffff0000, v20
    v_add_f32 v24, v24, v8
    v_fmac_f32 v25, v8, v8
    v_add_f32 v24, v24, v9
    v_fmac_f32 v25, v9, v9
    v_lshlrev_b32 v8, 16, v21
    v_and_b32 v9, 0xffff0000, v21
    v_add_f32 v24, v24, v8
    v_fmac_f32 v25, v8, v8
    v_add_f32 v24, v24, v9
    v_fmac_f32 v25, v9, v9
    v_mov_b32 v27, v24
    s_nop 1
    v_permlane16_swap_b32 v24, v27
    v_add_f32 v24, v24, v27
    v_mov_b32 v27, v24
    s_nop 1
    v_permlane32_swap_b32 v24, v27
    v_add_f32 v24, v24, v27
    v_mov_b32 v27, v25
    s_nop 1
    v_permlane16_swap_b32 v25, v27
    v_add_f32 v25, v25, v27
    v_mov_b32 v27, v25
    s_nop 1
    v_permlane32_swap_b32 v25, v27
    v_add_f32 v25, v25, v27
    s_mov_b64 exec, 0xffff
    buffer_store_dwordx2 v[24:25], v26, s[4:7], s57 offen sc1
    s_mov_b64 exec, -1
    s_branch L_khe_109
L_kh1b_108:
    s_mov_b32 m0, s50
    s_nop 0
    buffer_load_dwordx4 v1, s[4:7], s51 offen offset:0 sc1 lds
    ds_read_b128 v[92:95], v8 offset:3072
    ds_read_b128 v[96:99], v8 offset:4096
    s_waitcnt lgkmcnt(0)
    buffer_load_dwordx4 v1, s[4:7], s51 offen offset:1024 sc1 lds
    v_pk_add_f32 v[140:141], v[140:141], v[92:93]
    v_pk_add_f32 v[142:143], v[142:143], v[94:95]
    buffer_load_dwordx4 v1, s[4:7], s51 offen offset:2048 sc1 lds
    v_pk_add_f32 v[144:145], v[144:145], v[96:97]
    v_pk_add_f32 v[146:147], v[146:147], v[98:99]
    buffer_load_dwordx4 v1, s[4:7], s51 offen offset:3072 sc1 lds
    s_add_u32 s50, s50, 4096
    s_add_u32 s51, s51, 4096
    v_mov_b32 v24, 0
    v_mov_b32 v25, 0
    s_mov_b32 m0, s50
    s_nop 0
    buffer_load_dwordx4 v1, s[4:7], s51 offen offset:0 sc1 lds
    v_lshlrev_b32 v8, 16, v112
    v_and_b32 v9, 0xffff0000, v112
    buffer_load_dwordx4 v1, s[4:7], s51 offen offset:1024 sc1 lds
    v_add_f32 v140, v140, v8
    v_add_f32 v141, v141, v9
    buffer_load_dwordx4 v1, s[4:7], s51 offen offset:2048 sc1 lds
    v_lshlrev_b32 v8, 16, v113
    v_and_b32 v9, 0xffff0000, v113
    buffer_load_dwordx4 v1, s[4:7], s51 offen offset:3072 sc1 lds
    s_add_u32 s50, s50, 4096
    s_add_u32 s51, s51, 4096
    v_add_f32 v142, v142, v8
    v_add_f32 v143, v143, v9
    s_mov_b32 m0, s50
    s_nop 0
    buffer_load_dwordx4 v1, s[4:7], s51 offen offset:0 sc1 lds
    v_lshlrev_b32 v8, 16, v114
    v_and_b32 v9, 0xffff0000, v114
    buffer_load_dwordx4 v1, s[4:7], s51 offen offset:1024 sc1 lds
    v_add_f32 v144, v144, v8
    v_add_f32 v145, v145, v9
    buffer_load_dwordx4 v1, s[4:7], s51 offen offset:2048 sc1 lds
    v_lshlrev_b32 v8, 16, v115
    v_and_b32 v9, 0xffff0000, v115
    buffer_load_dwordx4 v1, s[4:7], s51 offen offset:3072 sc1 lds
    s_add_u32 s50, s50, 4096
    s_add_u32 s51, s51, 4096
    v_add_f32 v146, v146, v8
    v_add_f32 v147, v147, v9
    s_mov_b32 m0, s50
    s_nop 0
    buffer_load_dwordx4 v1, s[4:7], s51 offen offset:0 sc1 lds
    s_add_u32 s50, s50, 1024
    s_add_u32 s51, s51, 1024
    v_cvt_pk_bf16_f32 v16, v140, v141
    v_cvt_pk_bf16_f32 v17, v142, v143
    buffer_store_dwordx2 v[16:17], v7, s[4:7], s55 offen offset:1536 sc1
    v_lshlrev_b32 v8, 16, v16
    v_and_b32 v9, 0xffff0000, v16
    v_add_f32 v24, v24, v8
    v_fmac_f32 v25, v8, v8
    v_add_f32 v24, v24, v9
    v_fmac_f32 v25, v9, v9
    v_lshlrev_b32 v8, 16, v17
    v_and_b32 v9, 0xffff0000, v17
    v_add_f32 v24, v24, v8
    v_fmac_f32 v25, v8, v8
    v_add_f32 v24, v24, v9
    v_fmac_f32 v25, v9, v9
    v_cvt_pk_bf16_f32 v18, v144, v145
    v_cvt_pk_bf16_f32 v19, v146, v147
    buffer_store_dwordx2 v[18:19], v7, s[4:7], s55 offen offset:2048 sc1
    v_lshlrev_b32 v8, 16, v18
    v_and_b32 v9, 0xffff0000, v18
    v_add_f32 v24, v24, v8
    v_fmac_f32 v25, v8, v8
    v_add_f32 v24, v24, v9
    v_fmac_f32 v25, v9, v9
    v_lshlrev_b32 v8, 16, v19
    v_and_b32 v9, 0xffff0000, v19
    v_add_f32 v24, v24, v8
    v_fmac_f32 v25, v8, v8
    v_add_f32 v24, v24, v9
    v_fmac_f32 v25, v9, v9
    v_mov_b32 v27, v24
    s_nop 1
    v_permlane16_swap_b32 v24, v27
    v_add_f32 v24, v24, v27
    v_mov_b32 v27, v24
    s_nop 1
    v_permlane32_swap_b32 v24, v27
    v_add_f32 v24, v24, v27
    v_mov_b32 v27, v25
    s_nop 1
    v_permlane16_swap_b32 v25, v27
    v_add_f32 v25, v25, v27
    v_mov_b32 v27, v25
    s_nop 1
    v_permlane32_swap_b32 v25, v27
    v_add_f32 v25, v25, v27
    s_mov_b64 exec, 0xffff
    buffer_store_dwordx2 v[24:25], v26, s[4:7], s57 offen sc1
    s_mov_b64 exec, -1
L_khe_109:
    s_lshl_b32 s89, s41, 3
    s_add_u32 s89, s89, s42
    s_lshl_b32 s89, s89, 2
    s_add_u32 s89, s89, 50176
    s_and_b32 s45, s2, 7
    s_lshr_b32 s46, s2, 3
    s_lshl_b32 s45, s45, 1
    s_lshr_b32 s41, s46, 4
    s_add_u32 s41, s41, s45
    s_and_b32 s42, s46, 15
    s_mul_i32 s43, s42, 7
    s_mul_i32 s44, s42, 6
    s_add_u32 s44, s44, 12
    s_cmp_lt_u32 s42, 12
    s_cselect_b32 s43, s43, s44
    s_lshl_b32 s49, s41, 3
    s_add_u32 s49, s49, s3
    v_lshlrev_b32 v1, 4, v0
    v_mov_b32 v2, v1
    v_add_u32 v3, 0x10000, v1
    v_add_u32 v4, 0x20000, v1
    s_mul_i32 s45, s49, 20480
    s_add_u32 s45, s45, 60817408
    v_add_u32 v5, s45, v1
    v_and_b32 v6, 15, v0
    v_lshlrev_b32 v6, 3, v6
    v_lshrrev_b32 v9, 4, v0
    v_lshlrev_b32 v9, 9, v9
    v_add_u32 v6, v6, v9
    s_mul_i32 s56, s49, 2048
    s_add_u32 s56, s56, 70516736
    v_mov_b32 v236, 0x3f803f80
    v_mov_b32 v237, 0x3f803f80
    v_mov_b32 v238, 0x3f803f80
    v_mov_b32 v239, 0x3f803f80
    v_mov_b32 v28, 0xc0135761
    v_mov_b32 v29, 0xbdd2d3e8
    v_lshrrev_b32 v7, 5, v0
    v_lshlrev_b32 v7, 8, v7
    v_and_b32 v30, 15, v0
    v_lshlrev_b32 v30, 4, v30
    v_add_u32 v7, v7, v30
    v_bfe_u32 v30, v0, 4, 1
    v_lshlrev_b32 v30, 3, v30
    v_add_u32 v7, v7, v30
    s_mul_i32 s45, s49, 55296
    v_add_u32 v7, s45, v7
    s_lshl_b32 s55, s43, 9
    s_add_u32 s55, s55, 63438848
    s_waitcnt vmcnt(0)
    s_barrier
    s_cmp_eq_u32 s3, 0
    s_cbranch_scc1 L_b0_110
    s_cmp_eq_u32 s3, 0
    s_cbranch_scc1 L_cs_112
    s_sub_u32 s45, s3, 1
    s_mul_i32 s46, s45, 20480
    v_add_u32 v10, s46, v1
    ds_read_b128 v[80:83], v10 offset:0
    ds_read_b128 v[84:87], v10 offset:1024
    ds_read_b128 v[88:91], v10 offset:2048
    ds_read_b128 v[92:95], v10 offset:3072
    ds_read_b128 v[96:99], v10 offset:4096
    ds_read_b128 v[100:103], v10 offset:5120
    ds_read_b128 v[104:107], v10 offset:6144
    ds_read_b128 v[108:111], v10 offset:7168
    s_waitcnt lgkmcnt(0)
    v_mfma_f32_16x16x32_bf16 v[208:211], v[80:83], v[236:239], 0
    v_mfma_f32_16x16x32_bf16 v[208:211], v[84:87], v[236:239], v[208:211]
    v_mfma_f32_16x16x32_bf16 v[208:211], v[88:91], v[236:239], v[208:211]
    v_mfma_f32_16x16x32_bf16 v[208:211], v[92:95], v[236:239], v[208:211]
    v_mfma_f32_16x16x32_bf16 v[208:211], v[96:99], v[236:239], v[208:211]
    v_mfma_f32_16x16x32_bf16 v[208:211], v[100:103], v[236:239], v[208:211]
    v_mfma_f32_16x16x32_bf16 v[208:211], v[104:107], v[236:239], v[208:211]
    v_mfma_f32_16x16x32_bf16 v[208:211], v[108:111], v[236:239], v[208:211]
    ds_read_b128 v[80:83], v10 offset:8192
    ds_read_b128 v[84:87], v10 offset:9216
    ds_read_b128 v[88:91], v10 offset:10240
    ds_read_b128 v[92:95], v10 offset:11264
    ds_read_b128 v[96:99], v10 offset:12288
    ds_read_b128 v[100:103], v10 offset:13312
    ds_read_b128 v[104:107], v10 offset:14336
    ds_read_b128 v[108:111], v10 offset:15360
    s_waitcnt lgkmcnt(0)
    v_mfma_f32_16x16x32_bf16 v[208:211], v[80:83], v[236:239], v[208:211]
    v_mfma_f32_16x16x32_bf16 v[208:211], v[84:87], v[236:239], v[208:211]
    v_mfma_f32_16x16x32_bf16 v[208:211], v[88:91], v[236:239], v[208:211]
    v_mfma_f32_16x16x32_bf16 v[208:211], v[92:95], v[236:239], v[208:211]
    v_mfma_f32_16x16x32_bf16 v[208:211], v[96:99], v[236:239], v[208:211]
    v_mfma_f32_16x16x32_bf16 v[208:211], v[100:103], v[236:239], v[208:211]
    v_mfma_f32_16x16x32_bf16 v[208:211], v[104:107], v[236:239], v[208:211]
    v_mfma_f32_16x16x32_bf16 v[208:211], v[108:111], v[236:239], v[208:211]
    ds_read_b128 v[80:83], v10 offset:16384
    ds_read_b128 v[84:87], v10 offset:17408
    ds_read_b128 v[88:91], v10 offset:18432
    ds_read_b128 v[92:95], v10 offset:19456
    s_waitcnt lgkmcnt(0)
    v_mfma_f32_16x16x32_bf16 v[208:211], v[80:83], v[236:239], v[208:211]
    v_mfma_f32_16x16x32_bf16 v[208:211], v[84:87], v[236:239], v[208:211]
    v_mfma_f32_16x16x32_bf16 v[208:211], v[88:91], v[236:239], v[208:211]
    v_mfma_f32_16x16x32_bf16 v[208:211], v[92:95], v[236:239], v[208:211]
    s_lshl_b32 s45, s45, 10
    s_add_u32 s45, s45, 147456
    v_add_u32 v10, s45, v1
    s_nop 7
    ds_write_b128 v10, v[208:211]
    s_waitcnt lgkmcnt(0)
L_cs_112:
    s_branch L_b1_111
L_b0_110:
    v_mov_b32 v250, s24
    v_mov_b32 v251, 0
    s_mov_b64 exec, 1
    s_cmp_eq_u32 s29, 0
    s_cbranch_scc1 L_fl_113
    buffer_store_dword v250, v251, s[4:7], s89 offen
    s_branch L_fj_114
L_fl_113:
    buffer_atomic_swap v250, v251, s[4:7], s89 offen
L_fj_114:
    s_mov_b64 exec, -1
    s_lshl_b32 s59, s41, 6
    s_add_u32 s59, s59, 50176
    v_lshlrev_b32 v251, 2, v0
    s_mov_b32 s58, 0
    s_mov_b32 s60, 0xffff
    s_mov_b32 s61, 0x0
    s_mov_b64 exec, s[60:61]
L_poll_115:
    buffer_load_dword v252, v251, s[4:7], s59 offen sc1
    s_waitcnt vmcnt(0)
    v_cmp_ne_u32 vcc, s24, v252
    s_nop 1
    s_and_b64 vcc, vcc, s[60:61]
    s_cbranch_scc0 L_polld_116
    s_sleep 1
    s_add_u32 s58, s58, 1
    s_cmp_lt_u32 s58, 32768
    s_cbranch_scc1 L_poll_115
    s_load_dwordx2 s[20:21], s[0:1], 104
    s_waitcnt lgkmcnt(0)
    s_and_b32 s21, s21, 0xffff
    s_mov_b32 s22, 256
    s_mov_b32 s23, 0x20000
    v_mov_b32 v253, 0xdead000a
    v_mov_b32 v251, 44
    s_mov_b64 exec, 1
    buffer_store_dword v253, v251, s[20:23], 0 offen
L_polld_116:
    s_mov_b64 exec, -1
L_b1_111:
    s_waitcnt vmcnt(0)
    s_barrier
    s_mov_b32 s54, 0
    buffer_load_dwordx4 v[32:35], v5, s[4:7], s54 offen sc1
    s_mov_b32 s54, 1024
    buffer_load_dwordx4 v[36:39], v5, s[4:7], s54 offen sc1
    s_mov_b32 s54, 2048
    buffer_load_dwordx4 v[40:43], v5, s[4:7], s54 offen sc1
    s_mov_b32 s54, 3072
    buffer_load_dwordx4 v[44:47], v5, s[4:7], s54 offen sc1
    s_mov_b32 s54, 4096
    buffer_load_dwordx4 v[48:51], v5, s[4:7], s54 offen sc1
    buffer_load_dwordx2 v[112:113], v6, s[4:7], s56 offen offset:0 sc1
    buffer_load_dwordx2 v[114:115], v6, s[4:7], s56 offen offset:128 sc1
    buffer_load_dwordx2 v[116:117], v6, s[4:7], s56 offen offset:256 sc1
    buffer_load_dwordx2 v[118:119], v6, s[4:7], s56 offen offset:384 sc1
    v_add_u32 v10, 147456, v1
    ds_read_b128 v[208:211], v10 offset:0
    ds_read_b128 v[212:215], v10 offset:1024
    ds_read_b128 v[216:219], v10 offset:2048
    ds_read_b128 v[220:223], v10 offset:3072
    ds_read_b128 v[224:227], v10 offset:4096
    ds_read_b128 v[228:231], v10 offset:5120
    ds_read_b128 v[232:235], v10 offset:6144
    ds_read_b128 v[80:83], v2 offset:0
    ds_read_b128 v[84:87], v2 offset:20480
    ds_read_b128 v[88:91], v2 offset:40960
    ds_read_b128 v[92:95], v2 offset:61440
    ds_read_b128 v[96:99], v3 offset:16384
    s_mov_b32 s54, 5120
    buffer_load_dwordx4 v[52:55], v5, s[4:7], s54 offen sc1
    s_waitcnt vmcnt(9)
    s_waitcnt lgkmcnt(4)
    v_mfma_f32_16x16x32_bf16 v[128:131], v[80:83], v[32:35], 0
    ds_read_b128 v[100:103], v3 offset:36864
    s_waitcnt lgkmcnt(4)
    v_mfma_f32_16x16x32_bf16 v[132:135], v[84:87], v[32:35], 0
    ds_read_b128 v[104:107], v3 offset:57344
    s_waitcnt lgkmcnt(4)
    v_mfma_f32_16x16x32_bf16 v[136:139], v[88:91], v[32:35], 0
    ds_read_b128 v[108:111], v2 offset:1024
    s_waitcnt lgkmcnt(4)
    v_mfma_f32_16x16x32_bf16 v[140:143], v[92:95], v[32:35], 0
    ds_read_b128 v[80:83], v2 offset:21504
    s_waitcnt lgkmcnt(4)
    v_mfma_f32_16x16x32_bf16 v[144:147], v[96:99], v[32:35], 0
    ds_read_b128 v[84:87], v2 offset:41984
    s_waitcnt lgkmcnt(4)
    v_mfma_f32_16x16x32_bf16 v[148:151], v[100:103], v[32:35], 0
    ds_read_b128 v[88:91], v2 offset:62464
    s_waitcnt lgkmcnt(4)
    v_mfma_f32_16x16x32_bf16 v[152:155], v[104:107], v[32:35], 0
    ds_read_b128 v[92:95], v3 offset:17408
    s_mov_b32 s54, 6144
    buffer_load_dwordx4 v[56:59], v5, s[4:7], s54 offen sc1
    s_waitcnt vmcnt(9)
    s_waitcnt lgkmcnt(4)
    v_mfma_f32_16x16x32_bf16 v[128:131], v[108:111], v[36:39], v[128:131]
    ds_read_b128 v[96:99], v3 offset:37888
    s_waitcnt lgkmcnt(4)
    v_mfma_f32_16x16x32_bf16 v[132:135], v[80:83], v[36:39], v[132:135]
    ds_read_b128 v[100:103], v3 offset:58368
    s_waitcnt lgkmcnt(4)
    v_mfma_f32_16x16x32_bf16 v[136:139], v[84:87], v[36:39], v[136:139]
    ds_read_b128 v[104:107], v2 offset:2048
    s_waitcnt lgkmcnt(4)
    v_mfma_f32_16x16x32_bf16 v[140:143], v[88:91], v[36:39], v[140:143]
    ds_read_b128 v[108:111], v2 offset:22528
    s_waitcnt lgkmcnt(4)
    v_mfma_f32_16x16x32_bf16 v[144:147], v[92:95], v[36:39], v[144:147]
    ds_read_b128 v[80:83], v2 offset:43008
    s_waitcnt lgkmcnt(4)
    v_mfma_f32_16x16x32_bf16 v[148:151], v[96:99], v[36:39], v[148:151]
    ds_read_b128 v[84:87], v2 offset:63488
    s_waitcnt lgkmcnt(4)
    v_mfma_f32_16x16x32_bf16 v[152:155], v[100:103], v[36:39], v[152:155]
    ds_read_b128 v[88:91], v3 offset:18432
    s_mov_b32 s54, 7168
    buffer_load_dwordx4 v[60:63], v5, s[4:7], s54 offen sc1
    s_waitcnt vmcnt(9)
    s_waitcnt lgkmcnt(4)
    v_mfma_f32_16x16x32_bf16 v[128:131], v[104:107], v[40:43], v[128:131]
    ds_read_b128 v[92:95], v3 offset:38912
    s_waitcnt lgkmcnt(4)
    v_mfma_f32_16x16x32_bf16 v[132:135], v[108:111], v[40:43], v[132:135]
    ds_read_b128 v[96:99], v3 offset:59392
    s_waitcnt lgkmcnt(4)
    v_mfma_f32_16x16x32_bf16 v[136:139], v[80:83], v[40:43], v[136:139]
    ds_read_b128 v[100:103], v2 offset:3072
    s_waitcnt lgkmcnt(4)
    v_mfma_f32_16x16x32_bf16 v[140:143], v[84:87], v[40:43], v[140:143]
    ds_read_b128 v[104:107], v2 offset:23552
    s_waitcnt lgkmcnt(4)
    v_mfma_f32_16x16x32_bf16 v[144:147], v[88:91], v[40:43], v[144:147]
    ds_read_b128 v[108:111], v2 offset:44032
    s_waitcnt lgkmcnt(4)
    v_mfma_f32_16x16x32_bf16 v[148:151], v[92:95], v[40:43], v[148:151]
    ds_read_b128 v[80:83], v2 offset:64512
    s_waitcnt lgkmcnt(4)
    v_mfma_f32_16x16x32_bf16 v[152:155], v[96:99], v[40:43], v[152:155]
    ds_read_b128 v[84:87], v3 offset:19456
    s_mov_b32 s54, 8192
    buffer_load_dwordx4 v[64:67], v5, s[4:7], s54 offen sc1
    s_waitcnt vmcnt(9)
    s_waitcnt lgkmcnt(4)
    v_mfma_f32_16x16x32_bf16 v[128:131], v[100:103], v[44:47], v[128:131]
    ds_read_b128 v[88:91], v3 offset:39936
    s_waitcnt lgkmcnt(4)
    v_mfma_f32_16x16x32_bf16 v[132:135], v[104:107], v[44:47], v[132:135]
    ds_read_b128 v[92:95], v3 offset:60416
    s_waitcnt lgkmcnt(4)
    v_mfma_f32_16x16x32_bf16 v[136:139], v[108:111], v[44:47], v[136:139]
    ds_read_b128 v[96:99], v2 offset:4096
    s_waitcnt lgkmcnt(4)
    v_mfma_f32_16x16x32_bf16 v[140:143], v[80:83], v[44:47], v[140:143]
    ds_read_b128 v[100:103], v2 offset:24576
    s_waitcnt lgkmcnt(4)
    v_mfma_f32_16x16x32_bf16 v[144:147], v[84:87], v[44:47], v[144:147]
    ds_read_b128 v[104:107], v2 offset:45056
    s_waitcnt lgkmcnt(4)
    v_mfma_f32_16x16x32_bf16 v[148:151], v[88:91], v[44:47], v[148:151]
    ds_read_b128 v[108:111], v3 offset:0
    s_waitcnt lgkmcnt(4)
    v_mfma_f32_16x16x32_bf16 v[152:155], v[92:95], v[44:47], v[152:155]
    ds_read_b128 v[80:83], v3 offset:20480
    s_mov_b32 s54, 9216
    buffer_load_dwordx4 v[68:71], v5, s[4:7], s54 offen sc1
    s_waitcnt vmcnt(9)
    s_waitcnt lgkmcnt(4)
    v_mfma_f32_16x16x32_bf16 v[128:131], v[96:99], v[48:51], v[128:131]
    ds_read_b128 v[84:87], v3 offset:40960
    s_waitcnt lgkmcnt(4)
    v_mfma_f32_16x16x32_bf16 v[132:135], v[100:103], v[48:51], v[132:135]
    ds_read_b128 v[88:91], v3 offset:61440
    s_waitcnt lgkmcnt(4)
    v_mfma_f32_16x16x32_bf16 v[136:139], v[104:107], v[48:51], v[136:139]
    ds_read_b128 v[92:95], v2 offset:5120
    s_waitcnt lgkmcnt(4)
    v_mfma_f32_16x16x32_bf16 v[140:143], v[108:111], v[48:51], v[140:143]
    ds_read_b128 v[96:99], v2 offset:25600
    s_waitcnt lgkmcnt(4)
    v_mfma_f32_16x16x32_bf16 v[144:147], v[80:83], v[48:51], v[144:147]
    ds_read_b128 v[100:103], v2 offset:46080
    s_waitcnt lgkmcnt(4)
    v_mfma_f32_16x16x32_bf16 v[148:151], v[84:87], v[48:51], v[148:151]
    ds_read_b128 v[104:107], v3 offset:1024
    s_waitcnt lgkmcnt(4)
    v_mfma_f32_16x16x32_bf16 v[152:155], v[88:91], v[48:51], v[152:155]
    ds_read_b128 v[108:111], v3 offset:21504
    s_mov_b32 s54, 10240
    buffer_load_dwordx4 v[72:75], v5, s[4:7], s54 offen sc1
    s_waitcnt vmcnt(5)
    s_waitcnt lgkmcnt(4)
    v_mfma_f32_16x16x32_bf16 v[128:131], v[92:95], v[52:55], v[128:131]
    ds_read_b128 v[80:83], v3 offset:41984
    s_waitcnt lgkmcnt(4)
    v_mfma_f32_16x16x32_bf16 v[132:135], v[96:99], v[52:55], v[132:135]
    ds_read_b128 v[84:87], v3 offset:62464
    s_waitcnt lgkmcnt(4)
    v_mfma_f32_16x16x32_bf16 v[136:139], v[100:103], v[52:55], v[136:139]
    ds_read_b128 v[88:91], v2 offset:6144
    s_waitcnt lgkmcnt(4)
    v_mfma_f32_16x16x32_bf16 v[140:143], v[104:107], v[52:55], v[140:143]
    ds_read_b128 v[92:95], v2 offset:26624
    s_waitcnt lgkmcnt(4)
    v_mfma_f32_16x16x32_bf16 v[144:147], v[108:111], v[52:55], v[144:147]
    ds_read_b128 v[96:99], v2 offset:47104
    s_waitcnt lgkmcnt(4)
    v_mfma_f32_16x16x32_bf16 v[148:151], v[80:83], v[52:55], v[148:151]
    ds_read_b128 v[100:103], v3 offset:2048
    s_waitcnt lgkmcnt(4)
    v_mfma_f32_16x16x32_bf16 v[152:155], v[84:87], v[52:55], v[152:155]
    ds_read_b128 v[104:107], v3 offset:22528
    s_mov_b32 s54, 11264
    buffer_load_dwordx4 v[76:79], v5, s[4:7], s54 offen sc1
    s_waitcnt vmcnt(5)
    s_waitcnt lgkmcnt(4)
    v_mfma_f32_16x16x32_bf16 v[128:131], v[88:91], v[56:59], v[128:131]
    ds_read_b128 v[108:111], v3 offset:43008
    s_waitcnt lgkmcnt(4)
    v_mfma_f32_16x16x32_bf16 v[132:135], v[92:95], v[56:59], v[132:135]
    ds_read_b128 v[80:83], v3 offset:63488
    s_waitcnt lgkmcnt(4)
    v_mfma_f32_16x16x32_bf16 v[136:139], v[96:99], v[56:59], v[136:139]
    ds_read_b128 v[84:87], v2 offset:7168
    s_waitcnt lgkmcnt(4)
    v_mfma_f32_16x16x32_bf16 v[140:143], v[100:103], v[56:59], v[140:143]
    ds_read_b128 v[88:91], v2 offset:27648
    s_waitcnt lgkmcnt(4)
    v_mfma_f32_16x16x32_bf16 v[144:147], v[104:107], v[56:59], v[144:147]
    ds_read_b128 v[92:95], v2 offset:48128
    s_waitcnt lgkmcnt(4)
    v_mfma_f32_16x16x32_bf16 v[148:151], v[108:111], v[56:59], v[148:151]
    ds_read_b128 v[96:99], v3 offset:3072
    s_waitcnt lgkmcnt(4)
    v_mfma_f32_16x16x32_bf16 v[152:155], v[80:83], v[56:59], v[152:155]
    ds_read_b128 v[100:103], v3 offset:23552
    s_mov_b32 s54, 12288
    buffer_load_dwordx4 v[32:35], v5, s[4:7], s54 offen sc1
    s_waitcnt vmcnt(5)
    s_waitcnt lgkmcnt(4)
    v_mfma_f32_16x16x32_bf16 v[128:131], v[84:87], v[60:63], v[128:131]
    ds_read_b128 v[104:107], v3 offset:44032
    s_waitcnt lgkmcnt(4)
    v_mfma_f32_16x16x32_bf16 v[132:135], v[88:91], v[60:63], v[132:135]
    ds_read_b128 v[108:111], v3 offset:64512
    s_waitcnt lgkmcnt(4)
    v_mfma_f32_16x16x32_bf16 v[136:139], v[92:95], v[60:63], v[136:139]
    ds_read_b128 v[80:83], v2 offset:8192
    s_waitcnt lgkmcnt(4)
    v_mfma_f32_16x16x32_bf16 v[140:143], v[96:99], v[60:63], v[140:143]
    ds_read_b128 v[84:87], v2 offset:28672
    s_waitcnt lgkmcnt(4)
    v_mfma_f32_16x16x32_bf16 v[144:147], v[100:103], v[60:63], v[144:147]
    ds_read_b128 v[88:91], v2 offset:49152
    s_waitcnt lgkmcnt(4)
    v_mfma_f32_16x16x32_bf16 v[148:151], v[104:107], v[60:63], v[148:151]
    ds_read_b128 v[92:95], v3 offset:4096
    s_waitcnt lgkmcnt(4)
    v_mfma_f32_16x16x32_bf16 v[152:155], v[108:111], v[60:63], v[152:155]
    ds_read_b128 v[96:99], v3 offset:24576
    s_mov_b32 s54, 13312
    buffer_load_dwordx4 v[36:39], v5, s[4:7], s54 offen sc1
    s_waitcnt vmcnt(5)
    s_waitcnt lgkmcnt(4)
    v_mfma_f32_16x16x32_bf16 v[128:131], v[80:83], v[64:67], v[128:131]
    ds_read_b128 v[100:103], v3 offset:45056
    s_waitcnt lgkmcnt(4)
    v_mfma_f32_16x16x32_bf16 v[132:135], v[84:87], v[64:67], v[132:135]
    ds_read_b128 v[104:107], v4 offset:0
    s_waitcnt lgkmcnt(4)
    v_mfma_f32_16x16x32_bf16 v[136:139], v[88:91], v[64:67], v[136:139]
    ds_read_b128 v[108:111], v2 offset:9216
    s_waitcnt lgkmcnt(4)
    v_mfma_f32_16x16x32_bf16 v[140:143], v[92:95], v[64:67], v[140:143]
    ds_read_b128 v[80:83], v2 offset:29696
    s_waitcnt lgkmcnt(4)
    v_mfma_f32_16x16x32_bf16 v[144:147], v[96:99], v[64:67], v[144:147]
    ds_read_b128 v[84:87], v2 offset:50176
    s_waitcnt lgkmcnt(4)
    v_mfma_f32_16x16x32_bf16 v[148:151], v[100:103], v[64:67], v[148:151]
    ds_read_b128 v[88:91], v3 offset:5120
    s_waitcnt lgkmcnt(4)
    v_mfma_f32_16x16x32_bf16 v[152:155], v[104:107], v[64:67], v[152:155]
    ds_read_b128 v[92:95], v3 offset:25600
    s_mov_b32 s54, 14336
    buffer_load_dwordx4 v[40:43], v5, s[4:7], s54 offen sc1
    s_waitcnt vmcnt(5)
    s_waitcnt lgkmcnt(4)
    v_mfma_f32_16x16x32_bf16 v[128:131], v[108:111], v[68:71], v[128:131]
    ds_read_b128 v[96:99], v3 offset:46080
    v_lshlrev_b32 v1, 4, v0
    s_bfe_u32 s25, s2, 0x30003
    s_mul_i32 s25, s25, 276480
    s_add_u32 s25, s25, 14680064
    s_lshr_b32 s26, s3, 1
    s_mul_i32 s26, s26, 54
    s_and_b32 s27, s3, 1
    s_lshl_b32 s27, s27, 2
    s_add_u32 s26, s26, s27
    s_lshl_b32 s26, s26, 10
    s_add_u32 s62, s26, s25
    s_lshl_b32 s53, s3, 12
    s_lshr_b32 s26, s3, 2
    s_lshl_b32 s26, s26, 2
    s_and_b32 s27, s3, 3
    s_add_u32 s26, s26, s27
    s_add_u32 s27, s26, 216
    s_lshl_b32 s27, s27, 10
    s_add_u32 s63, s27, s25
    s_add_u32 s26, s26, 32
    s_lshl_b32 s64, s26, 10
    v_add_u32 v30, s53, v1
    v_add_u32 v31, 0x10000, v30
    v_add_u32 v26, s64, v1
    v_add_u32 v27, 0x10000, v26
    s_add_u32 s60, s62, 0
    buffer_load_dwordx4 v[156:159], v1, s[4:7], s60 offen sc1
    s_waitcnt lgkmcnt(4)
    v_mfma_f32_16x16x32_bf16 v[132:135], v[80:83], v[68:71], v[132:135]
    ds_read_b128 v[100:103], v4 offset:1024
    s_waitcnt lgkmcnt(4)
    v_mfma_f32_16x16x32_bf16 v[136:139], v[84:87], v[68:71], v[136:139]
    ds_read_b128 v[104:107], v2 offset:10240
    s_waitcnt lgkmcnt(4)
    v_mfma_f32_16x16x32_bf16 v[140:143], v[88:91], v[68:71], v[140:143]
    ds_read_b128 v[108:111], v2 offset:30720
    s_waitcnt lgkmcnt(4)
    v_mfma_f32_16x16x32_bf16 v[144:147], v[92:95], v[68:71], v[144:147]
    ds_read_b128 v[80:83], v2 offset:51200
    s_waitcnt lgkmcnt(4)
    v_mfma_f32_16x16x32_bf16 v[148:151], v[96:99], v[68:71], v[148:151]
    ds_read_b128 v[84:87], v3 offset:6144
    s_add_u32 s60, s62, 1024
    buffer_load_dwordx4 v[160:163], v1, s[4:7], s60 offen sc1
    s_waitcnt lgkmcnt(4)
    v_mfma_f32_16x16x32_bf16 v[152:155], v[100:103], v[68:71], v[152:155]
    ds_read_b128 v[88:91], v3 offset:26624
    s_mov_b32 s54, 15360
    buffer_load_dwordx4 v[44:47], v5, s[4:7], s54 offen sc1
    s_waitcnt vmcnt(7)
    s_waitcnt lgkmcnt(4)
    v_mfma_f32_16x16x32_bf16 v[128:131], v[104:107], v[72:75], v[128:131]
    ds_read_b128 v[92:95], v3 offset:47104
    s_waitcnt lgkmcnt(4)
    v_mfma_f32_16x16x32_bf16 v[132:135], v[108:111], v[72:75], v[132:135]
    ds_read_b128 v[96:99], v4 offset:2048
    s_waitcnt lgkmcnt(4)
    v_mfma_f32_16x16x32_bf16 v[136:139], v[80:83], v[72:75], v[136:139]
    ds_read_b128 v[100:103], v2 offset:11264
    s_waitcnt lgkmcnt(4)
    v_mfma_f32_16x16x32_bf16 v[140:143], v[84:87], v[72:75], v[140:143]
    ds_read_b128 v[104:107], v2 offset:31744
    s_add_u32 s60, s62, 2048
    buffer_load_dwordx4 v[164:167], v1, s[4:7], s60 offen sc1
    s_waitcnt lgkmcnt(4)
    v_mfma_f32_16x16x32_bf16 v[144:147], v[88:91], v[72:75], v[144:147]
    ds_read_b128 v[108:111], v2 offset:52224
    s_waitcnt lgkmcnt(4)
    v_mfma_f32_16x16x32_bf16 v[148:151], v[92:95], v[72:75], v[148:151]
    ds_read_b128 v[80:83], v3 offset:7168
    s_waitcnt lgkmcnt(4)
    v_mfma_f32_16x16x32_bf16 v[152:155], v[96:99], v[72:75], v[152:155]
    ds_read_b128 v[84:87], v3 offset:27648
    s_mov_b32 s54, 16384
    buffer_load_dwordx4 v[48:51], v5, s[4:7], s54 offen sc1
    s_waitcnt vmcnt(8)
    s_waitcnt lgkmcnt(4)
    v_mfma_f32_16x16x32_bf16 v[128:131], v[100:103], v[76:79], v[128:131]
    ds_read_b128 v[88:91], v3 offset:48128
    s_add_u32 s60, s62, 3072
    buffer_load_dwordx4 v[168:171], v1, s[4:7], s60 offen sc1
    s_waitcnt lgkmcnt(4)
    v_mfma_f32_16x16x32_bf16 v[132:135], v[104:107], v[76:79], v[132:135]
    ds_read_b128 v[92:95], v4 offset:3072
    s_waitcnt lgkmcnt(4)
    v_mfma_f32_16x16x32_bf16 v[136:139], v[108:111], v[76:79], v[136:139]
    ds_read_b128 v[96:99], v2 offset:12288
    s_waitcnt lgkmcnt(4)
    v_mfma_f32_16x16x32_bf16 v[140:143], v[80:83], v[76:79], v[140:143]
    ds_read_b128 v[100:103], v2 offset:32768
    s_waitcnt lgkmcnt(4)
    v_mfma_f32_16x16x32_bf16 v[144:147], v[84:87], v[76:79], v[144:147]
    ds_read_b128 v[104:107], v2 offset:53248
    s_waitcnt lgkmcnt(4)
    v_mfma_f32_16x16x32_bf16 v[148:151], v[88:91], v[76:79], v[148:151]
    ds_read_b128 v[108:111], v3 offset:8192
    s_add_u32 s60, s63, 0
    buffer_load_dwordx4 v[172:175], v1, s[4:7], s60 offen sc1
    s_waitcnt lgkmcnt(4)
    v_mfma_f32_16x16x32_bf16 v[152:155], v[92:95], v[76:79], v[152:155]
    ds_read_b128 v[80:83], v3 offset:28672
    s_mov_b32 s54, 17408
    buffer_load_dwordx4 v[52:55], v5, s[4:7], s54 offen sc1
    s_waitcnt vmcnt(10)
    s_waitcnt lgkmcnt(4)
    v_mfma_f32_16x16x32_bf16 v[128:131], v[96:99], v[32:35], v[128:131]
    ds_read_b128 v[84:87], v3 offset:49152
    s_waitcnt lgkmcnt(4)
    v_mfma_f32_16x16x32_bf16 v[132:135], v[100:103], v[32:35], v[132:135]
    ds_read_b128 v[88:91], v4 offset:4096
    s_waitcnt lgkmcnt(4)
    v_mfma_f32_16x16x32_bf16 v[136:139], v[104:107], v[32:35], v[136:139]
    ds_read_b128 v[92:95], v2 offset:13312
    s_waitcnt lgkmcnt(4)
    v_mfma_f32_16x16x32_bf16 v[140:143], v[108:111], v[32:35], v[140:143]
    ds_read_b128 v[96:99], v2 offset:33792
    s_add_u32 s60, s62, 8192
    buffer_load_dwordx4 v[176:179], v1, s[4:7], s60 offen sc1
    s_waitcnt lgkmcnt(4)
    v_mfma_f32_16x16x32_bf16 v[144:147], v[80:83], v[32:35], v[144:147]
    ds_read_b128 v[100:103], v2 offset:54272
    s_waitcnt lgkmcnt(4)
    v_mfma_f32_16x16x32_bf16 v[148:151], v[84:87], v[32:35], v[148:151]
    ds_read_b128 v[104:107], v3 offset:9216
    s_waitcnt lgkmcnt(4)
    v_mfma_f32_16x16x32_bf16 v[152:155], v[88:91], v[32:35], v[152:155]
    ds_read_b128 v[108:111], v3 offset:29696
    s_mov_b32 s54, 18432
    buffer_load_dwordx4 v[56:59], v5, s[4:7], s54 offen sc1
    s_waitcnt vmcnt(11)
    s_waitcnt lgkmcnt(4)
    v_mfma_f32_16x16x32_bf16 v[128:131], v[92:95], v[36:39], v[128:131]
    ds_read_b128 v[80:83], v3 offset:50176
    s_add_u32 s60, s62, 9216
    buffer_load_dwordx4 v[180:183], v1, s[4:7], s60 offen sc1
    s_waitcnt lgkmcnt(4)
    v_mfma_f32_16x16x32_bf16 v[132:135], v[96:99], v[36:39], v[132:135]
    ds_read_b128 v[84:87], v4 offset:5120
    s_waitcnt lgkmcnt(4)
    v_mfma_f32_16x16x32_bf16 v[136:139], v[100:103], v[36:39], v[136:139]
    ds_read_b128 v[88:91], v2 offset:14336
    s_waitcnt lgkmcnt(4)
    v_mfma_f32_16x16x32_bf16 v[140:143], v[104:107], v[36:39], v[140:143]
    ds_read_b128 v[92:95], v2 offset:34816
    s_waitcnt lgkmcnt(4)
    v_mfma_f32_16x16x32_bf16 v[144:147], v[108:111], v[36:39], v[144:147]
    ds_read_b128 v[96:99], v2 offset:55296
    s_waitcnt lgkmcnt(4)
    v_mfma_f32_16x16x32_bf16 v[148:151], v[80:83], v[36:39], v[148:151]
    ds_read_b128 v[100:103], v3 offset:10240
    s_add_u32 s60, s62, 10240
    buffer_load_dwordx4 v[184:187], v1, s[4:7], s60 offen sc1
    s_waitcnt lgkmcnt(4)
    v_mfma_f32_16x16x32_bf16 v[152:155], v[84:87], v[36:39], v[152:155]
    ds_read_b128 v[104:107], v3 offset:30720
    s_mov_b32 s54, 19456
    buffer_load_dwordx4 v[60:63], v5, s[4:7], s54 offen sc1
    s_waitcnt vmcnt(13)
    s_waitcnt lgkmcnt(4)
    v_mfma_f32_16x16x32_bf16 v[128:131], v[88:91], v[40:43], v[128:131]
    ds_read_b128 v[108:111], v3 offset:51200
    s_waitcnt lgkmcnt(4)
    v_mfma_f32_16x16x32_bf16 v[132:135], v[92:95], v[40:43], v[132:135]
    ds_read_b128 v[80:83], v4 offset:6144
    s_waitcnt lgkmcnt(4)
    v_mfma_f32_16x16x32_bf16 v[136:139], v[96:99], v[40:43], v[136:139]
    ds_read_b128 v[84:87], v2 offset:15360
    s_waitcnt lgkmcnt(4)
    v_mfma_f32_16x16x32_bf16 v[140:143], v[100:103], v[40:43], v[140:143]
    ds_read_b128 v[88:91], v2 offset:35840
    s_add_u32 s60, s62, 11264
    buffer_load_dwordx4 v[188:191], v1, s[4:7], s60 offen sc1
    s_waitcnt lgkmcnt(4)
    v_mfma_f32_16x16x32_bf16 v[144:147], v[104:107], v[40:43], v[144:147]
    ds_read_b128 v[92:95], v2 offset:56320
    s_waitcnt lgkmcnt(4)
    v_mfma_f32_16x16x32_bf16 v[148:151], v[108:111], v[40:43], v[148:151]
    ds_read_b128 v[96:99], v3 offset:11264
    s_waitcnt lgkmcnt(4)
    v_mfma_f32_16x16x32_bf16 v[152:155], v[80:83], v[40:43], v[152:155]
    ds_read_b128 v[100:103], v3 offset:31744
    s_waitcnt vmcnt(11)
    s_waitcnt lgkmcnt(4)
    v_mfma_f32_16x16x32_bf16 v[128:131], v[84:87], v[44:47], v[128:131]
    ds_read_b128 v[104:107], v3 offset:52224
    s_add_u32 s60, s63, 8192
    buffer_load_dwordx4 v[192:195], v1, s[4:7], s60 offen sc1
    s_waitcnt lgkmcnt(4)
    v_mfma_f32_16x16x32_bf16 v[132:135], v[88:91], v[44:47], v[132:135]
    ds_read_b128 v[108:111], v4 offset:7168
    s_waitcnt lgkmcnt(4)
    v_mfma_f32_16x16x32_bf16 v[136:139], v[92:95], v[44:47], v[136:139]
    ds_read_b128 v[80:83], v2 offset:16384
    s_waitcnt lgkmcnt(4)
    v_mfma_f32_16x16x32_bf16 v[140:143], v[96:99], v[44:47], v[140:143]
    ds_read_b128 v[84:87], v2 offset:36864
    s_waitcnt lgkmcnt(4)
    v_mfma_f32_16x16x32_bf16 v[144:147], v[100:103], v[44:47], v[144:147]
    ds_read_b128 v[88:91], v2 offset:57344
    s_waitcnt lgkmcnt(4)
    v_mfma_f32_16x16x32_bf16 v[148:151], v[104:107], v[44:47], v[148:151]
    ds_read_b128 v[92:95], v3 offset:12288
    s_add_u32 s60, s62, 16384
    buffer_load_dwordx4 v[196:199], v1, s[4:7], s60 offen sc1
    s_waitcnt lgkmcnt(4)
    v_mfma_f32_16x16x32_bf16 v[152:155], v[108:111], v[44:47], v[152:155]
    ds_read_b128 v[96:99], v3 offset:32768
    s_waitcnt vmcnt(11)
    s_waitcnt lgkmcnt(4)
    v_mfma_f32_16x16x32_bf16 v[128:131], v[80:83], v[48:51], v[128:131]
    ds_read_b128 v[100:103], v3 offset:53248
    s_waitcnt lgkmcnt(4)
    v_mfma_f32_16x16x32_bf16 v[132:135], v[84:87], v[48:51], v[132:135]
    ds_read_b128 v[104:107], v4 offset:8192
    s_waitcnt lgkmcnt(4)
    v_mfma_f32_16x16x32_bf16 v[136:139], v[88:91], v[48:51], v[136:139]
    ds_read_b128 v[108:111], v2 offset:17408
    s_waitcnt lgkmcnt(4)
    v_mfma_f32_16x16x32_bf16 v[140:143], v[92:95], v[48:51], v[140:143]
    ds_read_b128 v[80:83], v2 offset:37888
    s_add_u32 s60, s62, 17408
    buffer_load_dwordx4 v[200:203], v1, s[4:7], s60 offen sc1
    s_waitcnt lgkmcnt(4)
    v_mfma_f32_16x16x32_bf16 v[144:147], v[96:99], v[48:51], v[144:147]
    ds_read_b128 v[84:87], v2 offset:58368
    s_waitcnt lgkmcnt(4)
    v_mfma_f32_16x16x32_bf16 v[148:151], v[100:103], v[48:51], v[148:151]
    ds_read_b128 v[88:91], v3 offset:13312
    s_waitcnt lgkmcnt(4)
    v_mfma_f32_16x16x32_bf16 v[152:155], v[104:107], v[48:51], v[152:155]
    ds_read_b128 v[92:95], v3 offset:33792
    s_waitcnt vmcnt(9)
    s_waitcnt lgkmcnt(4)
    v_mfma_f32_16x16x32_bf16 v[128:131], v[108:111], v[52:55], v[128:131]
    ds_read_b128 v[96:99], v3 offset:54272
    s_add_u32 s60, s62, 18432
    buffer_load_dwordx4 v[204:207], v1, s[4:7], s60 offen sc1
    s_waitcnt lgkmcnt(4)
    v_mfma_f32_16x16x32_bf16 v[132:135], v[80:83], v[52:55], v[132:135]
    ds_read_b128 v[100:103], v4 offset:9216
    s_waitcnt lgkmcnt(4)
    v_mfma_f32_16x16x32_bf16 v[136:139], v[84:87], v[52:55], v[136:139]
    ds_read_b128 v[104:107], v2 offset:18432
    s_waitcnt lgkmcnt(4)
    v_mfma_f32_16x16x32_bf16 v[140:143], v[88:91], v[52:55], v[140:143]
    ds_read_b128 v[108:111], v2 offset:38912
    s_waitcnt lgkmcnt(4)
    v_mfma_f32_16x16x32_bf16 v[144:147], v[92:95], v[52:55], v[144:147]
    ds_read_b128 v[80:83], v2 offset:59392
    s_waitcnt lgkmcnt(4)
    v_mfma_f32_16x16x32_bf16 v[148:151], v[96:99], v[52:55], v[148:151]
    ds_read_b128 v[84:87], v3 offset:14336
    s_add_u32 s60, s62, 19456
    buffer_load_dwordx4 v[240:243], v1, s[4:7], s60 offen sc1
    s_waitcnt lgkmcnt(4)
    v_mfma_f32_16x16x32_bf16 v[152:155], v[100:103], v[52:55], v[152:155]
    ds_read_b128 v[88:91], v3 offset:34816
    s_waitcnt vmcnt(9)
    s_waitcnt lgkmcnt(4)
    v_mfma_f32_16x16x32_bf16 v[128:131], v[104:107], v[56:59], v[128:131]
    ds_read_b128 v[92:95], v3 offset:55296
    s_waitcnt lgkmcnt(4)
    v_mfma_f32_16x16x32_bf16 v[132:135], v[108:111], v[56:59], v[132:135]
    ds_read_b128 v[96:99], v4 offset:10240
    s_waitcnt lgkmcnt(4)
    v_mfma_f32_16x16x32_bf16 v[136:139], v[80:83], v[56:59], v[136:139]
    ds_read_b128 v[100:103], v2 offset:19456
    s_waitcnt lgkmcnt(4)
    v_mfma_f32_16x16x32_bf16 v[140:143], v[84:87], v[56:59], v[140:143]
    ds_read_b128 v[104:107], v2 offset:39936
    s_add_u32 s60, s63, 16384
    buffer_load_dwordx4 v[244:247], v1, s[4:7], s60 offen sc1
    s_waitcnt lgkmcnt(4)
    v_mfma_f32_16x16x32_bf16 v[144:147], v[88:91], v[56:59], v[144:147]
    ds_read_b128 v[108:111], v2 offset:60416
    s_waitcnt lgkmcnt(4)
    v_mfma_f32_16x16x32_bf16 v[148:151], v[92:95], v[56:59], v[148:151]
    ds_read_b128 v[80:83], v3 offset:15360
    s_waitcnt lgkmcnt(4)
    v_mfma_f32_16x16x32_bf16 v[152:155], v[96:99], v[56:59], v[152:155]
    ds_read_b128 v[84:87], v3 offset:35840
    s_waitcnt vmcnt(7)
    s_waitcnt lgkmcnt(4)
    v_mfma_f32_16x16x32_bf16 v[128:131], v[100:103], v[60:63], v[128:131]
    ds_read_b128 v[88:91], v3 offset:56320
    s_waitcnt lgkmcnt(4)
    v_mfma_f32_16x16x32_bf16 v[132:135], v[104:107], v[60:63], v[132:135]
    ds_read_b128 v[92:95], v4 offset:11264
    s_waitcnt lgkmcnt(4)
    v_mfma_f32_16x16x32_bf16 v[136:139], v[108:111], v[60:63], v[136:139]
    s_waitcnt lgkmcnt(3)
    v_mfma_f32_16x16x32_bf16 v[140:143], v[80:83], v[60:63], v[140:143]
    s_waitcnt lgkmcnt(2)
    v_mfma_f32_16x16x32_bf16 v[144:147], v[84:87], v[60:63], v[144:147]
    s_waitcnt lgkmcnt(1)
    v_mfma_f32_16x16x32_bf16 v[148:151], v[88:91], v[60:63], v[148:151]
    s_waitcnt lgkmcnt(0)
    v_mfma_f32_16x16x32_bf16 v[152:155], v[92:95], v[60:63], v[152:155]
    v_add_f32 v112, v112, v114
    v_add_f32 v113, v113, v115
    v_add_f32 v116, v116, v118
    v_add_f32 v117, v117, v119
    v_add_f32 v112, v112, v116
    v_add_f32 v113, v113, v117
    v_mov_b32 v114, v112
    s_nop 1
    v_permlane16_swap_b32 v112, v114
    v_add_f32 v112, v112, v114
    v_mov_b32 v114, v112
    s_nop 1
    v_permlane32_swap_b32 v112, v114
    v_add_f32 v112, v112, v114
    v_mov_b32 v114, v113
    s_nop 1
    v_permlane16_swap_b32 v113, v114
    v_add_f32 v113, v113, v114
    v_mov_b32 v114, v113
    s_nop 1
    v_permlane32_swap_b32 v113, v114
    v_add_f32 v113, v113, v114
    v_mul_f32 v112, 0x3acccccd, v112
    v_mul_f32 v113, 0x3acccccd, v113
    v_fma_f32 v113, -v112, v112, v113
    v_max_f32 v113, 0, v113
    v_add_f32 v113, 0x3727c5ac, v113
    v_rsq_f32 v113, v113
    s_waitcnt lgkmcnt(0)
    s_barrier
    s_waitcnt vmcnt(0)
    ds_write_b128 v30, v[156:159] offset:0
    v_pk_fma_f32 v[128:129], v[208:209], v[112:113], v[128:129] op_sel:[0,0,0] op_sel_hi:[1,0,1] neg_lo:[0,1,0] neg_hi:[0,1,0]
    v_pk_fma_f32 v[130:131], v[210:211], v[112:113], v[130:131] op_sel:[0,0,0] op_sel_hi:[1,0,1] neg_lo:[0,1,0] neg_hi:[0,1,0]
    v_pk_mul_f32 v[128:129], v[128:129], v[112:113] op_sel:[0,1] op_sel_hi:[1,1]
    v_pk_mul_f32 v[130:131], v[130:131], v[112:113] op_sel:[0,1] op_sel_hi:[1,1]
    v_pk_mul_f32 v[12:13], v[128:129], v[128:129]
    v_pk_mul_f32 v[14:15], v[130:131], v[130:131]
    v_pk_fma_f32 v[12:13], v[12:13], v[28:29], v[28:29] op_sel:[0,1,0] op_sel_hi:[1,1,0]
    v_pk_fma_f32 v[14:15], v[14:15], v[28:29], v[28:29] op_sel:[0,1,0] op_sel_hi:[1,1,0]
    v_pk_mul_f32 v[12:13], v[12:13], v[128:129]
    v_pk_mul_f32 v[14:15], v[14:15], v[130:131]
    ds_write_b128 v30, v[160:163] offset:1024
    v_exp_f32 v12, v12
    v_exp_f32 v13, v13
    v_exp_f32 v14, v14
    v_exp_f32 v15, v15
    v_pk_add_f32 v[12:13], v[12:13], 1.0 op_sel_hi:[1,0]
    v_pk_add_f32 v[14:15], v[14:15], 1.0 op_sel_hi:[1,0]
    v_rcp_f32 v12, v12
    v_rcp_f32 v13, v13
    v_rcp_f32 v14, v14
    v_rcp_f32 v15, v15
    ds_write_b128 v30, v[164:167] offset:2048
    v_pk_mul_f32 v[128:129], v[128:129], v[12:13]
    v_pk_mul_f32 v[130:131], v[130:131], v[14:15]
    v_cvt_pk_bf16_f32 v16, v128, v129
    v_cvt_pk_bf16_f32 v17, v130, v131
    buffer_store_dwordx2 v[16:17], v7, s[4:7], s55 offen offset:0 sc1
    v_pk_fma_f32 v[132:133], v[212:213], v[112:113], v[132:133] op_sel:[0,0,0] op_sel_hi:[1,0,1] neg_lo:[0,1,0] neg_hi:[0,1,0]
    v_pk_fma_f32 v[134:135], v[214:215], v[112:113], v[134:135] op_sel:[0,0,0] op_sel_hi:[1,0,1] neg_lo:[0,1,0] neg_hi:[0,1,0]
    v_pk_mul_f32 v[132:133], v[132:133], v[112:113] op_sel:[0,1] op_sel_hi:[1,1]
    v_pk_mul_f32 v[134:135], v[134:135], v[112:113] op_sel:[0,1] op_sel_hi:[1,1]
    v_pk_mul_f32 v[12:13], v[132:133], v[132:133]
    ds_write_b128 v30, v[168:171] offset:3072
    v_pk_mul_f32 v[14:15], v[134:135], v[134:135]
    v_pk_fma_f32 v[12:13], v[12:13], v[28:29], v[28:29] op_sel:[0,1,0] op_sel_hi:[1,1,0]
    v_pk_fma_f32 v[14:15], v[14:15], v[28:29], v[28:29] op_sel:[0,1,0] op_sel_hi:[1,1,0]
    v_pk_mul_f32 v[12:13], v[12:13], v[132:133]
    v_pk_mul_f32 v[14:15], v[14:15], v[134:135]
    v_exp_f32 v12, v12
    v_exp_f32 v13, v13
    v_exp_f32 v14, v14
    v_exp_f32 v15, v15
    v_pk_add_f32 v[12:13], v[12:13], 1.0 op_sel_hi:[1,0]
    ds_write_b128 v26, v[172:175] offset:0
    v_pk_add_f32 v[14:15], v[14:15], 1.0 op_sel_hi:[1,0]
    v_rcp_f32 v12, v12
    v_rcp_f32 v13, v13
    v_rcp_f32 v14, v14
    v_rcp_f32 v15, v15
    v_pk_mul_f32 v[132:133], v[132:133], v[12:13]
    v_pk_mul_f32 v[134:135], v[134:135], v[14:15]
    v_cvt_pk_bf16_f32 v18, v132, v133
    v_cvt_pk_bf16_f32 v19, v134, v135
    buffer_store_dwordx2 v[18:19], v7, s[4:7], s55 offen offset:512 sc1
    ds_write_b128 v30, v[176:179] offset:40960
    v_pk_fma_f32 v[136:137], v[216:217], v[112:113], v[136:137] op_sel:[0,0,0] op_sel_hi:[1,0,1] neg_lo:[0,1,0] neg_hi:[0,1,0]
    v_pk_fma_f32 v[138:139], v[218:219], v[112:113], v[138:139] op_sel:[0,0,0] op_sel_hi:[1,0,1] neg_lo:[0,1,0] neg_hi:[0,1,0]
    v_pk_mul_f32 v[136:137], v[136:137], v[112:113] op_sel:[0,1] op_sel_hi:[1,1]
    v_pk_mul_f32 v[138:139], v[138:139], v[112:113] op_sel:[0,1] op_sel_hi:[1,1]
    v_pk_mul_f32 v[12:13], v[136:137], v[136:137]
    v_pk_mul_f32 v[14:15], v[138:139], v[138:139]
    v_pk_fma_f32 v[12:13], v[12:13], v[28:29], v[28:29] op_sel:[0,1,0] op_sel_hi:[1,1,0]
    v_pk_fma_f32 v[14:15], v[14:15], v[28:29], v[28:29] op_sel:[0,1,0] op_sel_hi:[1,1,0]
    v_pk_mul_f32 v[12:13], v[12:13], v[136:137]
    v_pk_mul_f32 v[14:15], v[14:15], v[138:139]
    ds_write_b128 v30, v[180:183] offset:41984
    v_exp_f32 v12, v12
    v_exp_f32 v13, v13
    v_exp_f32 v14, v14
    v_exp_f32 v15, v15
    v_pk_add_f32 v[12:13], v[12:13], 1.0 op_sel_hi:[1,0]
    v_pk_add_f32 v[14:15], v[14:15], 1.0 op_sel_hi:[1,0]
    v_rcp_f32 v12, v12
    v_rcp_f32 v13, v13
    v_rcp_f32 v14, v14
    v_rcp_f32 v15, v15
    ds_write_b128 v30, v[184:187] offset:43008
    v_pk_mul_f32 v[136:137], v[136:137], v[12:13]
    v_pk_mul_f32 v[138:139], v[138:139], v[14:15]
    v_cvt_pk_bf16_f32 v20, v136, v137
    v_cvt_pk_bf16_f32 v21, v138, v139
    buffer_store_dwordx2 v[20:21], v7, s[4:7], s55 offen offset:1024 sc1
    v_pk_fma_f32 v[140:141], v[220:221], v[112:113], v[140:141] op_sel:[0,0,0] op_sel_hi:[1,0,1] neg_lo:[0,1,0] neg_hi:[0,1,0]
    v_pk_fma_f32 v[142:143], v[222:223], v[112:113], v[142:143] op_sel:[0,0,0] op_sel_hi:[1,0,1] neg_lo:[0,1,0] neg_hi:[0,1,0]
    v_pk_mul_f32 v[140:141], v[140:141], v[112:113] op_sel:[0,1] op_sel_hi:[1,1]
    v_pk_mul_f32 v[142:143], v[142:143], v[112:113] op_sel:[0,1] op_sel_hi:[1,1]
    v_pk_mul_f32 v[12:13], v[140:141], v[140:141]
    ds_write_b128 v30, v[188:191] offset:44032
    v_pk_mul_f32 v[14:15], v[142:143], v[142:143]
    v_pk_fma_f32 v[12:13], v[12:13], v[28:29], v[28:29] op_sel:[0,1,0] op_sel_hi:[1,1,0]
    v_pk_fma_f32 v[14:15], v[14:15], v[28:29], v[28:29] op_sel:[0,1,0] op_sel_hi:[1,1,0]
    v_pk_mul_f32 v[12:13], v[12:13], v[140:141]
    v_pk_mul_f32 v[14:15], v[14:15], v[142:143]
    v_exp_f32 v12, v12
    v_exp_f32 v13, v13
    v_exp_f32 v14, v14
    v_exp_f32 v15, v15
    v_pk_add_f32 v[12:13], v[12:13], 1.0 op_sel_hi:[1,0]
    ds_write_b128 v26, v[192:195] offset:40960
    v_pk_add_f32 v[14:15], v[14:15], 1.0 op_sel_hi:[1,0]
    v_rcp_f32 v12, v12
    v_rcp_f32 v13, v13
    v_rcp_f32 v14, v14
    v_rcp_f32 v15, v15
    v_pk_mul_f32 v[140:141], v[140:141], v[12:13]
    v_pk_mul_f32 v[142:143], v[142:143], v[14:15]
    v_cvt_pk_bf16_f32 v22, v140, v141
    v_cvt_pk_bf16_f32 v23, v142, v143
    buffer_store_dwordx2 v[22:23], v7, s[4:7], s55 offen offset:1536 sc1
    ds_write_b128 v31, v[196:199] offset:16384
    v_pk_fma_f32 v[144:145], v[224:225], v[112:113], v[144:145] op_sel:[0,0,0] op_sel_hi:[1,0,1] neg_lo:[0,1,0] neg_hi:[0,1,0]
    v_pk_fma_f32 v[146:147], v[226:227], v[112:113], v[146:147] op_sel:[0,0,0] op_sel_hi:[1,0,1] neg_lo:[0,1,0] neg_hi:[0,1,0]
    v_pk_mul_f32 v[144:145], v[144:145], v[112:113] op_sel:[0,1] op_sel_hi:[1,1]
    v_pk_mul_f32 v[146:147], v[146:147], v[112:113] op_sel:[0,1] op_sel_hi:[1,1]
    v_pk_mul_f32 v[12:13], v[144:145], v[144:145]
    v_pk_mul_f32 v[14:15], v[146:147], v[146:147]
    v_pk_fma_f32 v[12:13], v[12:13], v[28:29], v[28:29] op_sel:[0,1,0] op_sel_hi:[1,1,0]
    v_pk_fma_f32 v[14:15], v[14:15], v[28:29], v[28:29] op_sel:[0,1,0] op_sel_hi:[1,1,0]
    v_pk_mul_f32 v[12:13], v[12:13], v[144:145]
    v_pk_mul_f32 v[14:15], v[14:15], v[146:147]
    ds_write_b128 v31, v[200:203] offset:17408
    v_exp_f32 v12, v12
    v_exp_f32 v13, v13
    v_exp_f32 v14, v14
    v_exp_f32 v15, v15
    v_pk_add_f32 v[12:13], v[12:13], 1.0 op_sel_hi:[1,0]
    v_pk_add_f32 v[14:15], v[14:15], 1.0 op_sel_hi:[1,0]
    v_rcp_f32 v12, v12
    v_rcp_f32 v13, v13
    v_rcp_f32 v14, v14
    v_rcp_f32 v15, v15
    ds_write_b128 v31, v[204:207] offset:18432
    v_pk_mul_f32 v[144:145], v[144:145], v[12:13]
    v_pk_mul_f32 v[146:147], v[146:147], v[14:15]
    v_cvt_pk_bf16_f32 v16, v144, v145
    v_cvt_pk_bf16_f32 v17, v146, v147
    buffer_store_dwordx2 v[16:17], v7, s[4:7], s55 offen offset:2048 sc1
    v_pk_fma_f32 v[148:149], v[228:229], v[112:113], v[148:149] op_sel:[0,0,0] op_sel_hi:[1,0,1] neg_lo:[0,1,0] neg_hi:[0,1,0]
    v_pk_fma_f32 v[150:151], v[230:231], v[112:113], v[150:151] op_sel:[0,0,0] op_sel_hi:[1,0,1] neg_lo:[0,1,0] neg_hi:[0,1,0]
    v_pk_mul_f32 v[148:149], v[148:149], v[112:113] op_sel:[0,1] op_sel_hi:[1,1]
    v_pk_mul_f32 v[150:151], v[150:151], v[112:113] op_sel:[0,1] op_sel_hi:[1,1]
    v_pk_mul_f32 v[12:13], v[148:149], v[148:149]
    ds_write_b128 v31, v[240:243] offset:19456
    v_pk_mul_f32 v[14:15], v[150:151], v[150:151]
    v_pk_fma_f32 v[12:13], v[12:13], v[28:29], v[28:29] op_sel:[0,1,0] op_sel_hi:[1,1,0]
    v_pk_fma_f32 v[14:15], v[14:15], v[28:29], v[28:29] op_sel:[0,1,0] op_sel_hi:[1,1,0]
    v_pk_mul_f32 v[12:13], v[12:13], v[148:149]
    v_pk_mul_f32 v[14:15], v[14:15], v[150:151]
    v_exp_f32 v12, v12
    v_exp_f32 v13, v13
    v_exp_f32 v14, v14
    v_exp_f32 v15, v15
    v_pk_add_f32 v[12:13], v[12:13], 1.0 op_sel_hi:[1,0]
    ds_write_b128 v27, v[244:247] offset:16384
    v_pk_add_f32 v[14:15], v[14:15], 1.0 op_sel_hi:[1,0]
    v_rcp_f32 v12, v12
    v_rcp_f32 v13, v13
    v_rcp_f32 v14, v14
    v_rcp_f32 v15, v15
    v_pk_mul_f32 v[148:149], v[148:149], v[12:13]
    v_pk_mul_f32 v[150:151], v[150:151], v[14:15]
    v_cvt_pk_bf16_f32 v18, v148, v149
    v_cvt_pk_bf16_f32 v19, v150, v151
    buffer_store_dwordx2 v[18:19], v7, s[4:7], s55 offen offset:2560 sc1
    s_cmp_ge_u32 s42, 12
    s_cbranch_scc1 L_p5s_117
    v_pk_fma_f32 v[152:153], v[232:233], v[112:113], v[152:153] op_sel:[0,0,0] op_sel_hi:[1,0,1] neg_lo:[0,1,0] neg_hi:[0,1,0]
    v_pk_fma_f32 v[154:155], v[234:235], v[112:113], v[154:155] op_sel:[0,0,0] op_sel_hi:[1,0,1] neg_lo:[0,1,0] neg_hi:[0,1,0]
    v_pk_mul_f32 v[152:153], v[152:153], v[112:113] op_sel:[0,1] op_sel_hi:[1,1]
    v_pk_mul_f32 v[154:155], v[154:155], v[112:113] op_sel:[0,1] op_sel_hi:[1,1]
    v_pk_mul_f32 v[12:13], v[152:153], v[152:153]
    v_pk_mul_f32 v[14:15], v[154:155], v[154:155]
    v_pk_fma_f32 v[12:13], v[12:13], v[28:29], v[28:29] op_sel:[0,1,0] op_sel_hi:[1,1,0]
    v_pk_fma_f32 v[14:15], v[14:15], v[28:29], v[28:29] op_sel:[0,1,0] op_sel_hi:[1,1,0]
    v_pk_mul_f32 v[12:13], v[12:13], v[152:153]
    v_pk_mul_f32 v[14:15], v[14:15], v[154:155]
    v_exp_f32 v12, v12
    v_exp_f32 v13, v13
    v_exp_f32 v14, v14
    v_exp_f32 v15, v15
    v_pk_add_f32 v[12:13], v[12:13], 1.0 op_sel_hi:[1,0]
    v_pk_add_f32 v[14:15], v[14:15], 1.0 op_sel_hi:[1,0]
    v_rcp_f32 v12, v12
    v_rcp_f32 v13, v13
    v_rcp_f32 v14, v14
    v_rcp_f32 v15, v15
    v_pk_mul_f32 v[152:153], v[152:153], v[12:13]
    v_pk_mul_f32 v[154:155], v[154:155], v[14:15]
    v_cvt_pk_bf16_f32 v20, v152, v153
    v_cvt_pk_bf16_f32 v21, v154, v155
    buffer_store_dwordx2 v[20:21], v7, s[4:7], s55 offen offset:3072 sc1
L_p5s_117:
    s_lshl_b32 s89, s41, 4
    s_add_u32 s89, s89, s42
    s_lshl_b32 s89, s89, 2
    s_add_u32 s89, s89, 51200
    s_and_b32 s45, s2, 7
    s_lshr_b32 s46, s2, 3
    s_lshl_b32 s45, s45, 2
    s_lshr_b32 s41, s46, 3
    s_add_u32 s41, s41, s45
    s_and_b32 s42, s46, 7
    s_and_b32 s43, s3, 3
    s_lshr_b32 s44, s3, 2
    s_lshl_b32 s49, s41, 2
    s_add_u32 s49, s49, s43
    v_lshlrev_b32 v1, 4, v0
    s_load_dwordx2 s[20:21], s[0:1], 96
    s_lshl_b32 s45, s44, 12
    v_add_u32 v2, s45, v1
    v_add_u32 v3, 0x10000, v2
    s_mul_i32 s45, s44, 3072
    v_add_u32 v4, s45, v1
    s_mul_i32 s45, s49, 55296
    s_add_u32 s45, s45, 63438848
    s_lshl_b32 s46, s44, 12
    s_add_u32 s46, s46, s45
    v_add_u32 v5, s46, v1
    s_mul_i32 s46, s44, 3072
    s_add_u32 s46, s46, s45
    v_add_u32 v6, s46, v1
    v_lshrrev_b32 v7, 5, v0
    v_lshlrev_b32 v7, 8, v7
    v_and_b32 v30, 15, v0
    v_lshlrev_b32 v30, 4, v30
    v_add_u32 v7, v7, v30
    v_bfe_u32 v30, v0, 4, 1
    v_lshlrev_b32 v30, 3, v30
    v_add_u32 v7, v7, v30
    s_mul_i32 s45, s49, 20480
    v_add_u32 v7, s45, v7
    s_mul_i32 s55, s42, 2560
    s_add_u32 s56, s55, 50331648
    s_add_u32 s55, s55, 60817408
    v_lshrrev_b32 v11, 4, v0
    v_lshlrev_b32 v11, 4, v11
    s_mul_i32 s47, s42, 320
    s_add_u32 s47, s47, 12800
    s_lshl_b32 s45, s49, 4
    v_and_b32 v10, 15, v0
    v_add_u32 v10, s45, v10
    v_mul_u32_u24 v10, 1280, v10
    v_lshrrev_b32 v9, 4, v0
    v_lshlrev_b32 v9, 3, v9
    v_add_u32 v31, v10, v9
    s_mul_i32 s57, s42, 160
    s_waitcnt lgkmcnt(0)
    s_and_b32 s21, s21, 0xffff
    s_mov_b32 s22, 2621440
    s_mov_b32 s23, 0x20000
    s_waitcnt vmcnt(0)
    s_waitcnt lgkmcnt(0)
    s_barrier
    s_cmp_eq_u32 s3, 0
    s_cbranch_scc1 L_b0_118
    s_mul_i32 s58, s44, 1536
    s_add_u32 s59, s58, s55
    s_add_u32 s58, s58, s56
    buffer_load_dwordx2 v[112:113], v7, s[4:7], s58 offen offset:0 sc1
    buffer_load_dwordx2 v[208:209], v7, s[4:7], s59 offen offset:0 sc1
    buffer_load_dwordx2 v[114:115], v7, s[4:7], s58 offen offset:512 sc1
    buffer_load_dwordx2 v[210:211], v7, s[4:7], s59 offen offset:512 sc1
    buffer_load_dwordx2 v[116:117], v7, s[4:7], s58 offen offset:1024 sc1
    buffer_load_dwordx2 v[212:213], v7, s[4:7], s59 offen offset:1024 sc1
    s_mul_i32 s58, s44, 192
    s_add_u32 s58, s58, s47
    buffer_load_dwordx4 v[220:223], v11, s[4:7], s58 offen offset:0 sc1
    buffer_load_dwordx4 v[224:227], v11, s[4:7], s58 offen offset:64 sc1
    buffer_load_dwordx4 v[228:231], v11, s[4:7], s58 offen offset:128 sc1
    s_branch L_b1_119
L_b0_118:
    v_mov_b32 v250, s24
    v_mov_b32 v251, 0
    s_mov_b64 exec, 1
    s_cmp_eq_u32 s29, 0
    s_cbranch_scc1 L_fl_120
    buffer_store_dword v250, v251, s[4:7], s89 offen
    s_branch L_fj_121
L_fl_120:
    buffer_atomic_swap v250, v251, s[4:7], s89 offen
L_fj_121:
    s_mov_b64 exec, -1
    s_lshr_b32 s59, s41, 1
    s_lshl_b32 s59, s59, 6
    s_add_u32 s59, s59, 51200
    v_lshlrev_b32 v251, 2, v0
    s_mov_b32 s58, 0
    s_mov_b32 s60, 0xffff
    s_mov_b32 s61, 0x0
    s_mov_b64 exec, s[60:61]
L_poll_122:
    buffer_load_dword v252, v251, s[4:7], s59 offen sc1
    s_waitcnt vmcnt(0)
    v_cmp_ne_u32 vcc, s24, v252
    s_nop 1
    s_and_b64 vcc, vcc, s[60:61]
    s_cbranch_scc0 L_polld_123
    s_sleep 1
    s_add_u32 s58, s58, 1
    s_cmp_lt_u32 s58, 32768
    s_cbranch_scc1 L_poll_122
    s_load_dwordx2 s[20:21], s[0:1], 104
    s_waitcnt lgkmcnt(0)
    s_and_b32 s21, s21, 0xffff
    s_mov_b32 s22, 256
    s_mov_b32 s23, 0x20000
    v_mov_b32 v253, 0xdead000b
    v_mov_b32 v251, 48
    s_mov_b64 exec, 1
    buffer_store_dword v253, v251, s[20:23], 0 offen
L_polld_123:
    s_mov_b64 exec, -1
    s_mul_i32 s58, s44, 1536
    s_add_u32 s59, s58, s55
    s_add_u32 s58, s58, s56
    buffer_load_dwordx2 v[112:113], v7, s[4:7], s58 offen offset:0 sc1
    buffer_load_dwordx2 v[208:209], v7, s[4:7], s59 offen offset:0 sc1
    buffer_load_dwordx2 v[114:115], v7, s[4:7], s58 offen offset:512 sc1
    buffer_load_dwordx2 v[210:211], v7, s[4:7], s59 offen offset:512 sc1
    buffer_load_dwordx2 v[116:117], v7, s[4:7], s58 offen offset:1024 sc1
    buffer_load_dwordx2 v[212:213], v7, s[4:7], s59 offen offset:1024 sc1
    s_mul_i32 s58, s44, 192
    s_add_u32 s58, s58, s47
    buffer_load_dwordx4 v[220:223], v11, s[4:7], s58 offen offset:0 sc1
    buffer_load_dwordx4 v[224:227], v11, s[4:7], s58 offen offset:64 sc1
    buffer_load_dwordx4 v[228:231], v11, s[4:7], s58 offen offset:128 sc1
L_b1_119:
    s_barrier
    s_mov_b32 s54, 0
    buffer_load_dwordx4 v[32:35], v5, s[4:7], s54 offen sc1
    s_mov_b32 s54, 1024
    buffer_load_dwordx4 v[36:39], v5, s[4:7], s54 offen sc1
    s_mov_b32 s54, 2048
    buffer_load_dwordx4 v[40:43], v5, s[4:7], s54 offen sc1
    s_mov_b32 s54, 3072
    buffer_load_dwordx4 v[44:47], v5, s[4:7], s54 offen sc1
    s_mov_b32 s54, 8192
    buffer_load_dwordx4 v[48:51], v5, s[4:7], s54 offen sc1
    s_mov_b32 s54, 9216
    buffer_load_dwordx4 v[52:55], v5, s[4:7], s54 offen sc1
    ds_read_b128 v[80:83], v2 offset:0
    ds_read_b128 v[84:87], v2 offset:8192
    ds_read_b128 v[88:91], v2 offset:16384
    ds_read_b128 v[92:95], v2 offset:24576
    ds_read_b128 v[96:99], v2 offset:32768
    s_mov_b32 s54, 10240
    buffer_load_dwordx4 v[56:59], v5, s[4:7], s54 offen sc1
    s_waitcnt vmcnt(6)
    s_waitcnt lgkmcnt(4)
    v_mfma_f32_16x16x32_bf16 v[128:131], v[80:83], v[32:35], 0
    ds_read_b128 v[100:103], v2 offset:1024
    s_waitcnt lgkmcnt(4)
    v_mfma_f32_16x16x32_bf16 v[132:135], v[84:87], v[32:35], 0
    ds_read_b128 v[104:107], v2 offset:9216
    s_waitcnt lgkmcnt(4)
    v_mfma_f32_16x16x32_bf16 v[136:139], v[88:91], v[32:35], 0
    ds_read_b128 v[108:111], v2 offset:17408
    s_waitcnt lgkmcnt(4)
    v_mfma_f32_16x16x32_bf16 v[140:143], v[92:95], v[32:35], 0
    ds_read_b128 v[80:83], v2 offset:25600
    s_waitcnt lgkmcnt(4)
    v_mfma_f32_16x16x32_bf16 v[144:147], v[96:99], v[32:35], 0
    ds_read_b128 v[84:87], v2 offset:33792
    s_mov_b32 s54, 11264
    buffer_load_dwordx4 v[60:63], v5, s[4:7], s54 offen sc1
    s_waitcnt vmcnt(6)
    s_waitcnt lgkmcnt(4)
    v_mfma_f32_16x16x32_bf16 v[128:131], v[100:103], v[36:39], v[128:131]
    ds_read_b128 v[88:91], v2 offset:2048
    s_waitcnt lgkmcnt(4)
    v_mfma_f32_16x16x32_bf16 v[132:135], v[104:107], v[36:39], v[132:135]
    ds_read_b128 v[92:95], v2 offset:10240
    s_waitcnt lgkmcnt(4)
    v_mfma_f32_16x16x32_bf16 v[136:139], v[108:111], v[36:39], v[136:139]
    ds_read_b128 v[96:99], v2 offset:18432
    s_waitcnt lgkmcnt(4)
    v_mfma_f32_16x16x32_bf16 v[140:143], v[80:83], v[36:39], v[140:143]
    ds_read_b128 v[100:103], v2 offset:26624
    s_waitcnt lgkmcnt(4)
    v_mfma_f32_16x16x32_bf16 v[144:147], v[84:87], v[36:39], v[144:147]
    ds_read_b128 v[104:107], v2 offset:34816
    s_mov_b32 s54, 16384
    buffer_load_dwordx4 v[64:67], v5, s[4:7], s54 offen sc1
    s_waitcnt vmcnt(6)
    s_waitcnt lgkmcnt(4)
    v_mfma_f32_16x16x32_bf16 v[128:131], v[88:91], v[40:43], v[128:131]
    ds_read_b128 v[108:111], v2 offset:3072
    s_waitcnt lgkmcnt(4)
    v_mfma_f32_16x16x32_bf16 v[132:135], v[92:95], v[40:43], v[132:135]
    ds_read_b128 v[80:83], v2 offset:11264
    s_waitcnt lgkmcnt(4)
    v_mfma_f32_16x16x32_bf16 v[136:139], v[96:99], v[40:43], v[136:139]
    ds_read_b128 v[84:87], v2 offset:19456
    s_waitcnt lgkmcnt(4)
    v_mfma_f32_16x16x32_bf16 v[140:143], v[100:103], v[40:43], v[140:143]
    ds_read_b128 v[88:91], v2 offset:27648
    s_waitcnt lgkmcnt(4)
    v_mfma_f32_16x16x32_bf16 v[144:147], v[104:107], v[40:43], v[144:147]
    ds_read_b128 v[92:95], v2 offset:35840
    s_mov_b32 s54, 17408
    buffer_load_dwordx4 v[68:71], v5, s[4:7], s54 offen sc1
    s_waitcnt vmcnt(6)
    s_waitcnt lgkmcnt(4)
    v_mfma_f32_16x16x32_bf16 v[128:131], v[108:111], v[44:47], v[128:131]
    s_waitcnt lgkmcnt(0)
    s_barrier
    s_add_u32 s50, s62, 24576
    s_add_u32 m0, s53, 0
    s_nop 0
    buffer_load_dwordx4 v1, s[4:7], s50 offen sc1 lds
    buffer_load_dwordx4 v1, s[4:7], s50 offen offset:1024 sc1 lds
    buffer_load_dwordx4 v1, s[4:7], s50 offen offset:2048 sc1 lds
    buffer_load_dwordx4 v1, s[4:7], s50 offen offset:3072 sc1 lds
    s_add_u32 s50, s63, 24576
    s_add_u32 m0, s64, 0
    s_nop 0
    buffer_load_dwordx4 v1, s[4:7], s50 offen sc1 lds
    ds_read_b128 v[96:99], v2 offset:40960
    v_mfma_f32_16x16x32_bf16 v[132:135], v[80:83], v[44:47], v[132:135]
    ds_read_b128 v[100:103], v2 offset:49152
    v_mfma_f32_16x16x32_bf16 v[136:139], v[84:87], v[44:47], v[136:139]
    ds_read_b128 v[104:107], v2 offset:57344
    v_mfma_f32_16x16x32_bf16 v[140:143], v[88:91], v[44:47], v[140:143]
    ds_read_b128 v[108:111], v3 offset:0
    v_mfma_f32_16x16x32_bf16 v[144:147], v[92:95], v[44:47], v[144:147]
    ds_read_b128 v[80:83], v3 offset:8192
    s_mov_b32 s54, 18432
    buffer_load_dwordx4 v[72:75], v5, s[4:7], s54 offen sc1
    s_waitcnt vmcnt(11)
    s_waitcnt lgkmcnt(4)
    v_mfma_f32_16x16x32_bf16 v[128:131], v[96:99], v[48:51], v[128:131]
    ds_read_b128 v[84:87], v2 offset:41984
    s_waitcnt lgkmcnt(4)
    v_mfma_f32_16x16x32_bf16 v[132:135], v[100:103], v[48:51], v[132:135]
    ds_read_b128 v[88:91], v2 offset:50176
    s_waitcnt lgkmcnt(4)
    v_mfma_f32_16x16x32_bf16 v[136:139], v[104:107], v[48:51], v[136:139]
    ds_read_b128 v[92:95], v2 offset:58368
    s_waitcnt lgkmcnt(4)
    v_mfma_f32_16x16x32_bf16 v[140:143], v[108:111], v[48:51], v[140:143]
    ds_read_b128 v[96:99], v3 offset:1024
    s_waitcnt lgkmcnt(4)
    v_mfma_f32_16x16x32_bf16 v[144:147], v[80:83], v[48:51], v[144:147]
    ds_read_b128 v[100:103], v3 offset:9216
    s_mov_b32 s54, 19456
    buffer_load_dwordx4 v[76:79], v5, s[4:7], s54 offen sc1
    s_waitcnt vmcnt(11)
    s_waitcnt lgkmcnt(4)
    v_mfma_f32_16x16x32_bf16 v[128:131], v[84:87], v[52:55], v[128:131]
    ds_read_b128 v[104:107], v2 offset:43008
    s_waitcnt lgkmcnt(4)
    v_mfma_f32_16x16x32_bf16 v[132:135], v[88:91], v[52:55], v[132:135]
    ds_read_b128 v[108:111], v2 offset:51200
    s_waitcnt lgkmcnt(4)
    v_mfma_f32_16x16x32_bf16 v[136:139], v[92:95], v[52:55], v[136:139]
    ds_read_b128 v[80:83], v2 offset:59392
    s_waitcnt lgkmcnt(4)
    v_mfma_f32_16x16x32_bf16 v[140:143], v[96:99], v[52:55], v[140:143]
    ds_read_b128 v[84:87], v3 offset:2048
    s_waitcnt lgkmcnt(4)
    v_mfma_f32_16x16x32_bf16 v[144:147], v[100:103], v[52:55], v[144:147]
    ds_read_b128 v[88:91], v3 offset:10240
    s_mov_b32 s54, 24576
    buffer_load_dwordx4 v[32:35], v5, s[4:7], s54 offen sc1
    s_waitcnt vmcnt(11)
    s_waitcnt lgkmcnt(4)
    v_mfma_f32_16x16x32_bf16 v[128:131], v[104:107], v[56:59], v[128:131]
    ds_read_b128 v[92:95], v2 offset:44032
    s_waitcnt lgkmcnt(4)
    v_mfma_f32_16x16x32_bf16 v[132:135], v[108:111], v[56:59], v[132:135]
    ds_read_b128 v[96:99], v2 offset:52224
    s_waitcnt lgkmcnt(4)
    v_mfma_f32_16x16x32_bf16 v[136:139], v[80:83], v[56:59], v[136:139]
    ds_read_b128 v[100:103], v2 offset:60416
    s_waitcnt lgkmcnt(4)
    v_mfma_f32_16x16x32_bf16 v[140:143], v[84:87], v[56:59], v[140:143]
    ds_read_b128 v[104:107], v3 offset:3072
    s_waitcnt lgkmcnt(4)
    v_mfma_f32_16x16x32_bf16 v[144:147], v[88:91], v[56:59], v[144:147]
    ds_read_b128 v[108:111], v3 offset:11264
    s_mov_b32 s54, 25600
    buffer_load_dwordx4 v[36:39], v5, s[4:7], s54 offen sc1
    s_waitcnt vmcnt(11)
    s_waitcnt lgkmcnt(4)
    v_mfma_f32_16x16x32_bf16 v[128:131], v[92:95], v[60:63], v[128:131]
    s_waitcnt lgkmcnt(0)
    s_barrier
    s_add_u32 s50, s62, 32768
    s_add_u32 m0, s53, 40960
    s_nop 0
    buffer_load_dwordx4 v1, s[4:7], s50 offen sc1 lds
    buffer_load_dwordx4 v1, s[4:7], s50 offen offset:1024 sc1 lds
    buffer_load_dwordx4 v1, s[4:7], s50 offen offset:2048 sc1 lds
    buffer_load_dwordx4 v1, s[4:7], s50 offen offset:3072 sc1 lds
    s_add_u32 s50, s63, 32768
    s_add_u32 m0, s64, 40960
    s_nop 0
    buffer_load_dwordx4 v1, s[4:7], s50 offen sc1 lds
    ds_read_b128 v[80:83], v3 offset:16384
    v_mfma_f32_16x16x32_bf16 v[132:135], v[96:99], v[60:63], v[132:135]
    ds_read_b128 v[84:87], v3 offset:24576
    v_mfma_f32_16x16x32_bf16 v[136:139], v[100:103], v[60:63], v[136:139]
    ds_read_b128 v[88:91], v3 offset:32768
    v_mfma_f32_16x16x32_bf16 v[140:143], v[104:107], v[60:63], v[140:143]
    ds_read_b128 v[92:95], v3 offset:40960
    v_mfma_f32_16x16x32_bf16 v[144:147], v[108:111], v[60:63], v[144:147]
    ds_read_b128 v[96:99], v3 offset:49152
    s_mov_b32 s54, 26624
    buffer_load_dwordx4 v[40:43], v5, s[4:7], s54 offen sc1
    s_waitcnt vmcnt(16)
    s_waitcnt lgkmcnt(4)
    v_mfma_f32_16x16x32_bf16 v[128:131], v[80:83], v[64:67], v[128:131]
    ds_read_b128 v[100:103], v3 offset:17408
    s_waitcnt lgkmcnt(4)
    v_mfma_f32_16x16x32_bf16 v[132:135], v[84:87], v[64:67], v[132:135]
    ds_read_b128 v[104:107], v3 offset:25600
    s_waitcnt lgkmcnt(4)
    v_mfma_f32_16x16x32_bf16 v[136:139], v[88:91], v[64:67], v[136:139]
    ds_read_b128 v[108:111], v3 offset:33792
    s_waitcnt lgkmcnt(4)
    v_mfma_f32_16x16x32_bf16 v[140:143], v[92:95], v[64:67], v[140:143]
    ds_read_b128 v[80:83], v3 offset:41984
    s_waitcnt lgkmcnt(4)
    v_mfma_f32_16x16x32_bf16 v[144:147], v[96:99], v[64:67], v[144:147]
    ds_read_b128 v[84:87], v3 offset:50176
    s_mov_b32 s54, 27648
    buffer_load_dwordx4 v[44:47], v5, s[4:7], s54 offen sc1
    s_waitcnt vmcnt(16)
    s_waitcnt lgkmcnt(4)
    v_mfma_f32_16x16x32_bf16 v[128:131], v[100:103], v[68:71], v[128:131]
    ds_read_b128 v[88:91], v3 offset:18432
    s_waitcnt lgkmcnt(4)
    v_mfma_f32_16x16x32_bf16 v[132:135], v[104:107], v[68:71], v[132:135]
    ds_read_b128 v[92:95], v3 offset:26624
    s_waitcnt lgkmcnt(4)
    v_mfma_f32_16x16x32_bf16 v[136:139], v[108:111], v[68:71], v[136:139]
    ds_read_b128 v[96:99], v3 offset:34816
    s_waitcnt lgkmcnt(4)
    v_mfma_f32_16x16x32_bf16 v[140:143], v[80:83], v[68:71], v[140:143]
    ds_read_b128 v[100:103], v3 offset:43008
    s_waitcnt lgkmcnt(4)
    v_mfma_f32_16x16x32_bf16 v[144:147], v[84:87], v[68:71], v[144:147]
    ds_read_b128 v[104:107], v3 offset:51200
    s_mov_b32 s54, 32768
    buffer_load_dwordx4 v[48:51], v5, s[4:7], s54 offen sc1
    s_waitcnt vmcnt(11)
    s_waitcnt lgkmcnt(4)
    v_mfma_f32_16x16x32_bf16 v[128:131], v[88:91], v[72:75], v[128:131]
    ds_read_b128 v[108:111], v3 offset:19456
    s_waitcnt lgkmcnt(4)
    v_mfma_f32_16x16x32_bf16 v[132:135], v[92:95], v[72:75], v[132:135]
    ds_read_b128 v[80:83], v3 offset:27648
    s_waitcnt lgkmcnt(4)
    v_mfma_f32_16x16x32_bf16 v[136:139], v[96:99], v[72:75], v[136:139]
    ds_read_b128 v[84:87], v3 offset:35840
    s_waitcnt lgkmcnt(4)
    v_mfma_f32_16x16x32_bf16 v[140:143], v[100:103], v[72:75], v[140:143]
    ds_read_b128 v[88:91], v3 offset:44032
    s_waitcnt lgkmcnt(4)
    v_mfma_f32_16x16x32_bf16 v[144:147], v[104:107], v[72:75], v[144:147]
    ds_read_b128 v[92:95], v3 offset:52224
    s_mov_b32 s54, 33792
    buffer_load_dwordx4 v[52:55], v5, s[4:7], s54 offen sc1
    s_waitcnt vmcnt(11)
    s_waitcnt lgkmcnt(4)
    v_mfma_f32_16x16x32_bf16 v[128:131], v[108:111], v[76:79], v[128:131]
    s_waitcnt lgkmcnt(0)
    s_barrier
    s_add_u32 s50, s62, 40960
    s_add_u32 m0, s53, 81920
    s_nop 0
    buffer_load_dwordx4 v1, s[4:7], s50 offen sc1 lds
    buffer_load_dwordx4 v1, s[4:7], s50 offen offset:1024 sc1 lds
    buffer_load_dwordx4 v1, s[4:7], s50 offen offset:2048 sc1 lds
    buffer_load_dwordx4 v1, s[4:7], s50 offen offset:3072 sc1 lds
    s_add_u32 s50, s63, 40960
    s_add_u32 m0, s64, 81920
    s_nop 0
    buffer_load_dwordx4 v1, s[4:7], s50 offen sc1 lds
    ds_read_b128 v[96:99], v2 offset:0
    v_mfma_f32_16x16x32_bf16 v[132:135], v[80:83], v[76:79], v[132:135]
    ds_read_b128 v[100:103], v2 offset:8192
    v_mfma_f32_16x16x32_bf16 v[136:139], v[84:87], v[76:79], v[136:139]
    ds_read_b128 v[104:107], v2 offset:16384
    v_mfma_f32_16x16x32_bf16 v[140:143], v[88:91], v[76:79], v[140:143]
    ds_read_b128 v[108:111], v2 offset:24576
    v_mfma_f32_16x16x32_bf16 v[144:147], v[92:95], v[76:79], v[144:147]
    ds_read_b128 v[80:83], v2 offset:32768
    s_mov_b32 s54, 34816
    buffer_load_dwordx4 v[56:59], v5, s[4:7], s54 offen sc1
    s_waitcnt vmcnt(16)
    s_waitcnt lgkmcnt(4)
    v_mfma_f32_16x16x32_bf16 v[128:131], v[96:99], v[32:35], v[128:131]
    ds_read_b128 v[84:87], v2 offset:1024
    s_waitcnt lgkmcnt(4)
    v_mfma_f32_16x16x32_bf16 v[132:135], v[100:103], v[32:35], v[132:135]
    ds_read_b128 v[88:91], v2 offset:9216
    s_waitcnt lgkmcnt(4)
    v_mfma_f32_16x16x32_bf16 v[136:139], v[104:107], v[32:35], v[136:139]
    ds_read_b128 v[92:95], v2 offset:17408
    s_waitcnt lgkmcnt(4)
    v_mfma_f32_16x16x32_bf16 v[140:143], v[108:111], v[32:35], v[140:143]
    ds_read_b128 v[96:99], v2 offset:25600
    s_waitcnt lgkmcnt(4)
    v_mfma_f32_16x16x32_bf16 v[144:147], v[80:83], v[32:35], v[144:147]
    ds_read_b128 v[100:103], v2 offset:33792
    s_mov_b32 s54, 35840
    buffer_load_dwordx4 v[60:63], v5, s[4:7], s54 offen sc1
    s_waitcnt vmcnt(16)
    s_waitcnt lgkmcnt(4)
    v_mfma_f32_16x16x32_bf16 v[128:131], v[84:87], v[36:39], v[128:131]
    ds_read_b128 v[104:107], v2 offset:2048
    s_waitcnt lgkmcnt(4)
    v_mfma_f32_16x16x32_bf16 v[132:135], v[88:91], v[36:39], v[132:135]
    ds_read_b128 v[108:111], v2 offset:10240
    s_waitcnt lgkmcnt(4)
    v_mfma_f32_16x16x32_bf16 v[136:139], v[92:95], v[36:39], v[136:139]
    ds_read_b128 v[80:83], v2 offset:18432
    s_waitcnt lgkmcnt(4)
    v_mfma_f32_16x16x32_bf16 v[140:143], v[96:99], v[36:39], v[140:143]
    ds_read_b128 v[84:87], v2 offset:26624
    s_waitcnt lgkmcnt(4)
    v_mfma_f32_16x16x32_bf16 v[144:147], v[100:103], v[36:39], v[144:147]
    ds_read_b128 v[88:91], v2 offset:34816
    s_mov_b32 s54, 40960
    buffer_load_dwordx4 v[64:67], v5, s[4:7], s54 offen sc1
    s_waitcnt vmcnt(11)
    s_waitcnt lgkmcnt(4)
    v_mfma_f32_16x16x32_bf16 v[128:131], v[104:107], v[40:43], v[128:131]
    ds_read_b128 v[92:95], v2 offset:3072
    s_waitcnt lgkmcnt(4)
    v_mfma_f32_16x16x32_bf16 v[132:135], v[108:111], v[40:43], v[132:135]
    ds_read_b128 v[96:99], v2 offset:11264
    s_waitcnt lgkmcnt(4)
    v_mfma_f32_16x16x32_bf16 v[136:139], v[80:83], v[40:43], v[136:139]
    ds_read_b128 v[100:103], v2 offset:19456
    s_waitcnt lgkmcnt(4)
    v_mfma_f32_16x16x32_bf16 v[140:143], v[84:87], v[40:43], v[140:143]
    ds_read_b128 v[104:107], v2 offset:27648
    s_waitcnt lgkmcnt(4)
    v_mfma_f32_16x16x32_bf16 v[144:147], v[88:91], v[40:43], v[144:147]
    ds_read_b128 v[108:111], v2 offset:35840
    s_mov_b32 s54, 41984
    buffer_load_dwordx4 v[68:71], v5, s[4:7], s54 offen sc1
    s_waitcnt vmcnt(11)
    s_waitcnt lgkmcnt(4)
    v_mfma_f32_16x16x32_bf16 v[128:131], v[92:95], v[44:47], v[128:131]
    s_waitcnt lgkmcnt(0)
    s_barrier
    s_add_u32 s50, s62, 49152
    s_add_u32 m0, s53, 0
    s_nop 0
    buffer_load_dwordx4 v1, s[4:7], s50 offen sc1 lds
    buffer_load_dwordx4 v1, s[4:7], s50 offen offset:1024 sc1 lds
    buffer_load_dwordx4 v1, s[4:7], s50 offen offset:2048 sc1 lds
    buffer_load_dwordx4 v1, s[4:7], s50 offen offset:3072 sc1 lds
    s_add_u32 s50, s63, 49152
    s_add_u32 m0, s64, 0
    s_nop 0
    buffer_load_dwordx4 v1, s[4:7], s50 offen sc1 lds
    ds_read_b128 v[80:83], v2 offset:40960
    v_mfma_f32_16x16x32_bf16 v[132:135], v[96:99], v[44:47], v[132:135]
    ds_read_b128 v[84:87], v2 offset:49152
    v_mfma_f32_16x16x32_bf16 v[136:139], v[100:103], v[44:47], v[136:139]
    ds_read_b128 v[88:91], v2 offset:57344
    v_mfma_f32_16x16x32_bf16 v[140:143], v[104:107], v[44:47], v[140:143]
    ds_read_b128 v[92:95], v3 offset:0
    v_mfma_f32_16x16x32_bf16 v[144:147], v[108:111], v[44:47], v[144:147]
    ds_read_b128 v[96:99], v3 offset:8192
    s_mov_b32 s54, 43008
    buffer_load_dwordx4 v[72:75], v5, s[4:7], s54 offen sc1
    s_waitcnt vmcnt(16)
    s_waitcnt lgkmcnt(4)
    v_mfma_f32_16x16x32_bf16 v[128:131], v[80:83], v[48:51], v[128:131]
    ds_read_b128 v[100:103], v2 offset:41984
    s_waitcnt lgkmcnt(4)
    v_mfma_f32_16x16x32_bf16 v[132:135], v[84:87], v[48:51], v[132:135]
    ds_read_b128 v[104:107], v2 offset:50176
    s_waitcnt lgkmcnt(4)
    v_mfma_f32_16x16x32_bf16 v[136:139], v[88:91], v[48:51], v[136:139]
    ds_read_b128 v[108:111], v2 offset:58368
    s_waitcnt lgkmcnt(4)
    v_mfma_f32_16x16x32_bf16 v[140:143], v[92:95], v[48:51], v[140:143]
    ds_read_b128 v[80:83], v3 offset:1024
    s_waitcnt lgkmcnt(4)
    v_mfma_f32_16x16x32_bf16 v[144:147], v[96:99], v[48:51], v[144:147]
    ds_read_b128 v[84:87], v3 offset:9216
    s_mov_b32 s54, 44032
    buffer_load_dwordx4 v[76:79], v5, s[4:7], s54 offen sc1
    s_waitcnt vmcnt(16)
    s_waitcnt lgkmcnt(4)
    v_mfma_f32_16x16x32_bf16 v[128:131], v[100:103], v[52:55], v[128:131]
    ds_read_b128 v[88:91], v2 offset:43008
    s_waitcnt lgkmcnt(4)
    v_mfma_f32_16x16x32_bf16 v[132:135], v[104:107], v[52:55], v[132:135]
    ds_read_b128 v[92:95], v2 offset:51200
    s_waitcnt lgkmcnt(4)
    v_mfma_f32_16x16x32_bf16 v[136:139], v[108:111], v[52:55], v[136:139]
    ds_read_b128 v[96:99], v2 offset:59392
    s_waitcnt lgkmcnt(4)
    v_mfma_f32_16x16x32_bf16 v[140:143], v[80:83], v[52:55], v[140:143]
    ds_read_b128 v[100:103], v3 offset:2048
    s_waitcnt lgkmcnt(4)
    v_mfma_f32_16x16x32_bf16 v[144:147], v[84:87], v[52:55], v[144:147]
    ds_read_b128 v[104:107], v3 offset:10240
    s_mov_b32 s54, 49152
    buffer_load_dwordx4 v[32:35], v6, s[4:7], s54 offen sc1
    s_waitcnt vmcnt(11)
    s_waitcnt lgkmcnt(4)
    v_mfma_f32_16x16x32_bf16 v[128:131], v[88:91], v[56:59], v[128:131]
    ds_read_b128 v[108:111], v2 offset:44032
    s_waitcnt lgkmcnt(4)
    v_mfma_f32_16x16x32_bf16 v[132:135], v[92:95], v[56:59], v[132:135]
    ds_read_b128 v[80:83], v2 offset:52224
    s_waitcnt lgkmcnt(4)
    v_mfma_f32_16x16x32_bf16 v[136:139], v[96:99], v[56:59], v[136:139]
    ds_read_b128 v[84:87], v2 offset:60416
    s_waitcnt lgkmcnt(4)
    v_mfma_f32_16x16x32_bf16 v[140:143], v[100:103], v[56:59], v[140:143]
    ds_read_b128 v[88:91], v3 offset:3072
    s_waitcnt lgkmcnt(4)
    v_mfma_f32_16x16x32_bf16 v[144:147], v[104:107], v[56:59], v[144:147]
    ds_read_b128 v[92:95], v3 offset:11264
    s_mov_b32 s54, 50176
    buffer_load_dwordx4 v[36:39], v6, s[4:7], s54 offen sc1
    s_waitcnt vmcnt(11)
    s_waitcnt lgkmcnt(4)
    v_mfma_f32_16x16x32_bf16 v[128:131], v[108:111], v[60:63], v[128:131]
    s_waitcnt lgkmcnt(0)
    s_barrier
    ds_read_b128 v[96:99], v3 offset:16384
    v_mfma_f32_16x16x32_bf16 v[132:135], v[80:83], v[60:63], v[132:135]
    ds_read_b128 v[100:103], v3 offset:24576
    v_mfma_f32_16x16x32_bf16 v[136:139], v[84:87], v[60:63], v[136:139]
    ds_read_b128 v[104:107], v3 offset:32768
    v_mfma_f32_16x16x32_bf16 v[140:143], v[88:91], v[60:63], v[140:143]
    ds_read_b128 v[108:111], v3 offset:40960
    v_mfma_f32_16x16x32_bf16 v[144:147], v[92:95], v[60:63], v[144:147]
    ds_read_b128 v[80:83], v3 offset:49152
    s_mov_b32 s54, 51200
    buffer_load_dwordx4 v[40:43], v6, s[4:7], s54 offen sc1
    s_waitcnt vmcnt(11)
    s_waitcnt lgkmcnt(4)
    v_mfma_f32_16x16x32_bf16 v[128:131], v[96:99], v[64:67], v[128:131]
    ds_read_b128 v[84:87], v3 offset:17408
    s_waitcnt lgkmcnt(4)
    v_mfma_f32_16x16x32_bf16 v[132:135], v[100:103], v[64:67], v[132:135]
    ds_read_b128 v[88:91], v3 offset:25600
    s_waitcnt lgkmcnt(4)
    v_mfma_f32_16x16x32_bf16 v[136:139], v[104:107], v[64:67], v[136:139]
    ds_read_b128 v[92:95], v3 offset:33792
    s_waitcnt lgkmcnt(4)
    v_mfma_f32_16x16x32_bf16 v[140:143], v[108:111], v[64:67], v[140:143]
    ds_read_b128 v[96:99], v3 offset:41984
    s_waitcnt lgkmcnt(4)
    v_mfma_f32_16x16x32_bf16 v[144:147], v[80:83], v[64:67], v[144:147]
    ds_read_b128 v[100:103], v3 offset:50176
    s_waitcnt vmcnt(10)
    s_waitcnt lgkmcnt(4)
    v_mfma_f32_16x16x32_bf16 v[128:131], v[84:87], v[68:71], v[128:131]
    ds_read_b128 v[104:107], v3 offset:18432
    s_waitcnt lgkmcnt(4)
    v_mfma_f32_16x16x32_bf16 v[132:135], v[88:91], v[68:71], v[132:135]
    ds_read_b128 v[108:111], v3 offset:26624
    s_waitcnt lgkmcnt(4)
    v_mfma_f32_16x16x32_bf16 v[136:139], v[92:95], v[68:71], v[136:139]
    ds_read_b128 v[80:83], v3 offset:34816
    s_waitcnt lgkmcnt(4)
    v_mfma_f32_16x16x32_bf16 v[140:143], v[96:99], v[68:71], v[140:143]
    ds_read_b128 v[84:87], v3 offset:43008
    s_waitcnt lgkmcnt(4)
    v_mfma_f32_16x16x32_bf16 v[144:147], v[100:103], v[68:71], v[144:147]
    ds_read_b128 v[88:91], v3 offset:51200
    s_waitcnt vmcnt(4)
    s_waitcnt lgkmcnt(4)
    v_mfma_f32_16x16x32_bf16 v[128:131], v[104:107], v[72:75], v[128:131]
    ds_read_b128 v[92:95], v3 offset:19456
    s_waitcnt lgkmcnt(4)
    v_mfma_f32_16x16x32_bf16 v[132:135], v[108:111], v[72:75], v[132:135]
    ds_read_b128 v[96:99], v3 offset:27648
    s_waitcnt lgkmcnt(4)
    v_mfma_f32_16x16x32_bf16 v[136:139], v[80:83], v[72:75], v[136:139]
    ds_read_b128 v[100:103], v3 offset:35840
    s_waitcnt lgkmcnt(4)
    v_mfma_f32_16x16x32_bf16 v[140:143], v[84:87], v[72:75], v[140:143]
    ds_read_b128 v[104:107], v3 offset:44032
    s_waitcnt lgkmcnt(4)
    v_mfma_f32_16x16x32_bf16 v[144:147], v[88:91], v[72:75], v[144:147]
    ds_read_b128 v[108:111], v3 offset:52224
    s_waitcnt vmcnt(3)
    s_waitcnt lgkmcnt(4)
    v_mfma_f32_16x16x32_bf16 v[128:131], v[92:95], v[76:79], v[128:131]
    s_waitcnt lgkmcnt(0)
    s_barrier
    ds_read_b128 v[80:83], v4 offset:0
    v_mfma_f32_16x16x32_bf16 v[132:135], v[96:99], v[76:79], v[132:135]
    ds_read_b128 v[84:87], v4 offset:8192
    v_mfma_f32_16x16x32_bf16 v[136:139], v[100:103], v[76:79], v[136:139]
    ds_read_b128 v[88:91], v4 offset:16384
    v_mfma_f32_16x16x32_bf16 v[140:143], v[104:107], v[76:79], v[140:143]
    ds_read_b128 v[92:95], v4 offset:24576
    v_mfma_f32_16x16x32_bf16 v[144:147], v[108:111], v[76:79], v[144:147]
    ds_read_b128 v[96:99], v4 offset:32768
    s_waitcnt vmcnt(2)
    s_waitcnt lgkmcnt(4)
    v_mfma_f32_16x16x32_bf16 v[128:131], v[80:83], v[32:35], v[128:131]
    ds_read_b128 v[100:103], v4 offset:1024
    s_waitcnt lgkmcnt(4)
    v_mfma_f32_16x16x32_bf16 v[132:135], v[84:87], v[32:35], v[132:135]
    ds_read_b128 v[104:107], v4 offset:9216
    s_waitcnt lgkmcnt(4)
    v_mfma_f32_16x16x32_bf16 v[136:139], v[88:91], v[32:35], v[136:139]
    ds_read_b128 v[108:111], v4 offset:17408
    s_waitcnt lgkmcnt(4)
    v_mfma_f32_16x16x32_bf16 v[140:143], v[92:95], v[32:35], v[140:143]
    ds_read_b128 v[80:83], v4 offset:25600
    s_waitcnt lgkmcnt(4)
    v_mfma_f32_16x16x32_bf16 v[144:147], v[96:99], v[32:35], v[144:147]
    ds_read_b128 v[84:87], v4 offset:33792
    s_waitcnt vmcnt(1)
    s_waitcnt lgkmcnt(4)
    v_mfma_f32_16x16x32_bf16 v[128:131], v[100:103], v[36:39], v[128:131]
    ds_read_b128 v[88:91], v4 offset:2048
    s_waitcnt lgkmcnt(4)
    v_mfma_f32_16x16x32_bf16 v[132:135], v[104:107], v[36:39], v[132:135]
    ds_read_b128 v[92:95], v4 offset:10240
    s_waitcnt lgkmcnt(4)
    v_mfma_f32_16x16x32_bf16 v[136:139], v[108:111], v[36:39], v[136:139]
    ds_read_b128 v[96:99], v4 offset:18432
    s_waitcnt lgkmcnt(4)
    v_mfma_f32_16x16x32_bf16 v[140:143], v[80:83], v[36:39], v[140:143]
    ds_read_b128 v[100:103], v4 offset:26624
    s_waitcnt lgkmcnt(4)
    v_mfma_f32_16x16x32_bf16 v[144:147], v[84:87], v[36:39], v[144:147]
    ds_read_b128 v[104:107], v4 offset:34816
    s_waitcnt vmcnt(0)
    s_waitcnt lgkmcnt(4)
    v_mfma_f32_16x16x32_bf16 v[128:131], v[88:91], v[40:43], v[128:131]
    s_waitcnt lgkmcnt(3)
    v_mfma_f32_16x16x32_bf16 v[132:135], v[92:95], v[40:43], v[132:135]
    s_waitcnt lgkmcnt(2)
    v_mfma_f32_16x16x32_bf16 v[136:139], v[96:99], v[40:43], v[136:139]
    s_waitcnt lgkmcnt(1)
    v_mfma_f32_16x16x32_bf16 v[140:143], v[100:103], v[40:43], v[140:143]
    s_waitcnt lgkmcnt(0)
    v_mfma_f32_16x16x32_bf16 v[144:147], v[104:107], v[40:43], v[144:147]
    s_mul_i32 s45, s43, 5120
    s_add_u32 s45, s45, 143360
    v_add_u32 v8, s45, v1
    s_cmp_lg_u32 s44, 0
    s_cbranch_scc1 L_kh1_124
    s_nop 0
    ds_write_b128 v8, v[140:143] offset:3072
    s_nop 0
    ds_write_b128 v8, v[144:147] offset:4096
    s_branch L_khj_125
L_kh1_124:
    s_nop 7
    ds_write_b128 v8, v[128:131] offset:0
    ds_write_b128 v8, v[132:135] offset:1024
    ds_write_b128 v8, v[136:139] offset:2048
L_khj_125:
    s_waitcnt lgkmcnt(0)
    s_barrier
    s_cmp_lg_u32 s44, 0
    s_cbranch_scc1 L_kh1b_126
    ds_read_b128 v[80:83], v8 offset:0
    ds_read_b128 v[84:87], v8 offset:1024
    ds_read_b128 v[88:91], v8 offset:2048
    s_waitcnt lgkmcnt(0)
    v_pk_add_f32 v[128:129], v[128:129], v[80:81]
    v_pk_add_f32 v[130:131], v[130:131], v[82:83]
    v_pk_add_f32 v[132:133], v[132:133], v[84:85]
    v_pk_add_f32 v[134:135], v[134:135], v[86:87]
    v_pk_add_f32 v[136:137], v[136:137], v[88:89]
    v_pk_add_f32 v[138:139], v[138:139], v[90:91]
    v_lshlrev_b32 v8, 16, v208
    v_and_b32 v9, 0xffff0000, v208
    v_add_f32 v128, v128, v8
    v_add_f32 v129, v129, v9
    v_lshlrev_b32 v8, 16, v112
    v_and_b32 v9, 0xffff0000, v112
    v_fma_f32 v128, v128, v220, v8
    v_fma_f32 v129, v129, v221, v9
    v_lshlrev_b32 v8, 16, v209
    v_and_b32 v9, 0xffff0000, v209
    v_add_f32 v130, v130, v8
    v_add_f32 v131, v131, v9
    v_lshlrev_b32 v8, 16, v113
    v_and_b32 v9, 0xffff0000, v113
    v_fma_f32 v130, v130, v222, v8
    v_fma_f32 v131, v131, v223, v9
    v_cvt_pk_bf16_f32 v16, v128, v129
    v_cvt_pk_bf16_f32 v17, v130, v131
    buffer_store_dwordx2 v[16:17], v31, s[20:23], s57 offen offset:0
    v_lshlrev_b32 v8, 16, v210
    v_and_b32 v9, 0xffff0000, v210
    v_add_f32 v132, v132, v8
    v_add_f32 v133, v133, v9
    v_lshlrev_b32 v8, 16, v114
    v_and_b32 v9, 0xffff0000, v114
    v_fma_f32 v132, v132, v224, v8
    v_fma_f32 v133, v133, v225, v9
    v_lshlrev_b32 v8, 16, v211
    v_and_b32 v9, 0xffff0000, v211
    v_add_f32 v134, v134, v8
    v_add_f32 v135, v135, v9
    v_lshlrev_b32 v8, 16, v115
    v_and_b32 v9, 0xffff0000, v115
    v_fma_f32 v134, v134, v226, v8
    v_fma_f32 v135, v135, v227, v9
    v_cvt_pk_bf16_f32 v18, v132, v133
    v_cvt_pk_bf16_f32 v19, v134, v135
    buffer_store_dwordx2 v[18:19], v31, s[20:23], s57 offen offset:32
    v_lshlrev_b32 v8, 16, v212
    v_and_b32 v9, 0xffff0000, v212
    v_add_f32 v136, v136, v8
    v_add_f32 v137, v137, v9
    v_lshlrev_b32 v8, 16, v116
    v_and_b32 v9, 0xffff0000, v116
    v_fma_f32 v136, v136, v228, v8
    v_fma_f32 v137, v137, v229, v9
    v_lshlrev_b32 v8, 16, v213
    v_and_b32 v9, 0xffff0000, v213
    v_add_f32 v138, v138, v8
    v_add_f32 v139, v139, v9
    v_lshlrev_b32 v8, 16, v117
    v_and_b32 v9, 0xffff0000, v117
    v_fma_f32 v138, v138, v230, v8
    v_fma_f32 v139, v139, v231, v9
    v_cvt_pk_bf16_f32 v20, v136, v137
    v_cvt_pk_bf16_f32 v21, v138, v139
    buffer_store_dwordx2 v[20:21], v31, s[20:23], s57 offen offset:64
    s_branch L_khe_127
L_kh1b_126:
    ds_read_b128 v[92:95], v8 offset:3072
    ds_read_b128 v[96:99], v8 offset:4096
    s_waitcnt lgkmcnt(0)
    v_pk_add_f32 v[140:141], v[140:141], v[92:93]
    v_pk_add_f32 v[142:143], v[142:143], v[94:95]
    v_pk_add_f32 v[144:145], v[144:145], v[96:97]
    v_pk_add_f32 v[146:147], v[146:147], v[98:99]
    v_lshlrev_b32 v8, 16, v208
    v_and_b32 v9, 0xffff0000, v208
    v_add_f32 v140, v140, v8
    v_add_f32 v141, v141, v9
    v_lshlrev_b32 v8, 16, v112
    v_and_b32 v9, 0xffff0000, v112
    v_fma_f32 v140, v140, v220, v8
    v_fma_f32 v141, v141, v221, v9
    v_lshlrev_b32 v8, 16, v209
    v_and_b32 v9, 0xffff0000, v209
    v_add_f32 v142, v142, v8
    v_add_f32 v143, v143, v9
    v_lshlrev_b32 v8, 16, v113
    v_and_b32 v9, 0xffff0000, v113
    v_fma_f32 v142, v142, v222, v8
    v_fma_f32 v143, v143, v223, v9
    v_cvt_pk_bf16_f32 v16, v140, v141
    v_cvt_pk_bf16_f32 v17, v142, v143
    buffer_store_dwordx2 v[16:17], v31, s[20:23], s57 offen offset:96
    v_lshlrev_b32 v8, 16, v210
    v_and_b32 v9, 0xffff0000, v210
    v_add_f32 v144, v144, v8
    v_add_f32 v145, v145, v9
    v_lshlrev_b32 v8, 16, v114
    v_and_b32 v9, 0xffff0000, v114
    v_fma_f32 v144, v144, v224, v8
    v_fma_f32 v145, v145, v225, v9
    v_lshlrev_b32 v8, 16, v211
    v_and_b32 v9, 0xffff0000, v211
    v_add_f32 v146, v146, v8
    v_add_f32 v147, v147, v9
    v_lshlrev_b32 v8, 16, v115
    v_and_b32 v9, 0xffff0000, v115
    v_fma_f32 v146, v146, v226, v8
    v_fma_f32 v147, v147, v227, v9
    v_cvt_pk_bf16_f32 v18, v144, v145
    v_cvt_pk_bf16_f32 v19, v146, v147
    buffer_store_dwordx2 v[18:19], v31, s[20:23], s57 offen offset:128
L_khe_127:
    s_waitcnt vmcnt(0)
    s_endpgm
L_safe_in_64:
    v_mov_b32 v64, 0
    v_mov_b32 v65, 0
    v_mov_b32 v66, 0
    v_mov_b32 v67, 0
    v_mov_b32 v68, 0
    v_mov_b32 v69, 0
    v_mov_b32 v70, 0
    v_mov_b32 v71, 0
    v_mov_b32 v72, 0
    v_mov_b32 v73, 0
    v_mov_b32 v74, 0
    v_mov_b32 v75, 0
    v_mov_b32 v76, 0
    v_mov_b32 v77, 0
    v_mov_b32 v78, 0
    v_mov_b32 v79, 0
    v_mov_b32 v80, 0
    v_mov_b32 v81, 0
    v_mov_b32 v82, 0
    v_mov_b32 v83, 0
    v_mov_b32 v84, 0
    v_mov_b32 v85, 0
    v_mov_b32 v86, 0
    v_mov_b32 v87, 0
    v_mov_b32 v88, 0
    v_mov_b32 v89, 0
    v_mov_b32 v90, 0
    v_mov_b32 v91, 0
    v_mov_b32 v92, 0
    v_mov_b32 v93, 0
    v_mov_b32 v94, 0
    v_mov_b32 v95, 0
    v_mov_b32 v96, 0
    v_mov_b32 v97, 0
    v_mov_b32 v98, 0
    v_mov_b32 v99, 0
    v_mov_b32 v100, 0
    v_mov_b32 v101, 0
    v_mov_b32 v102, 0
    v_mov_b32 v103, 0
    v_mov_b32 v104, 0
    v_mov_b32 v105, 0
    v_mov_b32 v106, 0
    v_mov_b32 v107, 0
    v_mov_b32 v108, 0
    v_mov_b32 v109, 0
    v_mov_b32 v110, 0
    v_mov_b32 v111, 0
    v_mov_b32 v112, 0
    v_mov_b32 v113, 0
    v_mov_b32 v114, 0
    v_mov_b32 v115, 0
    v_mov_b32 v116, 0
    v_mov_b32 v117, 0
    v_mov_b32 v118, 0
    v_mov_b32 v119, 0
    v_mov_b32 v120, 0
    v_mov_b32 v121, 0
    v_mov_b32 v122, 0
    v_mov_b32 v123, 0
    v_mov_b32 v124, 0
    v_mov_b32 v125, 0
    v_mov_b32 v126, 0
    v_mov_b32 v127, 0
    v_mov_b32 v228, 0
    v_mov_b32 v229, 0
    v_mov_b32 v232, 0xff7fffff
    s_mov_b32 s42, 0
L_safe_128:
    s_waitcnt vmcnt(0) lgkmcnt(0)
    s_barrier
    s_mov_b32 m0, s43
    s_nop 0
    buffer_load_dwordx4 v5, s[12:15], s42 offen lds
    buffer_load_dwordx4 v6, s[12:15], s42 offen offset:1024 lds
    s_mov_b32 m0, s44
    s_nop 0
    buffer_load_dwordx4 v7, s[16:19], s42 offen lds
    buffer_load_dwordx4 v7, s[16:19], s42 offen offset:1024 lds
    s_waitcnt vmcnt(0)
    s_barrier
    ds_read_b128 v[192:195], v216 offset:0
    s_waitcnt lgkmcnt(0)
    v_mfma_f32_32x32x16_bf16 v[128:143], v[192:195], v[32:35], 0
    s_nop 7
    ds_read_b128 v[192:195], v217 offset:0
    s_waitcnt lgkmcnt(0)
    v_mfma_f32_32x32x16_bf16 v[128:143], v[192:195], v[36:39], v[128:143]
    s_nop 7
    ds_read_b128 v[192:195], v218 offset:0
    s_waitcnt lgkmcnt(0)
    v_mfma_f32_32x32x16_bf16 v[128:143], v[192:195], v[40:43], v[128:143]
    s_nop 7
    ds_read_b128 v[192:195], v219 offset:0
    s_waitcnt lgkmcnt(0)
    v_mfma_f32_32x32x16_bf16 v[128:143], v[192:195], v[44:47], v[128:143]
    s_nop 7
    ds_read_b128 v[192:195], v220 offset:0
    s_waitcnt lgkmcnt(0)
    v_mfma_f32_32x32x16_bf16 v[128:143], v[192:195], v[48:51], v[128:143]
    s_nop 7
    ds_read_b128 v[192:195], v221 offset:0
    s_waitcnt lgkmcnt(0)
    v_mfma_f32_32x32x16_bf16 v[128:143], v[192:195], v[52:55], v[128:143]
    s_nop 7
    ds_read_b128 v[192:195], v222 offset:0
    s_waitcnt lgkmcnt(0)
    v_mfma_f32_32x32x16_bf16 v[128:143], v[192:195], v[56:59], v[128:143]
    s_nop 7
    ds_read_b128 v[192:195], v223 offset:0
    s_waitcnt lgkmcnt(0)
    v_mfma_f32_32x32x16_bf16 v[128:143], v[192:195], v[60:63], v[128:143]
    s_nop 7
    s_nop 3
    v_max3_f32 v230, v128, v129, v130
    v_max3_f32 v230, v230, v131, v132
    v_max3_f32 v230, v230, v133, v134
    v_max3_f32 v230, v230, v135, v136
    v_max3_f32 v230, v230, v137, v138
    v_max3_f32 v230, v230, v139, v140
    v_max3_f32 v230, v230, v141, v142
    v_max_f32 v230, v230, v143
    v_mov_b32 v231, v230
    s_nop 1
    v_permlane32_swap_b32 v230, v231
    v_max_f32 v230, v230, v231
    v_max_f32 v230, v230, v232
    v_sub_f32 v233, v232, v230
    v_exp_f32 v233, v233
    v_mov_b32 v232, v230
    v_mul_f32 v64, v64, v233
    v_mul_f32 v65, v65, v233
    v_mul_f32 v66, v66, v233
    v_mul_f32 v67, v67, v233
    v_mul_f32 v68, v68, v233
    v_mul_f32 v69, v69, v233
    v_mul_f32 v70, v70, v233
    v_mul_f32 v71, v71, v233
    v_mul_f32 v72, v72, v233
    v_mul_f32 v73, v73, v233
    v_mul_f32 v74, v74, v233
    v_mul_f32 v75, v75, v233
    v_mul_f32 v76, v76, v233
    v_mul_f32 v77, v77, v233
    v_mul_f32 v78, v78, v233
    v_mul_f32 v79, v79, v233
    v_mul_f32 v80, v80, v233
    v_mul_f32 v81, v81, v233
    v_mul_f32 v82, v82, v233
    v_mul_f32 v83, v83, v233
    v_mul_f32 v84, v84, v233
    v_mul_f32 v85, v85, v233
    v_mul_f32 v86, v86, v233
    v_mul_f32 v87, v87, v233
    v_mul_f32 v88, v88, v233
    v_mul_f32 v89, v89, v233
    v_mul_f32 v90, v90, v233
    v_mul_f32 v91, v91, v233
    v_mul_f32 v92, v92, v233
    v_mul_f32 v93, v93, v233
    v_mul_f32 v94, v94, v233
    v_mul_f32 v95, v95, v233
    v_mul_f32 v96, v96, v233
    v_mul_f32 v97, v97, v233
    v_mul_f32 v98, v98, v233
    v_mul_f32 v99, v99, v233
    v_mul_f32 v100, v100, v233
    v_mul_f32 v101, v101, v233
    v_mul_f32 v102, v102, v233
    v_mul_f32 v103, v103, v233
    v_mul_f32 v104, v104, v233
    v_mul_f32 v105, v105, v233
    v_mul_f32 v106, v106, v233
    v_mul_f32 v107, v107, v233
    v_mul_f32 v108, v108, v233
    v_mul_f32 v109, v109, v233
    v_mul_f32 v110, v110, v233
    v_mul_f32 v111, v111, v233
    v_mul_f32 v112, v112, v233
    v_mul_f32 v113, v113, v233
    v_mul_f32 v114, v114, v233
    v_mul_f32 v115, v115, v233
    v_mul_f32 v116, v116, v233
    v_mul_f32 v117, v117, v233
    v_mul_f32 v118, v118, v233
    v_mul_f32 v119, v119, v233
    v_mul_f32 v120, v120, v233
    v_mul_f32 v121, v121, v233
    v_mul_f32 v122, v122, v233
    v_mul_f32 v123, v123, v233
    v_mul_f32 v124, v124, v233
    v_mul_f32 v125, v125, v233
    v_mul_f32 v126, v126, v233
    v_mul_f32 v127, v127, v233
    v_mul_f32 v228, v228, v233
    v_sub_f32 v128, v128, v232
    v_sub_f32 v129, v129, v232
    v_sub_f32 v130, v130, v232
    v_sub_f32 v131, v131, v232
    v_sub_f32 v132, v132, v232
    v_sub_f32 v133, v133, v232
    v_sub_f32 v134, v134, v232
    v_sub_f32 v135, v135, v232
    v_sub_f32 v136, v136, v232
    v_sub_f32 v137, v137, v232
    v_sub_f32 v138, v138, v232
    v_sub_f32 v139, v139, v232
    v_sub_f32 v140, v140, v232
    v_sub_f32 v141, v141, v232
    v_sub_f32 v142, v142, v232
    v_sub_f32 v143, v143, v232
    v_exp_f32 v128, v128
    v_exp_f32 v129, v129
    v_exp_f32 v130, v130
    v_exp_f32 v131, v131
    v_exp_f32 v132, v132
    v_exp_f32 v133, v133
    v_exp_f32 v134, v134
    v_exp_f32 v135, v135
    v_exp_f32 v136, v136
    v_exp_f32 v137, v137
    v_exp_f32 v138, v138
    v_exp_f32 v139, v139
    v_exp_f32 v140, v140
    v_exp_f32 v141, v141
    v_exp_f32 v142, v142
    v_exp_f32 v143, v143
    v_add_f32 v228, v228, v128
    v_add_f32 v228, v228, v129
    v_add_f32 v228, v228, v130
    v_add_f32 v228, v228, v131
    v_add_f32 v228, v228, v132
    v_add_f32 v228, v228, v133
    v_add_f32 v228, v228, v134
    v_add_f32 v228, v228, v135
    v_add_f32 v228, v228, v136
    v_add_f32 v228, v228, v137
    v_add_f32 v228, v228, v138
    v_add_f32 v228, v228, v139
    v_add_f32 v228, v228, v140
    v_add_f32 v228, v228, v141
    v_add_f32 v228, v228, v142
    v_add_f32 v228, v228, v143
    v_cvt_pk_bf16_f32 v160, v128, v129
    v_cvt_pk_bf16_f32 v161, v130, v131
    v_cvt_pk_bf16_f32 v162, v132, v133
    v_cvt_pk_bf16_f32 v163, v134, v135
    v_cvt_pk_bf16_f32 v164, v136, v137
    v_cvt_pk_bf16_f32 v165, v138, v139
    v_cvt_pk_bf16_f32 v166, v140, v141
    v_cvt_pk_bf16_f32 v167, v142, v143
    ds_read_b64_tr_b16 v[192:193], v224 offset:0
    ds_read_b64_tr_b16 v[194:195], v224 offset:2048
    s_waitcnt lgkmcnt(0)
    v_mfma_f32_32x32x16_bf16 v[64:79], v[192:195], v[160:163], v[64:79]
    s_nop 7
    ds_read_b64_tr_b16 v[192:193], v225 offset:0
    ds_read_b64_tr_b16 v[194:195], v225 offset:2048
    s_waitcnt lgkmcnt(0)
    v_mfma_f32_32x32x16_bf16 v[80:95], v[192:195], v[160:163], v[80:95]
    s_nop 7
    ds_read_b64_tr_b16 v[192:193], v226 offset:0
    ds_read_b64_tr_b16 v[194:195], v226 offset:2048
    s_waitcnt lgkmcnt(0)
    v_mfma_f32_32x32x16_bf16 v[96:111], v[192:195], v[160:163], v[96:111]
    s_nop 7
    ds_read_b64_tr_b16 v[192:193], v227 offset:0
    ds_read_b64_tr_b16 v[194:195], v227 offset:2048
    s_waitcnt lgkmcnt(0)
    v_mfma_f32_32x32x16_bf16 v[112:127], v[192:195], v[160:163], v[112:127]
    s_nop 7
    ds_read_b64_tr_b16 v[192:193], v224 offset:4096
    ds_read_b64_tr_b16 v[194:195], v224 offset:6144
    s_waitcnt lgkmcnt(0)
    v_mfma_f32_32x32x16_bf16 v[64:79], v[192:195], v[164:167], v[64:79]
    s_nop 7
    ds_read_b64_tr_b16 v[192:193], v225 offset:4096
    ds_read_b64_tr_b16 v[194:195], v225 offset:6144
    s_waitcnt lgkmcnt(0)
    v_mfma_f32_32x32x16_bf16 v[80:95], v[192:195], v[164:167], v[80:95]
    s_nop 7
    ds_read_b64_tr_b16 v[192:193], v226 offset:4096
    ds_read_b64_tr_b16 v[194:195], v226 offset:6144
    s_waitcnt lgkmcnt(0)
    v_mfma_f32_32x32x16_bf16 v[96:111], v[192:195], v[164:167], v[96:111]
    s_nop 7
    ds_read_b64_tr_b16 v[192:193], v227 offset:4096
    ds_read_b64_tr_b16 v[194:195], v227 offset:6144
    s_waitcnt lgkmcnt(0)
    v_mfma_f32_32x32x16_bf16 v[112:127], v[192:195], v[164:167], v[112:127]
    s_nop 7
    s_nop 7
    ds_read_b128 v[192:195], v216 offset:8192
    s_waitcnt lgkmcnt(0)
    v_mfma_f32_32x32x16_bf16 v[128:143], v[192:195], v[32:35], 0
    s_nop 7
    ds_read_b128 v[192:195], v217 offset:8192
    s_waitcnt lgkmcnt(0)
    v_mfma_f32_32x32x16_bf16 v[128:143], v[192:195], v[36:39], v[128:143]
    s_nop 7
    ds_read_b128 v[192:195], v218 offset:8192
    s_waitcnt lgkmcnt(0)
    v_mfma_f32_32x32x16_bf16 v[128:143], v[192:195], v[40:43], v[128:143]
    s_nop 7
    ds_read_b128 v[192:195], v219 offset:8192
    s_waitcnt lgkmcnt(0)
    v_mfma_f32_32x32x16_bf16 v[128:143], v[192:195], v[44:47], v[128:143]
    s_nop 7
    ds_read_b128 v[192:195], v220 offset:8192
    s_waitcnt lgkmcnt(0)
    v_mfma_f32_32x32x16_bf16 v[128:143], v[192:195], v[48:51], v[128:143]
    s_nop 7
    ds_read_b128 v[192:195], v221 offset:8192
    s_waitcnt lgkmcnt(0)
    v_mfma_f32_32x32x16_bf16 v[128:143], v[192:195], v[52:55], v[128:143]
    s_nop 7
    ds_read_b128 v[192:195], v222 offset:8192
    s_waitcnt lgkmcnt(0)
    v_mfma_f32_32x32x16_bf16 v[128:143], v[192:195], v[56:59], v[128:143]
    s_nop 7
    ds_read_b128 v[192:195], v223 offset:8192
    s_waitcnt lgkmcnt(0)
    v_mfma_f32_32x32x16_bf16 v[128:143], v[192:195], v[60:63], v[128:143]
    s_nop 7
    s_nop 3
    v_max3_f32 v230, v128, v129, v130
    v_max3_f32 v230, v230, v131, v132
    v_max3_f32 v230, v230, v133, v134
    v_max3_f32 v230, v230, v135, v136
    v_max3_f32 v230, v230, v137, v138
    v_max3_f32 v230, v230, v139, v140
    v_max3_f32 v230, v230, v141, v142
    v_max_f32 v230, v230, v143
    v_mov_b32 v231, v230
    s_nop 1
    v_permlane32_swap_b32 v230, v231
    v_max_f32 v230, v230, v231
    v_max_f32 v230, v230, v232
    v_sub_f32 v233, v232, v230
    v_exp_f32 v233, v233
    v_mov_b32 v232, v230
    v_mul_f32 v64, v64, v233
    v_mul_f32 v65, v65, v233
    v_mul_f32 v66, v66, v233
    v_mul_f32 v67, v67, v233
    v_mul_f32 v68, v68, v233
    v_mul_f32 v69, v69, v233
    v_mul_f32 v70, v70, v233
    v_mul_f32 v71, v71, v233
    v_mul_f32 v72, v72, v233
    v_mul_f32 v73, v73, v233
    v_mul_f32 v74, v74, v233
    v_mul_f32 v75, v75, v233
    v_mul_f32 v76, v76, v233
    v_mul_f32 v77, v77, v233
    v_mul_f32 v78, v78, v233
    v_mul_f32 v79, v79, v233
    v_mul_f32 v80, v80, v233
    v_mul_f32 v81, v81, v233
    v_mul_f32 v82, v82, v233
    v_mul_f32 v83, v83, v233
    v_mul_f32 v84, v84, v233
    v_mul_f32 v85, v85, v233
    v_mul_f32 v86, v86, v233
    v_mul_f32 v87, v87, v233
    v_mul_f32 v88, v88, v233
    v_mul_f32 v89, v89, v233
    v_mul_f32 v90, v90, v233
    v_mul_f32 v91, v91, v233
    v_mul_f32 v92, v92, v233
    v_mul_f32 v93, v93, v233
    v_mul_f32 v94, v94, v233
    v_mul_f32 v95, v95, v233
    v_mul_f32 v96, v96, v233
    v_mul_f32 v97, v97, v233
    v_mul_f32 v98, v98, v233
    v_mul_f32 v99, v99, v233
    v_mul_f32 v100, v100, v233
    v_mul_f32 v101, v101, v233
    v_mul_f32 v102, v102, v233
    v_mul_f32 v103, v103, v233
    v_mul_f32 v104, v104, v233
    v_mul_f32 v105, v105, v233
    v_mul_f32 v106, v106, v233
    v_mul_f32 v107, v107, v233
    v_mul_f32 v108, v108, v233
    v_mul_f32 v109, v109, v233
    v_mul_f32 v110, v110, v233
    v_mul_f32 v111, v111, v233
    v_mul_f32 v112, v112, v233
    v_mul_f32 v113, v113, v233
    v_mul_f32 v114, v114, v233
    v_mul_f32 v115, v115, v233
    v_mul_f32 v116, v116, v233
    v_mul_f32 v117, v117, v233
    v_mul_f32 v118, v118, v233
    v_mul_f32 v119, v119, v233
    v_mul_f32 v120, v120, v233
    v_mul_f32 v121, v121, v233
    v_mul_f32 v122, v122, v233
    v_mul_f32 v123, v123, v233
    v_mul_f32 v124, v124, v233
    v_mul_f32 v125, v125, v233
    v_mul_f32 v126, v126, v233
    v_mul_f32 v127, v127, v233
    v_mul_f32 v228, v228, v233
    v_sub_f32 v128, v128, v232
    v_sub_f32 v129, v129, v232
    v_sub_f32 v130, v130, v232
    v_sub_f32 v131, v131, v232
    v_sub_f32 v132, v132, v232
    v_sub_f32 v133, v133, v232
    v_sub_f32 v134, v134, v232
    v_sub_f32 v135, v135, v232
    v_sub_f32 v136, v136, v232
    v_sub_f32 v137, v137, v232
    v_sub_f32 v138, v138, v232
    v_sub_f32 v139, v139, v232
    v_sub_f32 v140, v140, v232
    v_sub_f32 v141, v141, v232
    v_sub_f32 v142, v142, v232
    v_sub_f32 v143, v143, v232
    v_exp_f32 v128, v128
    v_exp_f32 v129, v129
    v_exp_f32 v130, v130
    v_exp_f32 v131, v131
    v_exp_f32 v132, v132
    v_exp_f32 v133, v133
    v_exp_f32 v134, v134
    v_exp_f32 v135, v135
    v_exp_f32 v136, v136
    v_exp_f32 v137, v137
    v_exp_f32 v138, v138
    v_exp_f32 v139, v139
    v_exp_f32 v140, v140
    v_exp_f32 v141, v141
    v_exp_f32 v142, v142
    v_exp_f32 v143, v143
    v_add_f32 v228, v228, v128
    v_add_f32 v228, v228, v129
    v_add_f32 v228, v228, v130
    v_add_f32 v228, v228, v131
    v_add_f32 v228, v228, v132
    v_add_f32 v228, v228, v133
    v_add_f32 v228, v228, v134
    v_add_f32 v228, v228, v135
    v_add_f32 v228, v228, v136
    v_add_f32 v228, v228, v137
    v_add_f32 v228, v228, v138
    v_add_f32 v228, v228, v139
    v_add_f32 v228, v228, v140
    v_add_f32 v228, v228, v141
    v_add_f32 v228, v228, v142
    v_add_f32 v228, v228, v143
    v_cvt_pk_bf16_f32 v160, v128, v129
    v_cvt_pk_bf16_f32 v161, v130, v131
    v_cvt_pk_bf16_f32 v162, v132, v133
    v_cvt_pk_bf16_f32 v163, v134, v135
    v_cvt_pk_bf16_f32 v164, v136, v137
    v_cvt_pk_bf16_f32 v165, v138, v139
    v_cvt_pk_bf16_f32 v166, v140, v141
    v_cvt_pk_bf16_f32 v167, v142, v143
    ds_read_b64_tr_b16 v[192:193], v224 offset:8192
    ds_read_b64_tr_b16 v[194:195], v224 offset:10240
    s_waitcnt lgkmcnt(0)
    v_mfma_f32_32x32x16_bf16 v[64:79], v[192:195], v[160:163], v[64:79]
    s_nop 7
    ds_read_b64_tr_b16 v[192:193], v225 offset:8192
    ds_read_b64_tr_b16 v[194:195], v225 offset:10240
    s_waitcnt lgkmcnt(0)
    v_mfma_f32_32x32x16_bf16 v[80:95], v[192:195], v[160:163], v[80:95]
    s_nop 7
    ds_read_b64_tr_b16 v[192:193], v226 offset:8192
    ds_read_b64_tr_b16 v[194:195], v226 offset:10240
    s_waitcnt lgkmcnt(0)
    v_mfma_f32_32x32x16_bf16 v[96:111], v[192:195], v[160:163], v[96:111]
    s_nop 7
    ds_read_b64_tr_b16 v[192:193], v227 offset:8192
    ds_read_b64_tr_b16 v[194:195], v227 offset:10240
    s_waitcnt lgkmcnt(0)
    v_mfma_f32_32x32x16_bf16 v[112:127], v[192:195], v[160:163], v[112:127]
    s_nop 7
    ds_read_b64_tr_b16 v[192:193], v224 offset:12288
    ds_read_b64_tr_b16 v[194:195], v224 offset:14336
    s_waitcnt lgkmcnt(0)
    v_mfma_f32_32x32x16_bf16 v[64:79], v[192:195], v[164:167], v[64:79]
    s_nop 7
    ds_read_b64_tr_b16 v[192:193], v225 offset:12288
    ds_read_b64_tr_b16 v[194:195], v225 offset:14336
    s_waitcnt lgkmcnt(0)
    v_mfma_f32_32x32x16_bf16 v[80:95], v[192:195], v[164:167], v[80:95]
    s_nop 7
    ds_read_b64_tr_b16 v[192:193], v226 offset:12288
    ds_read_b64_tr_b16 v[194:195], v226 offset:14336
    s_waitcnt lgkmcnt(0)
    v_mfma_f32_32x32x16_bf16 v[96:111], v[192:195], v[164:167], v[96:111]
    s_nop 7
    ds_read_b64_tr_b16 v[192:193], v227 offset:12288
    ds_read_b64_tr_b16 v[194:195], v227 offset:14336
    s_waitcnt lgkmcnt(0)
    v_mfma_f32_32x32x16_bf16 v[112:127], v[192:195], v[164:167], v[112:127]
    s_nop 7
    s_nop 7
    s_add_u32 s42, s42, 16384
    s_cmp_lt_u32 s42, 131072
    s_cbranch_scc1 L_safe_128
    s_nop 15
    s_waitcnt vmcnt(0) lgkmcnt(0)
    s_barrier
    v_add_f32 v228, v228, v229
    v_mov_b32 v229, v228
    s_nop 1
    v_permlane32_swap_b32 v228, v229
    v_add_f32 v228, v228, v229
    v_rcp_f32 v228, v228
    v_and_b32 v1, 31, v0
    s_lshl_b32 s45, s41, 8
    s_lshl_b32 s46, s3, 5
    s_add_u32 s45, s45, s46
    v_add_u32 v1, s45, v1
    v_lshrrev_b32 v2, 4, v1
    v_mul_u32_u24 v2, 131072, v2
    v_and_b32 v1, 15, v1
    v_lshlrev_b32 v1, 4, v1
    v_add_u32 v2, v2, v1
    v_lshrrev_b32 v1, 5, v0
    v_lshlrev_b32 v1, 8, v1
    v_add_u32 v2, v2, v1
    s_lshl_b32 s45, s40, 12
    s_add_u32 s45, s45, 33554432
    v_mov_b32 v229, v228
    v_pk_mul_f32 v[64:65], v[64:65], v[228:229]
    v_pk_mul_f32 v[66:67], v[66:67], v[228:229]
    v_pk_mul_f32 v[68:69], v[68:69], v[228:229]
    v_pk_mul_f32 v[70:71], v[70:71], v[228:229]
    v_pk_mul_f32 v[72:73], v[72:73], v[228:229]
    v_pk_mul_f32 v[74:75], v[74:75], v[228:229]
    v_pk_mul_f32 v[76:77], v[76:77], v[228:229]
    v_pk_mul_f32 v[78:79], v[78:79], v[228:229]
    v_cvt_pk_bf16_f32 v128, v64, v65
    v_cvt_pk_bf16_f32 v129, v66, v67
    v_cvt_pk_bf16_f32 v130, v68, v69
    v_cvt_pk_bf16_f32 v131, v70, v71
    v_cvt_pk_bf16_f32 v132, v72, v73
    v_cvt_pk_bf16_f32 v133, v74, v75
    v_cvt_pk_bf16_f32 v134, v76, v77
    v_cvt_pk_bf16_f32 v135, v78, v79
    v_permlane32_swap_b32 v128, v130
    v_permlane32_swap_b32 v129, v131
    buffer_store_dwordx4 v[128:131], v2, s[4:7], s45 offen offset:0 sc1
    v_permlane32_swap_b32 v132, v134
    v_permlane32_swap_b32 v133, v135
    buffer_store_dwordx4 v[132:135], v2, s[4:7], s45 offen offset:512 sc1
    v_pk_mul_f32 v[80:81], v[80:81], v[228:229]
    v_pk_mul_f32 v[82:83], v[82:83], v[228:229]
    v_pk_mul_f32 v[84:85], v[84:85], v[228:229]
    v_pk_mul_f32 v[86:87], v[86:87], v[228:229]
    v_pk_mul_f32 v[88:89], v[88:89], v[228:229]
    v_pk_mul_f32 v[90:91], v[90:91], v[228:229]
    v_pk_mul_f32 v[92:93], v[92:93], v[228:229]
    v_pk_mul_f32 v[94:95], v[94:95], v[228:229]
    v_cvt_pk_bf16_f32 v144, v80, v81
    v_cvt_pk_bf16_f32 v145, v82, v83
    v_cvt_pk_bf16_f32 v146, v84, v85
    v_cvt_pk_bf16_f32 v147, v86, v87
    v_cvt_pk_bf16_f32 v148, v88, v89
    v_cvt_pk_bf16_f32 v149, v90, v91
    v_cvt_pk_bf16_f32 v150, v92, v93
    v_cvt_pk_bf16_f32 v151, v94, v95
    v_permlane32_swap_b32 v144, v146
    v_permlane32_swap_b32 v145, v147
    buffer_store_dwordx4 v[144:147], v2, s[4:7], s45 offen offset:1024 sc1
    v_permlane32_swap_b32 v148, v150
    v_permlane32_swap_b32 v149, v151
    buffer_store_dwordx4 v[148:151], v2, s[4:7], s45 offen offset:1536 sc1
    v_pk_mul_f32 v[96:97], v[96:97], v[228:229]
    v_pk_mul_f32 v[98:99], v[98:99], v[228:229]
    v_pk_mul_f32 v[100:101], v[100:101], v[228:229]
    v_pk_mul_f32 v[102:103], v[102:103], v[228:229]
    v_pk_mul_f32 v[104:105], v[104:105], v[228:229]
    v_pk_mul_f32 v[106:107], v[106:107], v[228:229]
    v_pk_mul_f32 v[108:109], v[108:109], v[228:229]
    v_pk_mul_f32 v[110:111], v[110:111], v[228:229]
    v_cvt_pk_bf16_f32 v128, v96, v97
    v_cvt_pk_bf16_f32 v129, v98, v99
    v_cvt_pk_bf16_f32 v130, v100, v101
    v_cvt_pk_bf16_f32 v131, v102, v103
    v_cvt_pk_bf16_f32 v132, v104, v105
    v_cvt_pk_bf16_f32 v133, v106, v107
    v_cvt_pk_bf16_f32 v134, v108, v109
    v_cvt_pk_bf16_f32 v135, v110, v111
    v_permlane32_swap_b32 v128, v130
    v_permlane32_swap_b32 v129, v131
    buffer_store_dwordx4 v[128:131], v2, s[4:7], s45 offen offset:2048 sc1
    v_permlane32_swap_b32 v132, v134
    v_permlane32_swap_b32 v133, v135
    buffer_store_dwordx4 v[132:135], v2, s[4:7], s45 offen offset:2560 sc1
    v_pk_mul_f32 v[112:113], v[112:113], v[228:229]
    v_pk_mul_f32 v[114:115], v[114:115], v[228:229]
    v_pk_mul_f32 v[116:117], v[116:117], v[228:229]
    v_pk_mul_f32 v[118:119], v[118:119], v[228:229]
    v_pk_mul_f32 v[120:121], v[120:121], v[228:229]
    v_pk_mul_f32 v[122:123], v[122:123], v[228:229]
    v_pk_mul_f32 v[124:125], v[124:125], v[228:229]
    v_pk_mul_f32 v[126:127], v[126:127], v[228:229]
    v_cvt_pk_bf16_f32 v144, v112, v113
    v_cvt_pk_bf16_f32 v145, v114, v115
    v_cvt_pk_bf16_f32 v146, v116, v117
    v_cvt_pk_bf16_f32 v147, v118, v119
    v_cvt_pk_bf16_f32 v148, v120, v121
    v_cvt_pk_bf16_f32 v149, v122, v123
    v_cvt_pk_bf16_f32 v150, v124, v125
    v_cvt_pk_bf16_f32 v151, v126, v127
    v_permlane32_swap_b32 v144, v146
    v_permlane32_swap_b32 v145, v147
    buffer_store_dwordx4 v[144:147], v2, s[4:7], s45 offen offset:3072 sc1
    v_permlane32_swap_b32 v148, v150
    v_permlane32_swap_b32 v149, v151
    buffer_store_dwordx4 v[148:151], v2, s[4:7], s45 offen offset:3584 sc1
    s_waitcnt vmcnt(0)
    s_branch L_safe_back_65
L_exit_main:
    s_endpgm
.section .rodata,"a"
.p2align 6
.amdhsa_kernel adaLN_cond__sliding_block_cached__mixer_s_mlp__prompt_kernel
  .amdhsa_next_free_vgpr 256
  .amdhsa_next_free_sgpr 102
  .amdhsa_accum_offset 256
  .amdhsa_group_segment_fixed_size 0
  .amdhsa_kernarg_size 120
  .amdhsa_user_sgpr_count 2
  .amdhsa_user_sgpr_kernarg_segment_ptr 1
  .amdhsa_system_sgpr_workgroup_id_x 1
.end_amdhsa_kernel
```
